```python
import torch

def _softmax(x, axis=-1):
    return torch.softmax(x, dim=axis)
def _gelu(x):
    return torch.nn.functional.gelu(x, approximate="tanh")
def _silu(x):
    return torch.nn.functional.silu(x)
def _sigmoid(x):
    return torch.sigmoid(x)
def _layernorm(x, axis=-1, eps=1e-5):
    m = x.mean(dim=axis, keepdim=True)
    v = x.var(dim=axis, keepdim=True, unbiased=False)
    return (x - m) / torch.sqrt(v + eps)
def _scatter_add(tgt, idx, src, axis=0):
    return tgt.clone().index_add_(axis, idx, src)
def _segment_sum(src, seg, n):
    out = torch.zeros((n,) + src.shape[1:], dtype=src.dtype)
    return out.index_add_(0, seg, src)
def _pad(x, pw):
    flat = tuple(v for pair in reversed(pw) for v in pair)
    return torch.nn.functional.pad(x, flat)

kernel_name = 'parallel_sum__ssm_conv_s5__glu_gated_bilinear__prompt'

def setup_inputs():

    _w = (lambda a: (lambda t: t.to(torch.bfloat16) if t.is_floating_point() else t)(torch.as_tensor(a)))
    def _A_setup():
        B, S, D = 1, 2048, 640
        P = D
        Lambda_re = -0.5 * (lambda _x: torch.exp(torch.as_tensor(_x)))((lambda *s: torch.randn(*s, dtype=torch.bfloat16) * 0.2)(P))
        Lambda_im = (lambda *s: torch.randn(*s, dtype=torch.bfloat16) * 0.8)(P) * 1.0
        B_re = (lambda *s: torch.randn(*s, dtype=torch.bfloat16) * 0.2)(P, D) * (D ** -0.5)
        B_im = (lambda *s: torch.randn(*s, dtype=torch.bfloat16) * 0.2)(P, D) * (D ** -0.5)
        C_re = (lambda *s: torch.randn(*s, dtype=torch.bfloat16) * 0.2)(D, P) * (P ** -0.5)
        C_im = (lambda *s: torch.randn(*s, dtype=torch.bfloat16) * 0.2)(D, P) * (P ** -0.5)
        log_dt = (lambda *s: torch.randn(*s, dtype=torch.bfloat16) * 0.2)(P) * 0.3 - 2.0
        Dskip = (lambda *s: torch.randn(*s, dtype=torch.bfloat16) * 0.05)(D)
        return {
            "x": _w((lambda *s: torch.randn(*s, dtype=torch.bfloat16) * 0.05)(B, S, D)),
            "Lambda_re": _w(Lambda_re),
            "Lambda_im": _w(Lambda_im),
            "B_re": _w(B_re),
            "B_im": _w(B_im),
            "C_re": _w(C_re),
            "C_im": _w(C_im),
            "log_dt": _w(log_dt),
            "Dskip": _w(Dskip),
        }
    _A_in = _A_setup()

    def _B_setup():
        B, S, D, F = 1, 2048, 640, 1728
        return {
            "x": _w((lambda *s: torch.randn(*s, dtype=torch.bfloat16) * 0.05)(B, S, D)),
            "w_gate": _w((lambda *s: torch.randn(*s, dtype=torch.bfloat16) * 0.4)(D, F) * (D ** -0.5)),
            "w_up": _w((lambda *s: torch.randn(*s, dtype=torch.bfloat16) * 0.4)(D, F) * (D ** -0.5)),
            "w_down": _w((lambda *s: torch.randn(*s, dtype=torch.bfloat16) * 0.4)(F, D) * (F ** -0.5)),
        }
    _B_in = _B_setup()

    return {
        "A_x": _A_in["x"],
        "A_Lambda_re": _A_in["Lambda_re"],
        "A_Lambda_im": _A_in["Lambda_im"],
        "A_B_re": _A_in["B_re"],
        "A_B_im": _A_in["B_im"],
        "A_C_re": _A_in["C_re"],
        "A_C_im": _A_in["C_im"],
        "A_log_dt": _A_in["log_dt"],
        "A_Dskip": _A_in["Dskip"],
        "B_x": _B_in["x"],
        "B_w_gate": _B_in["w_gate"],
        "B_w_up": _B_in["w_up"],
        "B_w_down": _B_in["w_down"],
    }

def reference(A_x, A_Lambda_re, A_Lambda_im, A_B_re, A_B_im, A_C_re, A_C_im, A_log_dt, A_Dskip, B_x, B_w_gate, B_w_up, B_w_down):
    def _A_ref(x, Lambda_re, Lambda_im, B_re, B_im, C_re, C_im, log_dt, Dskip):
        Bsz, L, H = x.shape
        Lam = Lambda_re + 1j * Lambda_im
        Bmat = B_re + 1j * B_im
        Cmat = C_re + 1j * C_im
        dt = torch.exp(log_dt)
        Lam_bar = torch.exp(dt * Lam)
        B_bar = ((Lam_bar - 1.0) / Lam)[:, None] * Bmat
        Bu = torch.einsum("bld,pd->blp", x + 0j, B_bar)
        h = torch.zeros_like(Bu[:, 0, :])
        hs = []
        for t in range(L):
            h = Lam_bar[None, :] * h + Bu[:, t, :]
            hs.append(h)
        hseq = torch.stack(hs, 1)
        y = 2.0 * torch.einsum("blp,dp->bld", hseq, Cmat).real + x * Dskip[None, None, :]
        return y

    def _B_ref(x, w_gate, w_up, w_down):
        g = torch.einsum("bsd,df->bsf", x, w_gate)
        u = torch.einsum("bsd,df->bsf", x, w_up)
        h = g * u
        return torch.einsum("bsf,fd->bsd", h, w_down)

    x = A_x
    xn = _layernorm(x, axis=-1)
    return x + _A_ref(xn, A_Lambda_re, A_Lambda_im, A_B_re, A_B_im, A_C_re, A_C_im, A_log_dt, A_Dskip) + _B_ref(xn, B_w_gate, B_w_up, B_w_down)
```

```asm
; @launch grid=(256,1,1) block=(512,1,1) lds=163840
.amdgcn_target "amdgcn-amd-amdhsa--gfx950"
.text
.globl parallel_sum__ssm_conv_s5__glu_gated_bilinear__prompt_kernel
.p2align 8
.type parallel_sum__ssm_conv_s5__glu_gated_bilinear__prompt_kernel,@function
parallel_sum__ssm_conv_s5__glu_gated_bilinear__prompt_kernel:
    s_cmp_ge_u32 s2, 256
    s_cbranch_scc1 parallel_sum__ssm_conv_s5__glu_gated_bilinear__prompt_kernel_done
    s_load_dwordx16 s[16:31], s[0:1], 0
    s_load_dwordx16 s[32:47], s[0:1], 64
    s_and_b32 s6, s2, 1
    s_lshl_b32 s6, s6, 2
    s_bfe_u32 s8, s2, 0x20003
    s_add_u32 s6, s6, s8
    s_lshr_b32 s7, s2, 5
    s_lshl_b32 s7, s7, 2
    s_bfe_u32 s8, s2, 0x20001
    s_add_u32 s7, s7, s8
    v_lshrrev_b32 v2, 6, v0
    v_and_b32 v1, 63, v0
    v_readfirstlane_b32 s5, v2
    s_sub_u32 s9, s7, 10
    s_mul_i32 s9, s9, 80
    s_min_u32 s9, s9, 1648
    s_lshr_b32 s10, s9, 4
    s_and_b32 s14, s5, 3
    v_lshrrev_b32 v2, 3, v1
    s_lshl_b32 s11, s14, 6
    v_add_u32 v3, s11, v2
    v_mul_u32_u24 v3, 1280, v3
    v_bfe_u32 v4, v1, 4, 2
    v_and_b32 v5, 7, v1
    v_xor_b32 v4, v4, v5
    v_xor_b32 v5, 4, v4
    v_lshl_add_u32 v6, v4, 4, v3
    v_lshl_add_u32 v7, v5, 4, v3
    s_cmp_ge_u32 s7, 10
    s_cselect_b64 vcc, -1, 0
    v_cndmask_b32 v8, v6, v7, vcc
    v_cndmask_b32 v9, v7, v6, vcc
    v_add_u32 v232, 0, v6
    v_add_u32 v233, 9216, v8
    v_add_u32 v234, 18432, v9
    v_add_u32 v235, 27648, v7
    v_add_u32 v236, 40960, v6
    v_add_u32 v237, 50176, v8
    v_add_u32 v238, 59392, v9
    v_add_u32 v239, 68608, v7
    s_mul_i32 s12, s6, 327680
    s_lshl_b32 s13, s14, 13
    s_waitcnt lgkmcnt(0)
    s_cmp_ge_u32 s5, 4
    s_cbranch_scc1 parallel_sum__ssm_conv_s5__glu_gated_bilinear__prompt_kernel_nocpf
    s_getpc_b64 s[80:81]
parallel_sum__ssm_conv_s5__glu_gated_bilinear__prompt_kernel_pc0:
    s_lshr_b32 s82, s2, 3
    s_lshl_b32 s82, s82, 2
    s_add_u32 s82, s82, s5
    s_lshl_b32 s82, s82, 6
    s_load_dword s84, s[80:81], s82 offset:0
    s_load_dword s85, s[80:81], s82 offset:8192
    s_load_dword s86, s[80:81], s82 offset:16384
    s_load_dword s87, s[80:81], s82 offset:24576
    s_load_dword s88, s[80:81], s82 offset:32768
    s_load_dword s89, s[80:81], s82 offset:40960
    s_load_dword s90, s[80:81], s82 offset:49152
    s_min_u32 s82, s82, parallel_sum__ssm_conv_s5__glu_gated_bilinear__prompt_kernel_done-parallel_sum__ssm_conv_s5__glu_gated_bilinear__prompt_kernel_pc0-57344
    s_load_dword s91, s[80:81], s82 offset:57344
parallel_sum__ssm_conv_s5__glu_gated_bilinear__prompt_kernel_nocpf:
    s_mov_b32 s48, s16
    s_mov_b32 s49, s17
    s_mov_b32 s50, 0x280000
    s_mov_b32 s51, 0x00020000
    s_cmp_lt_u32 s5, 4
    s_cbranch_scc1 parallel_sum__ssm_conv_s5__glu_gated_bilinear__prompt_kernel_nodma0
    s_mov_b32 m0, s13
    buffer_load_dwordx4 v232, s[48:51], s12 offen offset:0 lds
    buffer_load_dwordx4 v233, s[48:51], s12 offen offset:1024 lds
    buffer_load_dwordx4 v234, s[48:51], s12 offen offset:2048 lds
    buffer_load_dwordx4 v235, s[48:51], s12 offen offset:3072 lds
    s_add_u32 m0, s13, 4096
    s_nop 0
    buffer_load_dwordx4 v236, s[48:51], s12 offen offset:0 lds
    buffer_load_dwordx4 v237, s[48:51], s12 offen offset:1024 lds
    buffer_load_dwordx4 v238, s[48:51], s12 offen offset:2048 lds
    buffer_load_dwordx4 v239, s[48:51], s12 offen offset:3072 lds
parallel_sum__ssm_conv_s5__glu_gated_bilinear__prompt_kernel_nodma0:
    s_mov_b32 s56, s46
    s_mov_b32 s57, s47
    s_mov_b32 s58, 0xbc0000
    s_mov_b32 s59, 0x00020000
    s_add_u32 s64, s46, 0x1800000
    s_addc_u32 s65, s47, 0
    s_mov_b32 s66, 0xf0000
    s_mov_b32 s67, 0x00020000
    s_add_u32 s60, s46, 0x1000000
    s_addc_u32 s61, s47, 0
    s_mov_b32 s62, 0x41c000
    s_mov_b32 s63, 0x00020000
    s_cmp_lt_u32 s7, 10
    s_cbranch_scc1 parallel_sum__ssm_conv_s5__glu_gated_bilinear__prompt_kernel_ssm_b
    s_and_b32 s80, s14, 1
    s_cmp_lt_u32 s14, 2
    s_cselect_b32 s52, s36, s38
    s_cselect_b32 s53, s37, s39
    s_mov_b32 s54, 0x21c000
    s_mov_b32 s55, 0x00020000
    s_mov_b32 s100, 32768
    s_cselect_b32 s100, s100, 43136
    s_mul_i32 s11, s80, 5120
    s_add_u32 s100, s100, s11
    s_lshl_b32 s101, s9, 1
    s_mov_b32 s81, 0xcccccccd
    s_mul_i32 s11, s80, 320
    v_add_u32 v2, 0, v1
    v_add_u32 v2, s11, v2
    v_mul_hi_u32 v3, v2, s81
    v_lshrrev_b32 v3, 3, v3
    v_mul_u32_u24 v6, 10, v3
    v_sub_u32 v6, v2, v6
    v_bfe_u32 v2, v3, 4, 1
    v_bfe_u32 v7, v3, 2, 2
    v_and_b32 v3, 0x23, v3
    v_lshl_or_b32 v3, v2, 2, v3
    v_lshl_or_b32 v3, v7, 3, v3
    v_mul_u32_u24 v3, 3456, v3
    v_lshl_add_u32 v240, v6, 4, v3
    v_add_u32 v2, 64, v1
    v_add_u32 v2, s11, v2
    v_mul_hi_u32 v3, v2, s81
    v_lshrrev_b32 v3, 3, v3
    v_mul_u32_u24 v6, 10, v3
    v_sub_u32 v6, v2, v6
    v_bfe_u32 v2, v3, 4, 1
    v_bfe_u32 v7, v3, 2, 2
    v_and_b32 v3, 0x23, v3
    v_lshl_or_b32 v3, v2, 2, v3
    v_lshl_or_b32 v3, v7, 3, v3
    v_mul_u32_u24 v3, 3456, v3
    v_lshl_add_u32 v241, v6, 4, v3
    v_subrev_u32 v241, 1024, v241
    v_add_u32 v2, 128, v1
    v_add_u32 v2, s11, v2
    v_mul_hi_u32 v3, v2, s81
    v_lshrrev_b32 v3, 3, v3
    v_mul_u32_u24 v6, 10, v3
    v_sub_u32 v6, v2, v6
    v_bfe_u32 v2, v3, 4, 1
    v_bfe_u32 v7, v3, 2, 2
    v_and_b32 v3, 0x23, v3
    v_lshl_or_b32 v3, v2, 2, v3
    v_lshl_or_b32 v3, v7, 3, v3
    v_mul_u32_u24 v3, 3456, v3
    v_lshl_add_u32 v242, v6, 4, v3
    v_subrev_u32 v242, 2048, v242
    v_add_u32 v2, 192, v1
    v_add_u32 v2, s11, v2
    v_mul_hi_u32 v3, v2, s81
    v_lshrrev_b32 v3, 3, v3
    v_mul_u32_u24 v6, 10, v3
    v_sub_u32 v6, v2, v6
    v_bfe_u32 v2, v3, 4, 1
    v_bfe_u32 v7, v3, 2, 2
    v_and_b32 v3, 0x23, v3
    v_lshl_or_b32 v3, v2, 2, v3
    v_lshl_or_b32 v3, v7, 3, v3
    v_mul_u32_u24 v3, 3456, v3
    v_lshl_add_u32 v243, v6, 4, v3
    v_subrev_u32 v243, 3072, v243
    v_add_u32 v2, 256, v1
    v_add_u32 v2, s11, v2
    v_mul_hi_u32 v3, v2, s81
    v_lshrrev_b32 v3, 3, v3
    v_mul_u32_u24 v6, 10, v3
    v_sub_u32 v6, v2, v6
    v_bfe_u32 v2, v3, 4, 1
    v_bfe_u32 v7, v3, 2, 2
    v_and_b32 v3, 0x23, v3
    v_lshl_or_b32 v3, v2, 2, v3
    v_lshl_or_b32 v3, v7, 3, v3
    v_mul_u32_u24 v3, 3456, v3
    v_lshl_add_u32 v244, v6, 4, v3
    s_cmp_lt_u32 s5, 4
    s_cbranch_scc1 parallel_sum__ssm_conv_s5__glu_gated_bilinear__prompt_kernel_cglu
    s_mov_b32 m0, s100
    buffer_load_dwordx4 v240, s[52:55], s101 offen offset:0 lds
    buffer_load_dwordx4 v241, s[52:55], s101 offen offset:1024 lds
    buffer_load_dwordx4 v242, s[52:55], s101 offen offset:2048 lds
    buffer_load_dwordx4 v243, s[52:55], s101 offen offset:3072 lds
    s_add_u32 m0, s100, 4096
    s_nop 0
    buffer_load_dwordx4 v244, s[52:55], s101 offen offset:0 lds
    s_branch parallel_sum__ssm_conv_s5__glu_gated_bilinear__prompt_kernel_hglu
parallel_sum__ssm_conv_s5__glu_gated_bilinear__prompt_kernel_cglu:
    v_lshrrev_b32 v2, 4, v1
    v_and_b32 v3, 15, v1
    v_lshrrev_b32 v4, 1, v3
    v_xor_b32 v4, v4, v2
    s_lshl_b32 s11, s5, 13
    v_lshl_add_u32 v5, v3, 7, s11
    v_lshl_add_u32 v8, v4, 4, v5
    v_xor_b32 v9, 64, v8
    v_add_u32 v10, 0x1a100, v8
    v_add_u32 v11, 0x1a100, v9
    v_lshrrev_b32 v4, 2, v3
    v_lshl_add_u32 v4, v2, 2, v4
    v_mul_u32_u24 v4, 160, v4
    v_and_b32 v6, 3, v1
    v_lshl_add_u32 v4, v6, 3, v4
    v_add_u32 v12, 0x8000, v4
    v_add_u32 v13, 0x15080, v4
    v_add_u32 v14, 0x22100, v4
    v_lshrrev_b32 v4, 5, v1
    v_mul_u32_u24 v18, 96256, v4
    v_and_b32 v4, 1, v2
    v_lshl_add_u32 v18, v4, 8, v18
    v_lshl_add_u32 v18, v3, 4, v18
    s_lshl_b32 s11, s5, 9
    s_add_u32 s11, s11, 0xd080
    v_lshl_add_u32 v19, v3, 3, s11
    v_lshlrev_b32 v20, 4, v2
    v_add_u32 v20, 0xd880, v20
    s_lshl_b32 s12, s6, 4
    s_lshl_b32 s13, s5, 2
    s_add_u32 s12, s12, s13
    s_mul_i32 s12, s12, 96256
    s_lshl_b32 s13, s10, 9
    s_add_u32 s12, s12, s13
    s_add_u32 s12, s12, 40960
    s_add_u32 s13, s12, 192512
    s_cmp_lg_u32 s5, 0
    s_cbranch_scc1 tw_1
    s_mov_b32 s72, s46
    s_mov_b32 s73, s47
    s_mov_b32 s74, 0x1a00000
    s_mov_b32 s75, 0x00020000
    s_mov_b32 s76, s42
    s_mov_b32 s77, s43
    s_mov_b32 s78, 0x500000
    s_mov_b32 s79, 0x00020000
    v_lshlrev_b32 v21, 21, v1
    v_min_u32 v22, 0x4ffffc, v21
    s_mov_b64 exec, 0x1fff
    buffer_load_dword v21, v21, s[72:75], 0 offen
    s_mov_b64 exec, 15
    buffer_load_dword v22, v22, s[76:79], 0 offen
    s_mov_b64 exec, -1
tw_1:
    s_barrier
    ds_read_b128 v[32:35], v8 offset:0
    ds_read_b128 v[36:39], v8 offset:2048
    ds_read_b128 v[40:43], v8 offset:4096
    ds_read_b128 v[44:47], v8 offset:6144
    ds_read_b64_tr_b16 v[64:65], v12 offset:0
    ds_read_b64_tr_b16 v[66:67], v12 offset:2560
    ds_read_b64_tr_b16 v[68:69], v12 offset:10368
    ds_read_b64_tr_b16 v[70:71], v12 offset:12928
    ds_read_b64_tr_b16 v[72:73], v12 offset:32
    ds_read_b64_tr_b16 v[74:75], v12 offset:2592
    ds_read_b64_tr_b16 v[76:77], v12 offset:10400
    ds_read_b64_tr_b16 v[78:79], v12 offset:12960
    ds_read_b64_tr_b16 v[80:81], v12 offset:64
    ds_read_b64_tr_b16 v[82:83], v12 offset:2624
    s_waitcnt lgkmcnt(8)
    v_mfma_f32_16x16x32_bf16 v[96:99], v[64:67], v[32:35], 0
    ds_read_b64_tr_b16 v[84:85], v12 offset:10432
    ds_read_b64_tr_b16 v[86:87], v12 offset:12992
    v_mfma_f32_16x16x32_bf16 v[100:103], v[64:67], v[36:39], 0
    ds_read_b128 v[48:51], v9 offset:0
    ds_read_b128 v[52:55], v9 offset:2048
    v_mfma_f32_16x16x32_bf16 v[104:107], v[64:67], v[40:43], 0
    ds_read_b128 v[56:59], v9 offset:4096
    ds_read_b128 v[60:63], v9 offset:6144
    v_mfma_f32_16x16x32_bf16 v[108:111], v[64:67], v[44:47], 0
    s_waitcnt lgkmcnt(12)
    v_mfma_f32_16x16x32_bf16 v[112:115], v[68:71], v[32:35], 0
    ds_read_b64_tr_b16 v[64:65], v12 offset:96
    ds_read_b64_tr_b16 v[66:67], v12 offset:2656
    v_mfma_f32_16x16x32_bf16 v[116:119], v[68:71], v[36:39], 0
    v_mfma_f32_16x16x32_bf16 v[120:123], v[68:71], v[40:43], 0
    v_mfma_f32_16x16x32_bf16 v[124:127], v[68:71], v[44:47], 0
    s_waitcnt lgkmcnt(12)
    v_mfma_f32_16x16x32_bf16 v[128:131], v[72:75], v[32:35], 0
    ds_read_b64_tr_b16 v[68:69], v12 offset:10464
    ds_read_b64_tr_b16 v[70:71], v12 offset:13024
    v_mfma_f32_16x16x32_bf16 v[132:135], v[72:75], v[36:39], 0
    v_mfma_f32_16x16x32_bf16 v[136:139], v[72:75], v[40:43], 0
    v_mfma_f32_16x16x32_bf16 v[140:143], v[72:75], v[44:47], 0
    s_waitcnt lgkmcnt(12)
    v_mfma_f32_16x16x32_bf16 v[144:147], v[76:79], v[32:35], 0
    ds_read_b64_tr_b16 v[72:73], v12 offset:128
    ds_read_b64_tr_b16 v[74:75], v12 offset:2688
    v_mfma_f32_16x16x32_bf16 v[148:151], v[76:79], v[36:39], 0
    v_mfma_f32_16x16x32_bf16 v[152:155], v[76:79], v[40:43], 0
    v_mfma_f32_16x16x32_bf16 v[156:159], v[76:79], v[44:47], 0
    s_waitcnt lgkmcnt(12)
    v_mfma_f32_16x16x32_bf16 v[160:163], v[80:83], v[32:35], 0
    ds_read_b64_tr_b16 v[76:77], v12 offset:10496
    ds_read_b64_tr_b16 v[78:79], v12 offset:13056
    v_mfma_f32_16x16x32_bf16 v[164:167], v[80:83], v[36:39], 0
    v_mfma_f32_16x16x32_bf16 v[168:171], v[80:83], v[40:43], 0
    v_mfma_f32_16x16x32_bf16 v[172:175], v[80:83], v[44:47], 0
    s_waitcnt lgkmcnt(12)
    v_mfma_f32_16x16x32_bf16 v[176:179], v[84:87], v[32:35], 0
    ds_read_b64_tr_b16 v[80:81], v12 offset:5120
    ds_read_b64_tr_b16 v[82:83], v12 offset:7680
    v_mfma_f32_16x16x32_bf16 v[180:183], v[84:87], v[36:39], 0
    v_mfma_f32_16x16x32_bf16 v[184:187], v[84:87], v[40:43], 0
    v_mfma_f32_16x16x32_bf16 v[188:191], v[84:87], v[44:47], 0
    s_waitcnt lgkmcnt(8)
    v_mfma_f32_16x16x32_bf16 v[192:195], v[64:67], v[32:35], 0
    ds_read_b64_tr_b16 v[84:85], v12 offset:15488
    ds_read_b64_tr_b16 v[86:87], v12 offset:18048
    v_mfma_f32_16x16x32_bf16 v[196:199], v[64:67], v[36:39], 0
    v_mfma_f32_16x16x32_bf16 v[200:203], v[64:67], v[40:43], 0
    v_mfma_f32_16x16x32_bf16 v[204:207], v[64:67], v[44:47], 0
    s_waitcnt lgkmcnt(8)
    v_mfma_f32_16x16x32_bf16 v[208:211], v[68:71], v[32:35], 0
    ds_read_b64_tr_b16 v[64:65], v12 offset:5152
    ds_read_b64_tr_b16 v[66:67], v12 offset:7712
    v_mfma_f32_16x16x32_bf16 v[212:215], v[68:71], v[36:39], 0
    v_mfma_f32_16x16x32_bf16 v[216:219], v[68:71], v[40:43], 0
    v_mfma_f32_16x16x32_bf16 v[220:223], v[68:71], v[44:47], 0
    s_waitcnt lgkmcnt(8)
    v_mfma_f32_16x16x32_bf16 v[224:227], v[72:75], v[32:35], 0
    ds_read_b64_tr_b16 v[68:69], v12 offset:15520
    ds_read_b64_tr_b16 v[70:71], v12 offset:18080
    v_mfma_f32_16x16x32_bf16 v[228:231], v[72:75], v[36:39], 0
    v_mfma_f32_16x16x32_bf16 v[232:235], v[72:75], v[40:43], 0
    v_mfma_f32_16x16x32_bf16 v[236:239], v[72:75], v[44:47], 0
    s_waitcnt lgkmcnt(8)
    v_mfma_f32_16x16x32_bf16 v[240:243], v[76:79], v[32:35], 0
    ds_read_b64_tr_b16 v[72:73], v12 offset:5184
    ds_read_b64_tr_b16 v[74:75], v12 offset:7744
    v_mfma_f32_16x16x32_bf16 v[244:247], v[76:79], v[36:39], 0
    v_mfma_f32_16x16x32_bf16 v[248:251], v[76:79], v[40:43], 0
    v_mfma_f32_16x16x32_bf16 v[252:255], v[76:79], v[44:47], 0
    s_waitcnt lgkmcnt(8)
    v_mfma_f32_16x16x32_bf16 v[96:99], v[80:83], v[48:51], v[96:99]
    ds_read_b64_tr_b16 v[76:77], v12 offset:15552
    ds_read_b64_tr_b16 v[78:79], v12 offset:18112
    v_mfma_f32_16x16x32_bf16 v[100:103], v[80:83], v[52:55], v[100:103]
    v_mfma_f32_16x16x32_bf16 v[104:107], v[80:83], v[56:59], v[104:107]
    v_mfma_f32_16x16x32_bf16 v[108:111], v[80:83], v[60:63], v[108:111]
    s_waitcnt lgkmcnt(8)
    v_mfma_f32_16x16x32_bf16 v[112:115], v[84:87], v[48:51], v[112:115]
    ds_read_b64_tr_b16 v[80:81], v12 offset:5216
    ds_read_b64_tr_b16 v[82:83], v12 offset:7776
    v_mfma_f32_16x16x32_bf16 v[116:119], v[84:87], v[52:55], v[116:119]
    v_mfma_f32_16x16x32_bf16 v[120:123], v[84:87], v[56:59], v[120:123]
    v_mfma_f32_16x16x32_bf16 v[124:127], v[84:87], v[60:63], v[124:127]
    s_waitcnt lgkmcnt(8)
    v_mfma_f32_16x16x32_bf16 v[128:131], v[64:67], v[48:51], v[128:131]
    ds_read_b64_tr_b16 v[84:85], v12 offset:15584
    ds_read_b64_tr_b16 v[86:87], v12 offset:18144
    v_mfma_f32_16x16x32_bf16 v[132:135], v[64:67], v[52:55], v[132:135]
    v_mfma_f32_16x16x32_bf16 v[136:139], v[64:67], v[56:59], v[136:139]
    v_mfma_f32_16x16x32_bf16 v[140:143], v[64:67], v[60:63], v[140:143]
    s_waitcnt lgkmcnt(8)
    v_mfma_f32_16x16x32_bf16 v[144:147], v[68:71], v[48:51], v[144:147]
    ds_read_b64_tr_b16 v[64:65], v12 offset:5248
    ds_read_b64_tr_b16 v[66:67], v12 offset:7808
    v_mfma_f32_16x16x32_bf16 v[148:151], v[68:71], v[52:55], v[148:151]
    v_mfma_f32_16x16x32_bf16 v[152:155], v[68:71], v[56:59], v[152:155]
    v_mfma_f32_16x16x32_bf16 v[156:159], v[68:71], v[60:63], v[156:159]
    s_waitcnt lgkmcnt(8)
    v_mfma_f32_16x16x32_bf16 v[160:163], v[72:75], v[48:51], v[160:163]
    ds_read_b64_tr_b16 v[68:69], v12 offset:15616
    ds_read_b64_tr_b16 v[70:71], v12 offset:18176
    v_mfma_f32_16x16x32_bf16 v[164:167], v[72:75], v[52:55], v[164:167]
    v_mfma_f32_16x16x32_bf16 v[168:171], v[72:75], v[56:59], v[168:171]
    v_mfma_f32_16x16x32_bf16 v[172:175], v[72:75], v[60:63], v[172:175]
    s_waitcnt lgkmcnt(8)
    v_mfma_f32_16x16x32_bf16 v[176:179], v[76:79], v[48:51], v[176:179]
    v_mfma_f32_16x16x32_bf16 v[180:183], v[76:79], v[52:55], v[180:183]
    v_mfma_f32_16x16x32_bf16 v[184:187], v[76:79], v[56:59], v[184:187]
    v_mfma_f32_16x16x32_bf16 v[188:191], v[76:79], v[60:63], v[188:191]
    s_waitcnt lgkmcnt(6)
    v_mfma_f32_16x16x32_bf16 v[192:195], v[80:83], v[48:51], v[192:195]
    v_mfma_f32_16x16x32_bf16 v[196:199], v[80:83], v[52:55], v[196:199]
    v_mfma_f32_16x16x32_bf16 v[200:203], v[80:83], v[56:59], v[200:203]
    v_mfma_f32_16x16x32_bf16 v[204:207], v[80:83], v[60:63], v[204:207]
    s_waitcnt lgkmcnt(0)
    s_barrier
    v_mfma_f32_16x16x32_bf16 v[208:211], v[84:87], v[48:51], v[208:211]
    ds_read_b128 v[32:35], v8 offset:53376
    ds_read_b128 v[36:39], v8 offset:55424
    v_mfma_f32_16x16x32_bf16 v[212:215], v[84:87], v[52:55], v[212:215]
    ds_read_b128 v[40:43], v8 offset:57472
    ds_read_b128 v[44:47], v8 offset:59520
    v_mfma_f32_16x16x32_bf16 v[216:219], v[84:87], v[56:59], v[216:219]
    ds_read_b64_tr_b16 v[72:73], v13 offset:0
    ds_read_b64_tr_b16 v[74:75], v13 offset:2560
    v_mfma_f32_16x16x32_bf16 v[220:223], v[84:87], v[60:63], v[220:223]
    ds_read_b64_tr_b16 v[76:77], v13 offset:10368
    ds_read_b64_tr_b16 v[78:79], v13 offset:12928
    v_mfma_f32_16x16x32_bf16 v[224:227], v[64:67], v[48:51], v[224:227]
    ds_read_b64_tr_b16 v[80:81], v13 offset:32
    ds_read_b64_tr_b16 v[82:83], v13 offset:2592
    v_mfma_f32_16x16x32_bf16 v[228:231], v[64:67], v[52:55], v[228:231]
    ds_read_b64_tr_b16 v[84:85], v13 offset:10400
    ds_read_b64_tr_b16 v[86:87], v13 offset:12960
    v_mfma_f32_16x16x32_bf16 v[232:235], v[64:67], v[56:59], v[232:235]
    v_mfma_f32_16x16x32_bf16 v[236:239], v[64:67], v[60:63], v[236:239]
    v_mfma_f32_16x16x32_bf16 v[240:243], v[68:71], v[48:51], v[240:243]
    ds_read_b64_tr_b16 v[64:65], v13 offset:64
    ds_read_b64_tr_b16 v[66:67], v13 offset:2624
    v_mfma_f32_16x16x32_bf16 v[244:247], v[68:71], v[52:55], v[244:247]
    v_mfma_f32_16x16x32_bf16 v[248:251], v[68:71], v[56:59], v[248:251]
    v_mfma_f32_16x16x32_bf16 v[252:255], v[68:71], v[60:63], v[252:255]
    s_waitcnt lgkmcnt(8)
    v_mfma_f32_16x16x32_bf16 v[96:99], v[72:75], v[32:35], v[96:99]
    ds_read_b64_tr_b16 v[68:69], v13 offset:10432
    ds_read_b64_tr_b16 v[70:71], v13 offset:12992
    v_mfma_f32_16x16x32_bf16 v[100:103], v[72:75], v[36:39], v[100:103]
    ds_read_b128 v[48:51], v9 offset:53376
    ds_read_b128 v[52:55], v9 offset:55424
    v_mfma_f32_16x16x32_bf16 v[104:107], v[72:75], v[40:43], v[104:107]
    ds_read_b128 v[56:59], v9 offset:57472
    ds_read_b128 v[60:63], v9 offset:59520
    v_mfma_f32_16x16x32_bf16 v[108:111], v[72:75], v[44:47], v[108:111]
    s_waitcnt lgkmcnt(12)
    v_mfma_f32_16x16x32_bf16 v[112:115], v[76:79], v[32:35], v[112:115]
    ds_read_b64_tr_b16 v[72:73], v13 offset:96
    ds_read_b64_tr_b16 v[74:75], v13 offset:2656
    v_mfma_f32_16x16x32_bf16 v[116:119], v[76:79], v[36:39], v[116:119]
    v_mfma_f32_16x16x32_bf16 v[120:123], v[76:79], v[40:43], v[120:123]
    v_mfma_f32_16x16x32_bf16 v[124:127], v[76:79], v[44:47], v[124:127]
    s_waitcnt lgkmcnt(12)
    v_mfma_f32_16x16x32_bf16 v[128:131], v[80:83], v[32:35], v[128:131]
    ds_read_b64_tr_b16 v[76:77], v13 offset:10464
    ds_read_b64_tr_b16 v[78:79], v13 offset:13024
    v_mfma_f32_16x16x32_bf16 v[132:135], v[80:83], v[36:39], v[132:135]
    v_mfma_f32_16x16x32_bf16 v[136:139], v[80:83], v[40:43], v[136:139]
    v_mfma_f32_16x16x32_bf16 v[140:143], v[80:83], v[44:47], v[140:143]
    s_waitcnt lgkmcnt(12)
    v_mfma_f32_16x16x32_bf16 v[144:147], v[84:87], v[32:35], v[144:147]
    ds_read_b64_tr_b16 v[80:81], v13 offset:128
    ds_read_b64_tr_b16 v[82:83], v13 offset:2688
    v_mfma_f32_16x16x32_bf16 v[148:151], v[84:87], v[36:39], v[148:151]
    v_mfma_f32_16x16x32_bf16 v[152:155], v[84:87], v[40:43], v[152:155]
    v_mfma_f32_16x16x32_bf16 v[156:159], v[84:87], v[44:47], v[156:159]
    s_waitcnt lgkmcnt(12)
    v_mfma_f32_16x16x32_bf16 v[160:163], v[64:67], v[32:35], v[160:163]
    ds_read_b64_tr_b16 v[84:85], v13 offset:10496
    ds_read_b64_tr_b16 v[86:87], v13 offset:13056
    v_mfma_f32_16x16x32_bf16 v[164:167], v[64:67], v[36:39], v[164:167]
    v_mfma_f32_16x16x32_bf16 v[168:171], v[64:67], v[40:43], v[168:171]
    v_mfma_f32_16x16x32_bf16 v[172:175], v[64:67], v[44:47], v[172:175]
    s_waitcnt lgkmcnt(12)
    v_mfma_f32_16x16x32_bf16 v[176:179], v[68:71], v[32:35], v[176:179]
    ds_read_b64_tr_b16 v[64:65], v13 offset:5120
    ds_read_b64_tr_b16 v[66:67], v13 offset:7680
    v_mfma_f32_16x16x32_bf16 v[180:183], v[68:71], v[36:39], v[180:183]
    v_mfma_f32_16x16x32_bf16 v[184:187], v[68:71], v[40:43], v[184:187]
    v_mfma_f32_16x16x32_bf16 v[188:191], v[68:71], v[44:47], v[188:191]
    s_waitcnt lgkmcnt(8)
    v_mfma_f32_16x16x32_bf16 v[192:195], v[72:75], v[32:35], v[192:195]
    ds_read_b64_tr_b16 v[68:69], v13 offset:15488
    ds_read_b64_tr_b16 v[70:71], v13 offset:18048
    v_mfma_f32_16x16x32_bf16 v[196:199], v[72:75], v[36:39], v[196:199]
    v_mfma_f32_16x16x32_bf16 v[200:203], v[72:75], v[40:43], v[200:203]
    v_mfma_f32_16x16x32_bf16 v[204:207], v[72:75], v[44:47], v[204:207]
    s_waitcnt lgkmcnt(8)
    v_mfma_f32_16x16x32_bf16 v[208:211], v[76:79], v[32:35], v[208:211]
    ds_read_b64_tr_b16 v[72:73], v13 offset:5152
    ds_read_b64_tr_b16 v[74:75], v13 offset:7712
    v_mfma_f32_16x16x32_bf16 v[212:215], v[76:79], v[36:39], v[212:215]
    v_mfma_f32_16x16x32_bf16 v[216:219], v[76:79], v[40:43], v[216:219]
    v_mfma_f32_16x16x32_bf16 v[220:223], v[76:79], v[44:47], v[220:223]
    s_waitcnt lgkmcnt(8)
    v_mfma_f32_16x16x32_bf16 v[224:227], v[80:83], v[32:35], v[224:227]
    ds_read_b64_tr_b16 v[76:77], v13 offset:15520
    ds_read_b64_tr_b16 v[78:79], v13 offset:18080
    v_mfma_f32_16x16x32_bf16 v[228:231], v[80:83], v[36:39], v[228:231]
    v_mfma_f32_16x16x32_bf16 v[232:235], v[80:83], v[40:43], v[232:235]
    v_mfma_f32_16x16x32_bf16 v[236:239], v[80:83], v[44:47], v[236:239]
    s_waitcnt lgkmcnt(8)
    v_mfma_f32_16x16x32_bf16 v[240:243], v[84:87], v[32:35], v[240:243]
    ds_read_b64_tr_b16 v[80:81], v13 offset:5184
    ds_read_b64_tr_b16 v[82:83], v13 offset:7744
    v_mfma_f32_16x16x32_bf16 v[244:247], v[84:87], v[36:39], v[244:247]
    v_mfma_f32_16x16x32_bf16 v[248:251], v[84:87], v[40:43], v[248:251]
    v_mfma_f32_16x16x32_bf16 v[252:255], v[84:87], v[44:47], v[252:255]
    s_waitcnt lgkmcnt(8)
    v_mfma_f32_16x16x32_bf16 v[96:99], v[64:67], v[48:51], v[96:99]
    ds_read_b64_tr_b16 v[84:85], v13 offset:15552
    ds_read_b64_tr_b16 v[86:87], v13 offset:18112
    v_mfma_f32_16x16x32_bf16 v[100:103], v[64:67], v[52:55], v[100:103]
    v_mfma_f32_16x16x32_bf16 v[104:107], v[64:67], v[56:59], v[104:107]
    v_mfma_f32_16x16x32_bf16 v[108:111], v[64:67], v[60:63], v[108:111]
    s_waitcnt lgkmcnt(8)
    v_mfma_f32_16x16x32_bf16 v[112:115], v[68:71], v[48:51], v[112:115]
    ds_read_b64_tr_b16 v[64:65], v13 offset:5216
    ds_read_b64_tr_b16 v[66:67], v13 offset:7776
    v_mfma_f32_16x16x32_bf16 v[116:119], v[68:71], v[52:55], v[116:119]
    v_mfma_f32_16x16x32_bf16 v[120:123], v[68:71], v[56:59], v[120:123]
    v_mfma_f32_16x16x32_bf16 v[124:127], v[68:71], v[60:63], v[124:127]
    s_waitcnt lgkmcnt(8)
    v_mfma_f32_16x16x32_bf16 v[128:131], v[72:75], v[48:51], v[128:131]
    ds_read_b64_tr_b16 v[68:69], v13 offset:15584
    ds_read_b64_tr_b16 v[70:71], v13 offset:18144
    v_mfma_f32_16x16x32_bf16 v[132:135], v[72:75], v[52:55], v[132:135]
    v_mfma_f32_16x16x32_bf16 v[136:139], v[72:75], v[56:59], v[136:139]
    v_mfma_f32_16x16x32_bf16 v[140:143], v[72:75], v[60:63], v[140:143]
    s_waitcnt lgkmcnt(8)
    v_mfma_f32_16x16x32_bf16 v[144:147], v[76:79], v[48:51], v[144:147]
    ds_read_b64_tr_b16 v[72:73], v13 offset:5248
    ds_read_b64_tr_b16 v[74:75], v13 offset:7808
    v_mfma_f32_16x16x32_bf16 v[148:151], v[76:79], v[52:55], v[148:151]
    v_mfma_f32_16x16x32_bf16 v[152:155], v[76:79], v[56:59], v[152:155]
    v_mfma_f32_16x16x32_bf16 v[156:159], v[76:79], v[60:63], v[156:159]
    s_waitcnt lgkmcnt(8)
    v_mfma_f32_16x16x32_bf16 v[160:163], v[80:83], v[48:51], v[160:163]
    ds_read_b64_tr_b16 v[76:77], v13 offset:15616
    ds_read_b64_tr_b16 v[78:79], v13 offset:18176
    v_mfma_f32_16x16x32_bf16 v[164:167], v[80:83], v[52:55], v[164:167]
    v_mfma_f32_16x16x32_bf16 v[168:171], v[80:83], v[56:59], v[168:171]
    v_mfma_f32_16x16x32_bf16 v[172:175], v[80:83], v[60:63], v[172:175]
    s_waitcnt lgkmcnt(8)
    v_mfma_f32_16x16x32_bf16 v[176:179], v[84:87], v[48:51], v[176:179]
    v_mfma_f32_16x16x32_bf16 v[180:183], v[84:87], v[52:55], v[180:183]
    v_mfma_f32_16x16x32_bf16 v[184:187], v[84:87], v[56:59], v[184:187]
    v_mfma_f32_16x16x32_bf16 v[188:191], v[84:87], v[60:63], v[188:191]
    s_waitcnt lgkmcnt(6)
    v_mfma_f32_16x16x32_bf16 v[192:195], v[64:67], v[48:51], v[192:195]
    v_mfma_f32_16x16x32_bf16 v[196:199], v[64:67], v[52:55], v[196:199]
    v_mfma_f32_16x16x32_bf16 v[200:203], v[64:67], v[56:59], v[200:203]
    v_mfma_f32_16x16x32_bf16 v[204:207], v[64:67], v[60:63], v[204:207]
    s_waitcnt lgkmcnt(0)
    s_barrier
    v_mfma_f32_16x16x32_bf16 v[208:211], v[68:71], v[48:51], v[208:211]
    ds_read_b128 v[32:35], v10 offset:0
    ds_read_b128 v[36:39], v10 offset:2048
    v_mfma_f32_16x16x32_bf16 v[212:215], v[68:71], v[52:55], v[212:215]
    ds_read_b128 v[40:43], v10 offset:4096
    ds_read_b128 v[44:47], v10 offset:6144
    v_mfma_f32_16x16x32_bf16 v[216:219], v[68:71], v[56:59], v[216:219]
    ds_read_b64_tr_b16 v[80:81], v14 offset:0
    ds_read_b64_tr_b16 v[82:83], v14 offset:2560
    v_mfma_f32_16x16x32_bf16 v[220:223], v[68:71], v[60:63], v[220:223]
    ds_read_b64_tr_b16 v[84:85], v14 offset:10368
    ds_read_b64_tr_b16 v[86:87], v14 offset:12928
    v_mfma_f32_16x16x32_bf16 v[224:227], v[72:75], v[48:51], v[224:227]
    ds_read_b64_tr_b16 v[64:65], v14 offset:32
    ds_read_b64_tr_b16 v[66:67], v14 offset:2592
    v_mfma_f32_16x16x32_bf16 v[228:231], v[72:75], v[52:55], v[228:231]
    ds_read_b64_tr_b16 v[68:69], v14 offset:10400
    ds_read_b64_tr_b16 v[70:71], v14 offset:12960
    v_mfma_f32_16x16x32_bf16 v[232:235], v[72:75], v[56:59], v[232:235]
    v_mfma_f32_16x16x32_bf16 v[236:239], v[72:75], v[60:63], v[236:239]
    v_mfma_f32_16x16x32_bf16 v[240:243], v[76:79], v[48:51], v[240:243]
    ds_read_b64_tr_b16 v[72:73], v14 offset:64
    ds_read_b64_tr_b16 v[74:75], v14 offset:2624
    v_mfma_f32_16x16x32_bf16 v[244:247], v[76:79], v[52:55], v[244:247]
    v_mfma_f32_16x16x32_bf16 v[248:251], v[76:79], v[56:59], v[248:251]
    v_mfma_f32_16x16x32_bf16 v[252:255], v[76:79], v[60:63], v[252:255]
    s_waitcnt lgkmcnt(8)
    v_mfma_f32_16x16x32_bf16 v[96:99], v[80:83], v[32:35], v[96:99]
    ds_read_b64_tr_b16 v[76:77], v14 offset:10432
    ds_read_b64_tr_b16 v[78:79], v14 offset:12992
    v_mfma_f32_16x16x32_bf16 v[100:103], v[80:83], v[36:39], v[100:103]
    ds_read_b128 v[48:51], v11 offset:0
    ds_read_b128 v[52:55], v11 offset:2048
    v_mfma_f32_16x16x32_bf16 v[104:107], v[80:83], v[40:43], v[104:107]
    ds_read_b128 v[56:59], v11 offset:4096
    ds_read_b128 v[60:63], v11 offset:6144
    v_mfma_f32_16x16x32_bf16 v[108:111], v[80:83], v[44:47], v[108:111]
    s_waitcnt lgkmcnt(12)
    v_mfma_f32_16x16x32_bf16 v[112:115], v[84:87], v[32:35], v[112:115]
    ds_read_b64_tr_b16 v[80:81], v14 offset:96
    ds_read_b64_tr_b16 v[82:83], v14 offset:2656
    v_mfma_f32_16x16x32_bf16 v[116:119], v[84:87], v[36:39], v[116:119]
    v_mfma_f32_16x16x32_bf16 v[120:123], v[84:87], v[40:43], v[120:123]
    v_mfma_f32_16x16x32_bf16 v[124:127], v[84:87], v[44:47], v[124:127]
    s_waitcnt lgkmcnt(12)
    v_mfma_f32_16x16x32_bf16 v[128:131], v[64:67], v[32:35], v[128:131]
    ds_read_b64_tr_b16 v[84:85], v14 offset:10464
    ds_read_b64_tr_b16 v[86:87], v14 offset:13024
    v_mfma_f32_16x16x32_bf16 v[132:135], v[64:67], v[36:39], v[132:135]
    v_mfma_f32_16x16x32_bf16 v[136:139], v[64:67], v[40:43], v[136:139]
    v_mfma_f32_16x16x32_bf16 v[140:143], v[64:67], v[44:47], v[140:143]
    s_waitcnt lgkmcnt(12)
    v_mfma_f32_16x16x32_bf16 v[144:147], v[68:71], v[32:35], v[144:147]
    ds_read_b64_tr_b16 v[64:65], v14 offset:128
    ds_read_b64_tr_b16 v[66:67], v14 offset:2688
    v_mfma_f32_16x16x32_bf16 v[148:151], v[68:71], v[36:39], v[148:151]
    v_mfma_f32_16x16x32_bf16 v[152:155], v[68:71], v[40:43], v[152:155]
    v_mfma_f32_16x16x32_bf16 v[156:159], v[68:71], v[44:47], v[156:159]
    s_waitcnt lgkmcnt(12)
    v_mfma_f32_16x16x32_bf16 v[160:163], v[72:75], v[32:35], v[160:163]
    ds_read_b64_tr_b16 v[68:69], v14 offset:10496
    ds_read_b64_tr_b16 v[70:71], v14 offset:13056
    v_mfma_f32_16x16x32_bf16 v[164:167], v[72:75], v[36:39], v[164:167]
    v_mfma_f32_16x16x32_bf16 v[168:171], v[72:75], v[40:43], v[168:171]
    v_mfma_f32_16x16x32_bf16 v[172:175], v[72:75], v[44:47], v[172:175]
    s_waitcnt lgkmcnt(12)
    v_mfma_f32_16x16x32_bf16 v[176:179], v[76:79], v[32:35], v[176:179]
    ds_read_b64_tr_b16 v[72:73], v14 offset:5120
    ds_read_b64_tr_b16 v[74:75], v14 offset:7680
    v_mfma_f32_16x16x32_bf16 v[180:183], v[76:79], v[36:39], v[180:183]
    v_mfma_f32_16x16x32_bf16 v[184:187], v[76:79], v[40:43], v[184:187]
    v_mfma_f32_16x16x32_bf16 v[188:191], v[76:79], v[44:47], v[188:191]
    s_waitcnt lgkmcnt(8)
    v_mfma_f32_16x16x32_bf16 v[192:195], v[80:83], v[32:35], v[192:195]
    ds_read_b64_tr_b16 v[76:77], v14 offset:15488
    ds_read_b64_tr_b16 v[78:79], v14 offset:18048
    v_mfma_f32_16x16x32_bf16 v[196:199], v[80:83], v[36:39], v[196:199]
    v_mfma_f32_16x16x32_bf16 v[200:203], v[80:83], v[40:43], v[200:203]
    v_mfma_f32_16x16x32_bf16 v[204:207], v[80:83], v[44:47], v[204:207]
    s_waitcnt lgkmcnt(8)
    v_mfma_f32_16x16x32_bf16 v[208:211], v[84:87], v[32:35], v[208:211]
    ds_read_b64_tr_b16 v[80:81], v14 offset:5152
    ds_read_b64_tr_b16 v[82:83], v14 offset:7712
    v_mfma_f32_16x16x32_bf16 v[212:215], v[84:87], v[36:39], v[212:215]
    v_mfma_f32_16x16x32_bf16 v[216:219], v[84:87], v[40:43], v[216:219]
    v_mfma_f32_16x16x32_bf16 v[220:223], v[84:87], v[44:47], v[220:223]
    s_waitcnt lgkmcnt(8)
    v_mfma_f32_16x16x32_bf16 v[224:227], v[64:67], v[32:35], v[224:227]
    ds_read_b64_tr_b16 v[84:85], v14 offset:15520
    ds_read_b64_tr_b16 v[86:87], v14 offset:18080
    v_mfma_f32_16x16x32_bf16 v[228:231], v[64:67], v[36:39], v[228:231]
    v_mfma_f32_16x16x32_bf16 v[232:235], v[64:67], v[40:43], v[232:235]
    v_mfma_f32_16x16x32_bf16 v[236:239], v[64:67], v[44:47], v[236:239]
    s_waitcnt lgkmcnt(8)
    v_mfma_f32_16x16x32_bf16 v[240:243], v[68:71], v[32:35], v[240:243]
    ds_read_b64_tr_b16 v[64:65], v14 offset:5184
    ds_read_b64_tr_b16 v[66:67], v14 offset:7744
    v_mfma_f32_16x16x32_bf16 v[244:247], v[68:71], v[36:39], v[244:247]
    v_mfma_f32_16x16x32_bf16 v[248:251], v[68:71], v[40:43], v[248:251]
    v_mfma_f32_16x16x32_bf16 v[252:255], v[68:71], v[44:47], v[252:255]
    s_waitcnt lgkmcnt(8)
    v_mfma_f32_16x16x32_bf16 v[96:99], v[72:75], v[48:51], v[96:99]
    ds_read_b64_tr_b16 v[68:69], v14 offset:15552
    ds_read_b64_tr_b16 v[70:71], v14 offset:18112
    v_mfma_f32_16x16x32_bf16 v[100:103], v[72:75], v[52:55], v[100:103]
    v_mfma_f32_16x16x32_bf16 v[104:107], v[72:75], v[56:59], v[104:107]
    v_mfma_f32_16x16x32_bf16 v[108:111], v[72:75], v[60:63], v[108:111]
    s_waitcnt lgkmcnt(8)
    v_mfma_f32_16x16x32_bf16 v[112:115], v[76:79], v[48:51], v[112:115]
    ds_read_b64_tr_b16 v[72:73], v14 offset:5216
    ds_read_b64_tr_b16 v[74:75], v14 offset:7776
    v_mfma_f32_16x16x32_bf16 v[116:119], v[76:79], v[52:55], v[116:119]
    v_mfma_f32_16x16x32_bf16 v[120:123], v[76:79], v[56:59], v[120:123]
    v_mfma_f32_16x16x32_bf16 v[124:127], v[76:79], v[60:63], v[124:127]
    s_waitcnt lgkmcnt(8)
    v_mfma_f32_16x16x32_bf16 v[128:131], v[80:83], v[48:51], v[128:131]
    ds_read_b64_tr_b16 v[76:77], v14 offset:15584
    ds_read_b64_tr_b16 v[78:79], v14 offset:18144
    v_mfma_f32_16x16x32_bf16 v[132:135], v[80:83], v[52:55], v[132:135]
    v_mfma_f32_16x16x32_bf16 v[136:139], v[80:83], v[56:59], v[136:139]
    v_mfma_f32_16x16x32_bf16 v[140:143], v[80:83], v[60:63], v[140:143]
    s_waitcnt lgkmcnt(8)
    v_mfma_f32_16x16x32_bf16 v[144:147], v[84:87], v[48:51], v[144:147]
    ds_read_b64_tr_b16 v[80:81], v14 offset:5248
    ds_read_b64_tr_b16 v[82:83], v14 offset:7808
    v_mfma_f32_16x16x32_bf16 v[148:151], v[84:87], v[52:55], v[148:151]
    v_mfma_f32_16x16x32_bf16 v[152:155], v[84:87], v[56:59], v[152:155]
    v_mfma_f32_16x16x32_bf16 v[156:159], v[84:87], v[60:63], v[156:159]
    s_waitcnt lgkmcnt(8)
    v_mfma_f32_16x16x32_bf16 v[160:163], v[64:67], v[48:51], v[160:163]
    ds_read_b64_tr_b16 v[84:85], v14 offset:15616
    ds_read_b64_tr_b16 v[86:87], v14 offset:18176
    v_mfma_f32_16x16x32_bf16 v[164:167], v[64:67], v[52:55], v[164:167]
    v_mfma_f32_16x16x32_bf16 v[168:171], v[64:67], v[56:59], v[168:171]
    v_mfma_f32_16x16x32_bf16 v[172:175], v[64:67], v[60:63], v[172:175]
    s_waitcnt lgkmcnt(8)
    v_mfma_f32_16x16x32_bf16 v[176:179], v[68:71], v[48:51], v[176:179]
    v_mfma_f32_16x16x32_bf16 v[180:183], v[68:71], v[52:55], v[180:183]
    v_mfma_f32_16x16x32_bf16 v[184:187], v[68:71], v[56:59], v[184:187]
    v_mfma_f32_16x16x32_bf16 v[188:191], v[68:71], v[60:63], v[188:191]
    s_waitcnt lgkmcnt(6)
    v_mfma_f32_16x16x32_bf16 v[192:195], v[72:75], v[48:51], v[192:195]
    v_mfma_f32_16x16x32_bf16 v[196:199], v[72:75], v[52:55], v[196:199]
    v_mfma_f32_16x16x32_bf16 v[200:203], v[72:75], v[56:59], v[200:203]
    v_mfma_f32_16x16x32_bf16 v[204:207], v[72:75], v[60:63], v[204:207]
    s_waitcnt lgkmcnt(0)
    s_barrier
    v_mfma_f32_16x16x32_bf16 v[208:211], v[76:79], v[48:51], v[208:211]
    ds_read_b128 v[32:35], v8 offset:0
    ds_read_b128 v[36:39], v8 offset:2048
    v_mfma_f32_16x16x32_bf16 v[212:215], v[76:79], v[52:55], v[212:215]
    ds_read_b128 v[40:43], v8 offset:4096
    ds_read_b128 v[44:47], v8 offset:6144
    v_mfma_f32_16x16x32_bf16 v[216:219], v[76:79], v[56:59], v[216:219]
    ds_read_b64_tr_b16 v[64:65], v12 offset:0
    ds_read_b64_tr_b16 v[66:67], v12 offset:2560
    v_mfma_f32_16x16x32_bf16 v[220:223], v[76:79], v[60:63], v[220:223]
    ds_read_b64_tr_b16 v[68:69], v12 offset:10368
    ds_read_b64_tr_b16 v[70:71], v12 offset:12928
    v_mfma_f32_16x16x32_bf16 v[224:227], v[80:83], v[48:51], v[224:227]
    ds_read_b64_tr_b16 v[72:73], v12 offset:32
    ds_read_b64_tr_b16 v[74:75], v12 offset:2592
    v_mfma_f32_16x16x32_bf16 v[228:231], v[80:83], v[52:55], v[228:231]
    ds_read_b64_tr_b16 v[76:77], v12 offset:10400
    ds_read_b64_tr_b16 v[78:79], v12 offset:12960
    v_mfma_f32_16x16x32_bf16 v[232:235], v[80:83], v[56:59], v[232:235]
    v_mfma_f32_16x16x32_bf16 v[236:239], v[80:83], v[60:63], v[236:239]
    v_mfma_f32_16x16x32_bf16 v[240:243], v[84:87], v[48:51], v[240:243]
    ds_read_b64_tr_b16 v[80:81], v12 offset:64
    ds_read_b64_tr_b16 v[82:83], v12 offset:2624
    v_mfma_f32_16x16x32_bf16 v[244:247], v[84:87], v[52:55], v[244:247]
    v_mfma_f32_16x16x32_bf16 v[248:251], v[84:87], v[56:59], v[248:251]
    v_mfma_f32_16x16x32_bf16 v[252:255], v[84:87], v[60:63], v[252:255]
    s_waitcnt lgkmcnt(8)
    v_mfma_f32_16x16x32_bf16 v[96:99], v[64:67], v[32:35], v[96:99]
    ds_read_b64_tr_b16 v[84:85], v12 offset:10432
    ds_read_b64_tr_b16 v[86:87], v12 offset:12992
    v_mfma_f32_16x16x32_bf16 v[100:103], v[64:67], v[36:39], v[100:103]
    ds_read_b128 v[48:51], v9 offset:0
    ds_read_b128 v[52:55], v9 offset:2048
    v_mfma_f32_16x16x32_bf16 v[104:107], v[64:67], v[40:43], v[104:107]
    ds_read_b128 v[56:59], v9 offset:4096
    ds_read_b128 v[60:63], v9 offset:6144
    v_mfma_f32_16x16x32_bf16 v[108:111], v[64:67], v[44:47], v[108:111]
    s_waitcnt lgkmcnt(12)
    v_mfma_f32_16x16x32_bf16 v[112:115], v[68:71], v[32:35], v[112:115]
    ds_read_b64_tr_b16 v[64:65], v12 offset:96
    ds_read_b64_tr_b16 v[66:67], v12 offset:2656
    v_mfma_f32_16x16x32_bf16 v[116:119], v[68:71], v[36:39], v[116:119]
    v_mfma_f32_16x16x32_bf16 v[120:123], v[68:71], v[40:43], v[120:123]
    v_mfma_f32_16x16x32_bf16 v[124:127], v[68:71], v[44:47], v[124:127]
    s_waitcnt lgkmcnt(12)
    v_mfma_f32_16x16x32_bf16 v[128:131], v[72:75], v[32:35], v[128:131]
    ds_read_b64_tr_b16 v[68:69], v12 offset:10464
    ds_read_b64_tr_b16 v[70:71], v12 offset:13024
    v_mfma_f32_16x16x32_bf16 v[132:135], v[72:75], v[36:39], v[132:135]
    v_mfma_f32_16x16x32_bf16 v[136:139], v[72:75], v[40:43], v[136:139]
    v_mfma_f32_16x16x32_bf16 v[140:143], v[72:75], v[44:47], v[140:143]
    s_waitcnt lgkmcnt(12)
    v_mfma_f32_16x16x32_bf16 v[144:147], v[76:79], v[32:35], v[144:147]
    ds_read_b64_tr_b16 v[72:73], v12 offset:128
    ds_read_b64_tr_b16 v[74:75], v12 offset:2688
    v_mfma_f32_16x16x32_bf16 v[148:151], v[76:79], v[36:39], v[148:151]
    v_mfma_f32_16x16x32_bf16 v[152:155], v[76:79], v[40:43], v[152:155]
    v_mfma_f32_16x16x32_bf16 v[156:159], v[76:79], v[44:47], v[156:159]
    s_waitcnt lgkmcnt(12)
    v_mfma_f32_16x16x32_bf16 v[160:163], v[80:83], v[32:35], v[160:163]
    ds_read_b64_tr_b16 v[76:77], v12 offset:10496
    ds_read_b64_tr_b16 v[78:79], v12 offset:13056
    v_mfma_f32_16x16x32_bf16 v[164:167], v[80:83], v[36:39], v[164:167]
    v_mfma_f32_16x16x32_bf16 v[168:171], v[80:83], v[40:43], v[168:171]
    v_mfma_f32_16x16x32_bf16 v[172:175], v[80:83], v[44:47], v[172:175]
    s_waitcnt lgkmcnt(12)
    v_mfma_f32_16x16x32_bf16 v[176:179], v[84:87], v[32:35], v[176:179]
    ds_read_b64_tr_b16 v[80:81], v12 offset:5120
    ds_read_b64_tr_b16 v[82:83], v12 offset:7680
    v_mfma_f32_16x16x32_bf16 v[180:183], v[84:87], v[36:39], v[180:183]
    v_mfma_f32_16x16x32_bf16 v[184:187], v[84:87], v[40:43], v[184:187]
    v_mfma_f32_16x16x32_bf16 v[188:191], v[84:87], v[44:47], v[188:191]
    s_waitcnt lgkmcnt(8)
    v_mfma_f32_16x16x32_bf16 v[192:195], v[64:67], v[32:35], v[192:195]
    ds_read_b64_tr_b16 v[84:85], v12 offset:15488
    ds_read_b64_tr_b16 v[86:87], v12 offset:18048
    v_mfma_f32_16x16x32_bf16 v[196:199], v[64:67], v[36:39], v[196:199]
    v_mfma_f32_16x16x32_bf16 v[200:203], v[64:67], v[40:43], v[200:203]
    v_mfma_f32_16x16x32_bf16 v[204:207], v[64:67], v[44:47], v[204:207]
    s_waitcnt lgkmcnt(8)
    v_mfma_f32_16x16x32_bf16 v[208:211], v[68:71], v[32:35], v[208:211]
    ds_read_b64_tr_b16 v[64:65], v12 offset:5152
    ds_read_b64_tr_b16 v[66:67], v12 offset:7712
    v_mfma_f32_16x16x32_bf16 v[212:215], v[68:71], v[36:39], v[212:215]
    v_mfma_f32_16x16x32_bf16 v[216:219], v[68:71], v[40:43], v[216:219]
    v_mfma_f32_16x16x32_bf16 v[220:223], v[68:71], v[44:47], v[220:223]
    s_waitcnt lgkmcnt(8)
    v_mfma_f32_16x16x32_bf16 v[224:227], v[72:75], v[32:35], v[224:227]
    ds_read_b64_tr_b16 v[68:69], v12 offset:15520
    ds_read_b64_tr_b16 v[70:71], v12 offset:18080
    v_mfma_f32_16x16x32_bf16 v[228:231], v[72:75], v[36:39], v[228:231]
    v_mfma_f32_16x16x32_bf16 v[232:235], v[72:75], v[40:43], v[232:235]
    v_mfma_f32_16x16x32_bf16 v[236:239], v[72:75], v[44:47], v[236:239]
    s_waitcnt lgkmcnt(8)
    v_mfma_f32_16x16x32_bf16 v[240:243], v[76:79], v[32:35], v[240:243]
    ds_read_b64_tr_b16 v[72:73], v12 offset:5184
    ds_read_b64_tr_b16 v[74:75], v12 offset:7744
    v_mfma_f32_16x16x32_bf16 v[244:247], v[76:79], v[36:39], v[244:247]
    v_mfma_f32_16x16x32_bf16 v[248:251], v[76:79], v[40:43], v[248:251]
    v_mfma_f32_16x16x32_bf16 v[252:255], v[76:79], v[44:47], v[252:255]
    s_waitcnt lgkmcnt(8)
    v_mfma_f32_16x16x32_bf16 v[96:99], v[80:83], v[48:51], v[96:99]
    ds_read_b64_tr_b16 v[76:77], v12 offset:15552
    ds_read_b64_tr_b16 v[78:79], v12 offset:18112
    v_mfma_f32_16x16x32_bf16 v[100:103], v[80:83], v[52:55], v[100:103]
    v_mfma_f32_16x16x32_bf16 v[104:107], v[80:83], v[56:59], v[104:107]
    v_mfma_f32_16x16x32_bf16 v[108:111], v[80:83], v[60:63], v[108:111]
    s_waitcnt lgkmcnt(8)
    v_mfma_f32_16x16x32_bf16 v[112:115], v[84:87], v[48:51], v[112:115]
    ds_read_b64_tr_b16 v[80:81], v12 offset:5216
    ds_read_b64_tr_b16 v[82:83], v12 offset:7776
    v_mfma_f32_16x16x32_bf16 v[116:119], v[84:87], v[52:55], v[116:119]
    v_mfma_f32_16x16x32_bf16 v[120:123], v[84:87], v[56:59], v[120:123]
    v_mfma_f32_16x16x32_bf16 v[124:127], v[84:87], v[60:63], v[124:127]
    s_waitcnt lgkmcnt(8)
    v_mfma_f32_16x16x32_bf16 v[128:131], v[64:67], v[48:51], v[128:131]
    ds_read_b64_tr_b16 v[84:85], v12 offset:15584
    ds_read_b64_tr_b16 v[86:87], v12 offset:18144
    v_mfma_f32_16x16x32_bf16 v[132:135], v[64:67], v[52:55], v[132:135]
    v_mfma_f32_16x16x32_bf16 v[136:139], v[64:67], v[56:59], v[136:139]
    v_mfma_f32_16x16x32_bf16 v[140:143], v[64:67], v[60:63], v[140:143]
    s_waitcnt lgkmcnt(8)
    v_mfma_f32_16x16x32_bf16 v[144:147], v[68:71], v[48:51], v[144:147]
    ds_read_b64_tr_b16 v[64:65], v12 offset:5248
    ds_read_b64_tr_b16 v[66:67], v12 offset:7808
    v_mfma_f32_16x16x32_bf16 v[148:151], v[68:71], v[52:55], v[148:151]
    v_mfma_f32_16x16x32_bf16 v[152:155], v[68:71], v[56:59], v[152:155]
    v_mfma_f32_16x16x32_bf16 v[156:159], v[68:71], v[60:63], v[156:159]
    s_waitcnt lgkmcnt(8)
    v_mfma_f32_16x16x32_bf16 v[160:163], v[72:75], v[48:51], v[160:163]
    ds_read_b64_tr_b16 v[68:69], v12 offset:15616
    ds_read_b64_tr_b16 v[70:71], v12 offset:18176
    v_mfma_f32_16x16x32_bf16 v[164:167], v[72:75], v[52:55], v[164:167]
    v_mfma_f32_16x16x32_bf16 v[168:171], v[72:75], v[56:59], v[168:171]
    v_mfma_f32_16x16x32_bf16 v[172:175], v[72:75], v[60:63], v[172:175]
    s_waitcnt lgkmcnt(8)
    v_mfma_f32_16x16x32_bf16 v[176:179], v[76:79], v[48:51], v[176:179]
    v_mfma_f32_16x16x32_bf16 v[180:183], v[76:79], v[52:55], v[180:183]
    v_mfma_f32_16x16x32_bf16 v[184:187], v[76:79], v[56:59], v[184:187]
    v_mfma_f32_16x16x32_bf16 v[188:191], v[76:79], v[60:63], v[188:191]
    s_waitcnt lgkmcnt(6)
    v_mfma_f32_16x16x32_bf16 v[192:195], v[80:83], v[48:51], v[192:195]
    v_mfma_f32_16x16x32_bf16 v[196:199], v[80:83], v[52:55], v[196:199]
    v_mfma_f32_16x16x32_bf16 v[200:203], v[80:83], v[56:59], v[200:203]
    v_mfma_f32_16x16x32_bf16 v[204:207], v[80:83], v[60:63], v[204:207]
    s_waitcnt lgkmcnt(0)
    s_barrier
    v_mfma_f32_16x16x32_bf16 v[208:211], v[84:87], v[48:51], v[208:211]
    ds_read_b128 v[32:35], v8 offset:53376
    ds_read_b128 v[36:39], v8 offset:55424
    v_mfma_f32_16x16x32_bf16 v[212:215], v[84:87], v[52:55], v[212:215]
    ds_read_b128 v[40:43], v8 offset:57472
    ds_read_b128 v[44:47], v8 offset:59520
    v_mfma_f32_16x16x32_bf16 v[216:219], v[84:87], v[56:59], v[216:219]
    ds_read_b64_tr_b16 v[72:73], v13 offset:0
    ds_read_b64_tr_b16 v[74:75], v13 offset:2560
    v_mfma_f32_16x16x32_bf16 v[220:223], v[84:87], v[60:63], v[220:223]
    ds_read_b64_tr_b16 v[76:77], v13 offset:10368
    ds_read_b64_tr_b16 v[78:79], v13 offset:12928
    v_mfma_f32_16x16x32_bf16 v[224:227], v[64:67], v[48:51], v[224:227]
    ds_read_b64_tr_b16 v[80:81], v13 offset:32
    ds_read_b64_tr_b16 v[82:83], v13 offset:2592
    v_mfma_f32_16x16x32_bf16 v[228:231], v[64:67], v[52:55], v[228:231]
    ds_read_b64_tr_b16 v[84:85], v13 offset:10400
    ds_read_b64_tr_b16 v[86:87], v13 offset:12960
    v_mfma_f32_16x16x32_bf16 v[232:235], v[64:67], v[56:59], v[232:235]
    v_mfma_f32_16x16x32_bf16 v[236:239], v[64:67], v[60:63], v[236:239]
    v_mfma_f32_16x16x32_bf16 v[240:243], v[68:71], v[48:51], v[240:243]
    ds_read_b64_tr_b16 v[64:65], v13 offset:64
    ds_read_b64_tr_b16 v[66:67], v13 offset:2624
    v_mfma_f32_16x16x32_bf16 v[244:247], v[68:71], v[52:55], v[244:247]
    v_mfma_f32_16x16x32_bf16 v[248:251], v[68:71], v[56:59], v[248:251]
    v_mfma_f32_16x16x32_bf16 v[252:255], v[68:71], v[60:63], v[252:255]
    s_waitcnt lgkmcnt(8)
    v_mfma_f32_16x16x32_bf16 v[96:99], v[72:75], v[32:35], v[96:99]
    ds_read_b64_tr_b16 v[68:69], v13 offset:10432
    ds_read_b64_tr_b16 v[70:71], v13 offset:12992
    v_mfma_f32_16x16x32_bf16 v[100:103], v[72:75], v[36:39], v[100:103]
    ds_read_b128 v[48:51], v9 offset:53376
    ds_read_b128 v[52:55], v9 offset:55424
    v_mfma_f32_16x16x32_bf16 v[104:107], v[72:75], v[40:43], v[104:107]
    ds_read_b128 v[56:59], v9 offset:57472
    ds_read_b128 v[60:63], v9 offset:59520
    v_mfma_f32_16x16x32_bf16 v[108:111], v[72:75], v[44:47], v[108:111]
    s_waitcnt lgkmcnt(12)
    v_mfma_f32_16x16x32_bf16 v[112:115], v[76:79], v[32:35], v[112:115]
    ds_read_b64_tr_b16 v[72:73], v13 offset:96
    ds_read_b64_tr_b16 v[74:75], v13 offset:2656
    v_mfma_f32_16x16x32_bf16 v[116:119], v[76:79], v[36:39], v[116:119]
    v_mfma_f32_16x16x32_bf16 v[120:123], v[76:79], v[40:43], v[120:123]
    v_mfma_f32_16x16x32_bf16 v[124:127], v[76:79], v[44:47], v[124:127]
    s_waitcnt lgkmcnt(12)
    v_mfma_f32_16x16x32_bf16 v[128:131], v[80:83], v[32:35], v[128:131]
    ds_read_b64_tr_b16 v[76:77], v13 offset:10464
    ds_read_b64_tr_b16 v[78:79], v13 offset:13024
    v_mfma_f32_16x16x32_bf16 v[132:135], v[80:83], v[36:39], v[132:135]
    v_mfma_f32_16x16x32_bf16 v[136:139], v[80:83], v[40:43], v[136:139]
    v_mfma_f32_16x16x32_bf16 v[140:143], v[80:83], v[44:47], v[140:143]
    s_waitcnt lgkmcnt(12)
    v_mfma_f32_16x16x32_bf16 v[144:147], v[84:87], v[32:35], v[144:147]
    ds_read_b64_tr_b16 v[80:81], v13 offset:128
    ds_read_b64_tr_b16 v[82:83], v13 offset:2688
    v_mfma_f32_16x16x32_bf16 v[148:151], v[84:87], v[36:39], v[148:151]
    v_mfma_f32_16x16x32_bf16 v[152:155], v[84:87], v[40:43], v[152:155]
    v_mfma_f32_16x16x32_bf16 v[156:159], v[84:87], v[44:47], v[156:159]
    s_waitcnt lgkmcnt(12)
    v_mfma_f32_16x16x32_bf16 v[160:163], v[64:67], v[32:35], v[160:163]
    ds_read_b64_tr_b16 v[84:85], v13 offset:10496
    ds_read_b64_tr_b16 v[86:87], v13 offset:13056
    v_mfma_f32_16x16x32_bf16 v[164:167], v[64:67], v[36:39], v[164:167]
    v_mfma_f32_16x16x32_bf16 v[168:171], v[64:67], v[40:43], v[168:171]
    v_mfma_f32_16x16x32_bf16 v[172:175], v[64:67], v[44:47], v[172:175]
    s_waitcnt lgkmcnt(12)
    v_mfma_f32_16x16x32_bf16 v[176:179], v[68:71], v[32:35], v[176:179]
    ds_read_b64_tr_b16 v[64:65], v13 offset:5120
    ds_read_b64_tr_b16 v[66:67], v13 offset:7680
    v_mfma_f32_16x16x32_bf16 v[180:183], v[68:71], v[36:39], v[180:183]
    v_mfma_f32_16x16x32_bf16 v[184:187], v[68:71], v[40:43], v[184:187]
    v_mfma_f32_16x16x32_bf16 v[188:191], v[68:71], v[44:47], v[188:191]
    s_waitcnt lgkmcnt(8)
    v_mfma_f32_16x16x32_bf16 v[192:195], v[72:75], v[32:35], v[192:195]
    ds_read_b64_tr_b16 v[68:69], v13 offset:15488
    ds_read_b64_tr_b16 v[70:71], v13 offset:18048
    v_mfma_f32_16x16x32_bf16 v[196:199], v[72:75], v[36:39], v[196:199]
    v_mfma_f32_16x16x32_bf16 v[200:203], v[72:75], v[40:43], v[200:203]
    v_mfma_f32_16x16x32_bf16 v[204:207], v[72:75], v[44:47], v[204:207]
    s_waitcnt lgkmcnt(8)
    v_mfma_f32_16x16x32_bf16 v[208:211], v[76:79], v[32:35], v[208:211]
    ds_read_b64_tr_b16 v[72:73], v13 offset:5152
    ds_read_b64_tr_b16 v[74:75], v13 offset:7712
    v_mfma_f32_16x16x32_bf16 v[212:215], v[76:79], v[36:39], v[212:215]
    v_mfma_f32_16x16x32_bf16 v[216:219], v[76:79], v[40:43], v[216:219]
    v_mfma_f32_16x16x32_bf16 v[220:223], v[76:79], v[44:47], v[220:223]
    s_waitcnt lgkmcnt(8)
    v_mfma_f32_16x16x32_bf16 v[224:227], v[80:83], v[32:35], v[224:227]
    ds_read_b64_tr_b16 v[76:77], v13 offset:15520
    ds_read_b64_tr_b16 v[78:79], v13 offset:18080
    v_mfma_f32_16x16x32_bf16 v[228:231], v[80:83], v[36:39], v[228:231]
    v_mfma_f32_16x16x32_bf16 v[232:235], v[80:83], v[40:43], v[232:235]
    v_mfma_f32_16x16x32_bf16 v[236:239], v[80:83], v[44:47], v[236:239]
    s_waitcnt lgkmcnt(8)
    v_mfma_f32_16x16x32_bf16 v[240:243], v[84:87], v[32:35], v[240:243]
    ds_read_b64_tr_b16 v[80:81], v13 offset:5184
    ds_read_b64_tr_b16 v[82:83], v13 offset:7744
    v_mfma_f32_16x16x32_bf16 v[244:247], v[84:87], v[36:39], v[244:247]
    v_mfma_f32_16x16x32_bf16 v[248:251], v[84:87], v[40:43], v[248:251]
    v_mfma_f32_16x16x32_bf16 v[252:255], v[84:87], v[44:47], v[252:255]
    s_waitcnt lgkmcnt(8)
    v_mfma_f32_16x16x32_bf16 v[96:99], v[64:67], v[48:51], v[96:99]
    ds_read_b64_tr_b16 v[84:85], v13 offset:15552
    ds_read_b64_tr_b16 v[86:87], v13 offset:18112
    v_mfma_f32_16x16x32_bf16 v[100:103], v[64:67], v[52:55], v[100:103]
    v_mfma_f32_16x16x32_bf16 v[104:107], v[64:67], v[56:59], v[104:107]
    v_mfma_f32_16x16x32_bf16 v[108:111], v[64:67], v[60:63], v[108:111]
    s_waitcnt lgkmcnt(8)
    v_mfma_f32_16x16x32_bf16 v[112:115], v[68:71], v[48:51], v[112:115]
    ds_read_b64_tr_b16 v[64:65], v13 offset:5216
    ds_read_b64_tr_b16 v[66:67], v13 offset:7776
    v_mfma_f32_16x16x32_bf16 v[116:119], v[68:71], v[52:55], v[116:119]
    v_mfma_f32_16x16x32_bf16 v[120:123], v[68:71], v[56:59], v[120:123]
    v_mfma_f32_16x16x32_bf16 v[124:127], v[68:71], v[60:63], v[124:127]
    s_waitcnt lgkmcnt(8)
    v_mfma_f32_16x16x32_bf16 v[128:131], v[72:75], v[48:51], v[128:131]
    ds_read_b64_tr_b16 v[68:69], v13 offset:15584
    ds_read_b64_tr_b16 v[70:71], v13 offset:18144
    v_mfma_f32_16x16x32_bf16 v[132:135], v[72:75], v[52:55], v[132:135]
    v_mfma_f32_16x16x32_bf16 v[136:139], v[72:75], v[56:59], v[136:139]
    v_mfma_f32_16x16x32_bf16 v[140:143], v[72:75], v[60:63], v[140:143]
    s_waitcnt lgkmcnt(8)
    v_mfma_f32_16x16x32_bf16 v[144:147], v[76:79], v[48:51], v[144:147]
    ds_read_b64_tr_b16 v[72:73], v13 offset:5248
    ds_read_b64_tr_b16 v[74:75], v13 offset:7808
    v_mfma_f32_16x16x32_bf16 v[148:151], v[76:79], v[52:55], v[148:151]
    v_mfma_f32_16x16x32_bf16 v[152:155], v[76:79], v[56:59], v[152:155]
    v_mfma_f32_16x16x32_bf16 v[156:159], v[76:79], v[60:63], v[156:159]
    s_waitcnt lgkmcnt(8)
    v_mfma_f32_16x16x32_bf16 v[160:163], v[80:83], v[48:51], v[160:163]
    ds_read_b64_tr_b16 v[76:77], v13 offset:15616
    ds_read_b64_tr_b16 v[78:79], v13 offset:18176
    v_mfma_f32_16x16x32_bf16 v[164:167], v[80:83], v[52:55], v[164:167]
    v_mfma_f32_16x16x32_bf16 v[168:171], v[80:83], v[56:59], v[168:171]
    v_mfma_f32_16x16x32_bf16 v[172:175], v[80:83], v[60:63], v[172:175]
    s_waitcnt lgkmcnt(8)
    v_mfma_f32_16x16x32_bf16 v[176:179], v[84:87], v[48:51], v[176:179]
    v_mfma_f32_16x16x32_bf16 v[180:183], v[84:87], v[52:55], v[180:183]
    v_mfma_f32_16x16x32_bf16 v[184:187], v[84:87], v[56:59], v[184:187]
    v_mfma_f32_16x16x32_bf16 v[188:191], v[84:87], v[60:63], v[188:191]
    s_waitcnt lgkmcnt(6)
    v_mfma_f32_16x16x32_bf16 v[192:195], v[64:67], v[48:51], v[192:195]
    v_mfma_f32_16x16x32_bf16 v[196:199], v[64:67], v[52:55], v[196:199]
    v_mfma_f32_16x16x32_bf16 v[200:203], v[64:67], v[56:59], v[200:203]
    v_mfma_f32_16x16x32_bf16 v[204:207], v[64:67], v[60:63], v[204:207]
    s_waitcnt lgkmcnt(0)
    s_barrier
    v_mfma_f32_16x16x32_bf16 v[208:211], v[68:71], v[48:51], v[208:211]
    ds_read_b128 v[32:35], v10 offset:0
    ds_read_b128 v[36:39], v10 offset:2048
    v_mfma_f32_16x16x32_bf16 v[212:215], v[68:71], v[52:55], v[212:215]
    ds_read_b128 v[40:43], v10 offset:4096
    ds_read_b128 v[44:47], v10 offset:6144
    v_mfma_f32_16x16x32_bf16 v[216:219], v[68:71], v[56:59], v[216:219]
    ds_read_b64_tr_b16 v[80:81], v14 offset:0
    ds_read_b64_tr_b16 v[82:83], v14 offset:2560
    v_mfma_f32_16x16x32_bf16 v[220:223], v[68:71], v[60:63], v[220:223]
    ds_read_b64_tr_b16 v[84:85], v14 offset:10368
    ds_read_b64_tr_b16 v[86:87], v14 offset:12928
    v_mfma_f32_16x16x32_bf16 v[224:227], v[72:75], v[48:51], v[224:227]
    ds_read_b64_tr_b16 v[64:65], v14 offset:32
    ds_read_b64_tr_b16 v[66:67], v14 offset:2592
    v_mfma_f32_16x16x32_bf16 v[228:231], v[72:75], v[52:55], v[228:231]
    ds_read_b64_tr_b16 v[68:69], v14 offset:10400
    ds_read_b64_tr_b16 v[70:71], v14 offset:12960
    v_mfma_f32_16x16x32_bf16 v[232:235], v[72:75], v[56:59], v[232:235]
    v_mfma_f32_16x16x32_bf16 v[236:239], v[72:75], v[60:63], v[236:239]
    v_mfma_f32_16x16x32_bf16 v[240:243], v[76:79], v[48:51], v[240:243]
    ds_read_b64_tr_b16 v[72:73], v14 offset:64
    ds_read_b64_tr_b16 v[74:75], v14 offset:2624
    v_mfma_f32_16x16x32_bf16 v[244:247], v[76:79], v[52:55], v[244:247]
    v_mfma_f32_16x16x32_bf16 v[248:251], v[76:79], v[56:59], v[248:251]
    v_mfma_f32_16x16x32_bf16 v[252:255], v[76:79], v[60:63], v[252:255]
    s_waitcnt lgkmcnt(8)
    v_mfma_f32_16x16x32_bf16 v[96:99], v[80:83], v[32:35], v[96:99]
    ds_read_b64_tr_b16 v[76:77], v14 offset:10432
    ds_read_b64_tr_b16 v[78:79], v14 offset:12992
    v_mfma_f32_16x16x32_bf16 v[100:103], v[80:83], v[36:39], v[100:103]
    ds_read_b128 v[48:51], v11 offset:0
    ds_read_b128 v[52:55], v11 offset:2048
    v_mfma_f32_16x16x32_bf16 v[104:107], v[80:83], v[40:43], v[104:107]
    ds_read_b128 v[56:59], v11 offset:4096
    ds_read_b128 v[60:63], v11 offset:6144
    v_mfma_f32_16x16x32_bf16 v[108:111], v[80:83], v[44:47], v[108:111]
    s_waitcnt lgkmcnt(12)
    v_mfma_f32_16x16x32_bf16 v[112:115], v[84:87], v[32:35], v[112:115]
    ds_read_b64_tr_b16 v[80:81], v14 offset:96
    ds_read_b64_tr_b16 v[82:83], v14 offset:2656
    v_mfma_f32_16x16x32_bf16 v[116:119], v[84:87], v[36:39], v[116:119]
    v_mfma_f32_16x16x32_bf16 v[120:123], v[84:87], v[40:43], v[120:123]
    v_mfma_f32_16x16x32_bf16 v[124:127], v[84:87], v[44:47], v[124:127]
    s_waitcnt lgkmcnt(12)
    v_mfma_f32_16x16x32_bf16 v[128:131], v[64:67], v[32:35], v[128:131]
    ds_read_b64_tr_b16 v[84:85], v14 offset:10464
    ds_read_b64_tr_b16 v[86:87], v14 offset:13024
    v_mfma_f32_16x16x32_bf16 v[132:135], v[64:67], v[36:39], v[132:135]
    v_mfma_f32_16x16x32_bf16 v[136:139], v[64:67], v[40:43], v[136:139]
    v_mfma_f32_16x16x32_bf16 v[140:143], v[64:67], v[44:47], v[140:143]
    s_waitcnt lgkmcnt(12)
    v_mfma_f32_16x16x32_bf16 v[144:147], v[68:71], v[32:35], v[144:147]
    ds_read_b64_tr_b16 v[64:65], v14 offset:128
    ds_read_b64_tr_b16 v[66:67], v14 offset:2688
    v_mfma_f32_16x16x32_bf16 v[148:151], v[68:71], v[36:39], v[148:151]
    v_mfma_f32_16x16x32_bf16 v[152:155], v[68:71], v[40:43], v[152:155]
    v_mfma_f32_16x16x32_bf16 v[156:159], v[68:71], v[44:47], v[156:159]
    s_waitcnt lgkmcnt(12)
    v_mfma_f32_16x16x32_bf16 v[160:163], v[72:75], v[32:35], v[160:163]
    ds_read_b64_tr_b16 v[68:69], v14 offset:10496
    ds_read_b64_tr_b16 v[70:71], v14 offset:13056
    v_mfma_f32_16x16x32_bf16 v[164:167], v[72:75], v[36:39], v[164:167]
    v_mfma_f32_16x16x32_bf16 v[168:171], v[72:75], v[40:43], v[168:171]
    v_mfma_f32_16x16x32_bf16 v[172:175], v[72:75], v[44:47], v[172:175]
    s_waitcnt lgkmcnt(12)
    v_mfma_f32_16x16x32_bf16 v[176:179], v[76:79], v[32:35], v[176:179]
    ds_read_b64_tr_b16 v[72:73], v14 offset:5120
    ds_read_b64_tr_b16 v[74:75], v14 offset:7680
    v_mfma_f32_16x16x32_bf16 v[180:183], v[76:79], v[36:39], v[180:183]
    v_mfma_f32_16x16x32_bf16 v[184:187], v[76:79], v[40:43], v[184:187]
    v_mfma_f32_16x16x32_bf16 v[188:191], v[76:79], v[44:47], v[188:191]
    s_waitcnt lgkmcnt(8)
    v_mfma_f32_16x16x32_bf16 v[192:195], v[80:83], v[32:35], v[192:195]
    ds_read_b64_tr_b16 v[76:77], v14 offset:15488
    ds_read_b64_tr_b16 v[78:79], v14 offset:18048
    v_mfma_f32_16x16x32_bf16 v[196:199], v[80:83], v[36:39], v[196:199]
    v_mfma_f32_16x16x32_bf16 v[200:203], v[80:83], v[40:43], v[200:203]
    v_mfma_f32_16x16x32_bf16 v[204:207], v[80:83], v[44:47], v[204:207]
    s_waitcnt lgkmcnt(8)
    v_mfma_f32_16x16x32_bf16 v[208:211], v[84:87], v[32:35], v[208:211]
    ds_read_b64_tr_b16 v[80:81], v14 offset:5152
    ds_read_b64_tr_b16 v[82:83], v14 offset:7712
    v_mfma_f32_16x16x32_bf16 v[212:215], v[84:87], v[36:39], v[212:215]
    v_mfma_f32_16x16x32_bf16 v[216:219], v[84:87], v[40:43], v[216:219]
    v_mfma_f32_16x16x32_bf16 v[220:223], v[84:87], v[44:47], v[220:223]
    s_waitcnt lgkmcnt(8)
    v_mfma_f32_16x16x32_bf16 v[224:227], v[64:67], v[32:35], v[224:227]
    ds_read_b64_tr_b16 v[84:85], v14 offset:15520
    ds_read_b64_tr_b16 v[86:87], v14 offset:18080
    v_mfma_f32_16x16x32_bf16 v[228:231], v[64:67], v[36:39], v[228:231]
    v_mfma_f32_16x16x32_bf16 v[232:235], v[64:67], v[40:43], v[232:235]
    v_mfma_f32_16x16x32_bf16 v[236:239], v[64:67], v[44:47], v[236:239]
    s_waitcnt lgkmcnt(8)
    v_mfma_f32_16x16x32_bf16 v[240:243], v[68:71], v[32:35], v[240:243]
    ds_read_b64_tr_b16 v[64:65], v14 offset:5184
    ds_read_b64_tr_b16 v[66:67], v14 offset:7744
    v_mfma_f32_16x16x32_bf16 v[244:247], v[68:71], v[36:39], v[244:247]
    v_mfma_f32_16x16x32_bf16 v[248:251], v[68:71], v[40:43], v[248:251]
    v_mfma_f32_16x16x32_bf16 v[252:255], v[68:71], v[44:47], v[252:255]
    s_waitcnt lgkmcnt(8)
    v_mfma_f32_16x16x32_bf16 v[96:99], v[72:75], v[48:51], v[96:99]
    ds_read_b64_tr_b16 v[68:69], v14 offset:15552
    ds_read_b64_tr_b16 v[70:71], v14 offset:18112
    v_mfma_f32_16x16x32_bf16 v[100:103], v[72:75], v[52:55], v[100:103]
    v_mfma_f32_16x16x32_bf16 v[104:107], v[72:75], v[56:59], v[104:107]
    v_mfma_f32_16x16x32_bf16 v[108:111], v[72:75], v[60:63], v[108:111]
    s_waitcnt lgkmcnt(8)
    v_mfma_f32_16x16x32_bf16 v[112:115], v[76:79], v[48:51], v[112:115]
    ds_read_b64_tr_b16 v[72:73], v14 offset:5216
    ds_read_b64_tr_b16 v[74:75], v14 offset:7776
    v_mfma_f32_16x16x32_bf16 v[116:119], v[76:79], v[52:55], v[116:119]
    v_mfma_f32_16x16x32_bf16 v[120:123], v[76:79], v[56:59], v[120:123]
    v_mfma_f32_16x16x32_bf16 v[124:127], v[76:79], v[60:63], v[124:127]
    s_waitcnt lgkmcnt(8)
    v_mfma_f32_16x16x32_bf16 v[128:131], v[80:83], v[48:51], v[128:131]
    ds_read_b64_tr_b16 v[76:77], v14 offset:15584
    ds_read_b64_tr_b16 v[78:79], v14 offset:18144
    v_mfma_f32_16x16x32_bf16 v[132:135], v[80:83], v[52:55], v[132:135]
    v_mfma_f32_16x16x32_bf16 v[136:139], v[80:83], v[56:59], v[136:139]
    v_mfma_f32_16x16x32_bf16 v[140:143], v[80:83], v[60:63], v[140:143]
    s_waitcnt lgkmcnt(8)
    v_mfma_f32_16x16x32_bf16 v[144:147], v[84:87], v[48:51], v[144:147]
    ds_read_b64_tr_b16 v[80:81], v14 offset:5248
    ds_read_b64_tr_b16 v[82:83], v14 offset:7808
    v_mfma_f32_16x16x32_bf16 v[148:151], v[84:87], v[52:55], v[148:151]
    v_mfma_f32_16x16x32_bf16 v[152:155], v[84:87], v[56:59], v[152:155]
    v_mfma_f32_16x16x32_bf16 v[156:159], v[84:87], v[60:63], v[156:159]
    s_waitcnt lgkmcnt(8)
    v_mfma_f32_16x16x32_bf16 v[160:163], v[64:67], v[48:51], v[160:163]
    ds_read_b64_tr_b16 v[84:85], v14 offset:15616
    ds_read_b64_tr_b16 v[86:87], v14 offset:18176
    v_mfma_f32_16x16x32_bf16 v[164:167], v[64:67], v[52:55], v[164:167]
    v_mfma_f32_16x16x32_bf16 v[168:171], v[64:67], v[56:59], v[168:171]
    v_mfma_f32_16x16x32_bf16 v[172:175], v[64:67], v[60:63], v[172:175]
    s_waitcnt lgkmcnt(8)
    v_mfma_f32_16x16x32_bf16 v[176:179], v[68:71], v[48:51], v[176:179]
    v_mfma_f32_16x16x32_bf16 v[180:183], v[68:71], v[52:55], v[180:183]
    v_mfma_f32_16x16x32_bf16 v[184:187], v[68:71], v[56:59], v[184:187]
    v_mfma_f32_16x16x32_bf16 v[188:191], v[68:71], v[60:63], v[188:191]
    s_waitcnt lgkmcnt(6)
    v_mfma_f32_16x16x32_bf16 v[192:195], v[72:75], v[48:51], v[192:195]
    v_mfma_f32_16x16x32_bf16 v[196:199], v[72:75], v[52:55], v[196:199]
    v_mfma_f32_16x16x32_bf16 v[200:203], v[72:75], v[56:59], v[200:203]
    v_mfma_f32_16x16x32_bf16 v[204:207], v[72:75], v[60:63], v[204:207]
    s_waitcnt lgkmcnt(0)
    s_barrier
    v_mfma_f32_16x16x32_bf16 v[208:211], v[76:79], v[48:51], v[208:211]
    ds_read_b128 v[32:35], v8 offset:0
    ds_read_b128 v[36:39], v8 offset:2048
    v_mfma_f32_16x16x32_bf16 v[212:215], v[76:79], v[52:55], v[212:215]
    ds_read_b128 v[40:43], v8 offset:4096
    ds_read_b128 v[44:47], v8 offset:6144
    v_mfma_f32_16x16x32_bf16 v[216:219], v[76:79], v[56:59], v[216:219]
    ds_read_b64_tr_b16 v[64:65], v12 offset:0
    ds_read_b64_tr_b16 v[66:67], v12 offset:2560
    v_mfma_f32_16x16x32_bf16 v[220:223], v[76:79], v[60:63], v[220:223]
    ds_read_b64_tr_b16 v[68:69], v12 offset:10368
    ds_read_b64_tr_b16 v[70:71], v12 offset:12928
    v_mfma_f32_16x16x32_bf16 v[224:227], v[80:83], v[48:51], v[224:227]
    ds_read_b64_tr_b16 v[72:73], v12 offset:32
    ds_read_b64_tr_b16 v[74:75], v12 offset:2592
    v_mfma_f32_16x16x32_bf16 v[228:231], v[80:83], v[52:55], v[228:231]
    ds_read_b64_tr_b16 v[76:77], v12 offset:10400
    ds_read_b64_tr_b16 v[78:79], v12 offset:12960
    v_mfma_f32_16x16x32_bf16 v[232:235], v[80:83], v[56:59], v[232:235]
    v_mfma_f32_16x16x32_bf16 v[236:239], v[80:83], v[60:63], v[236:239]
    v_mfma_f32_16x16x32_bf16 v[240:243], v[84:87], v[48:51], v[240:243]
    ds_read_b64_tr_b16 v[80:81], v12 offset:64
    ds_read_b64_tr_b16 v[82:83], v12 offset:2624
    v_mfma_f32_16x16x32_bf16 v[244:247], v[84:87], v[52:55], v[244:247]
    v_mfma_f32_16x16x32_bf16 v[248:251], v[84:87], v[56:59], v[248:251]
    v_mfma_f32_16x16x32_bf16 v[252:255], v[84:87], v[60:63], v[252:255]
    s_waitcnt lgkmcnt(8)
    v_mfma_f32_16x16x32_bf16 v[96:99], v[64:67], v[32:35], v[96:99]
    ds_read_b64_tr_b16 v[84:85], v12 offset:10432
    ds_read_b64_tr_b16 v[86:87], v12 offset:12992
    v_mfma_f32_16x16x32_bf16 v[100:103], v[64:67], v[36:39], v[100:103]
    ds_read_b128 v[48:51], v9 offset:0
    ds_read_b128 v[52:55], v9 offset:2048
    v_mfma_f32_16x16x32_bf16 v[104:107], v[64:67], v[40:43], v[104:107]
    ds_read_b128 v[56:59], v9 offset:4096
    ds_read_b128 v[60:63], v9 offset:6144
    v_mfma_f32_16x16x32_bf16 v[108:111], v[64:67], v[44:47], v[108:111]
    s_waitcnt lgkmcnt(12)
    v_mfma_f32_16x16x32_bf16 v[112:115], v[68:71], v[32:35], v[112:115]
    ds_read_b64_tr_b16 v[64:65], v12 offset:96
    ds_read_b64_tr_b16 v[66:67], v12 offset:2656
    v_mfma_f32_16x16x32_bf16 v[116:119], v[68:71], v[36:39], v[116:119]
    v_mfma_f32_16x16x32_bf16 v[120:123], v[68:71], v[40:43], v[120:123]
    v_mfma_f32_16x16x32_bf16 v[124:127], v[68:71], v[44:47], v[124:127]
    s_waitcnt lgkmcnt(12)
    v_mfma_f32_16x16x32_bf16 v[128:131], v[72:75], v[32:35], v[128:131]
    ds_read_b64_tr_b16 v[68:69], v12 offset:10464
    ds_read_b64_tr_b16 v[70:71], v12 offset:13024
    v_mfma_f32_16x16x32_bf16 v[132:135], v[72:75], v[36:39], v[132:135]
    v_mfma_f32_16x16x32_bf16 v[136:139], v[72:75], v[40:43], v[136:139]
    v_mfma_f32_16x16x32_bf16 v[140:143], v[72:75], v[44:47], v[140:143]
    s_waitcnt lgkmcnt(12)
    v_mfma_f32_16x16x32_bf16 v[144:147], v[76:79], v[32:35], v[144:147]
    ds_read_b64_tr_b16 v[72:73], v12 offset:128
    ds_read_b64_tr_b16 v[74:75], v12 offset:2688
    v_mfma_f32_16x16x32_bf16 v[148:151], v[76:79], v[36:39], v[148:151]
    v_mfma_f32_16x16x32_bf16 v[152:155], v[76:79], v[40:43], v[152:155]
    v_mfma_f32_16x16x32_bf16 v[156:159], v[76:79], v[44:47], v[156:159]
    s_waitcnt lgkmcnt(12)
    v_mfma_f32_16x16x32_bf16 v[160:163], v[80:83], v[32:35], v[160:163]
    ds_read_b64_tr_b16 v[76:77], v12 offset:10496
    ds_read_b64_tr_b16 v[78:79], v12 offset:13056
    v_mfma_f32_16x16x32_bf16 v[164:167], v[80:83], v[36:39], v[164:167]
    v_mfma_f32_16x16x32_bf16 v[168:171], v[80:83], v[40:43], v[168:171]
    v_mfma_f32_16x16x32_bf16 v[172:175], v[80:83], v[44:47], v[172:175]
    s_waitcnt lgkmcnt(12)
    v_mfma_f32_16x16x32_bf16 v[176:179], v[84:87], v[32:35], v[176:179]
    ds_read_b64_tr_b16 v[80:81], v12 offset:5120
    ds_read_b64_tr_b16 v[82:83], v12 offset:7680
    v_mfma_f32_16x16x32_bf16 v[180:183], v[84:87], v[36:39], v[180:183]
    v_mfma_f32_16x16x32_bf16 v[184:187], v[84:87], v[40:43], v[184:187]
    v_mfma_f32_16x16x32_bf16 v[188:191], v[84:87], v[44:47], v[188:191]
    s_waitcnt lgkmcnt(8)
    v_mfma_f32_16x16x32_bf16 v[192:195], v[64:67], v[32:35], v[192:195]
    ds_read_b64_tr_b16 v[84:85], v12 offset:15488
    ds_read_b64_tr_b16 v[86:87], v12 offset:18048
    v_mfma_f32_16x16x32_bf16 v[196:199], v[64:67], v[36:39], v[196:199]
    v_mfma_f32_16x16x32_bf16 v[200:203], v[64:67], v[40:43], v[200:203]
    v_mfma_f32_16x16x32_bf16 v[204:207], v[64:67], v[44:47], v[204:207]
    s_waitcnt lgkmcnt(8)
    v_mfma_f32_16x16x32_bf16 v[208:211], v[68:71], v[32:35], v[208:211]
    ds_read_b64_tr_b16 v[64:65], v12 offset:5152
    ds_read_b64_tr_b16 v[66:67], v12 offset:7712
    v_mfma_f32_16x16x32_bf16 v[212:215], v[68:71], v[36:39], v[212:215]
    v_mfma_f32_16x16x32_bf16 v[216:219], v[68:71], v[40:43], v[216:219]
    v_mfma_f32_16x16x32_bf16 v[220:223], v[68:71], v[44:47], v[220:223]
    s_waitcnt lgkmcnt(8)
    v_mfma_f32_16x16x32_bf16 v[224:227], v[72:75], v[32:35], v[224:227]
    ds_read_b64_tr_b16 v[68:69], v12 offset:15520
    ds_read_b64_tr_b16 v[70:71], v12 offset:18080
    v_mfma_f32_16x16x32_bf16 v[228:231], v[72:75], v[36:39], v[228:231]
    v_mfma_f32_16x16x32_bf16 v[232:235], v[72:75], v[40:43], v[232:235]
    v_mfma_f32_16x16x32_bf16 v[236:239], v[72:75], v[44:47], v[236:239]
    s_waitcnt lgkmcnt(8)
    v_mfma_f32_16x16x32_bf16 v[240:243], v[76:79], v[32:35], v[240:243]
    ds_read_b64_tr_b16 v[72:73], v12 offset:5184
    ds_read_b64_tr_b16 v[74:75], v12 offset:7744
    v_mfma_f32_16x16x32_bf16 v[244:247], v[76:79], v[36:39], v[244:247]
    v_mfma_f32_16x16x32_bf16 v[248:251], v[76:79], v[40:43], v[248:251]
    v_mfma_f32_16x16x32_bf16 v[252:255], v[76:79], v[44:47], v[252:255]
    s_waitcnt lgkmcnt(8)
    v_mfma_f32_16x16x32_bf16 v[96:99], v[80:83], v[48:51], v[96:99]
    ds_read_b64_tr_b16 v[76:77], v12 offset:15552
    ds_read_b64_tr_b16 v[78:79], v12 offset:18112
    v_mfma_f32_16x16x32_bf16 v[100:103], v[80:83], v[52:55], v[100:103]
    v_mfma_f32_16x16x32_bf16 v[104:107], v[80:83], v[56:59], v[104:107]
    v_mfma_f32_16x16x32_bf16 v[108:111], v[80:83], v[60:63], v[108:111]
    s_waitcnt lgkmcnt(8)
    v_mfma_f32_16x16x32_bf16 v[112:115], v[84:87], v[48:51], v[112:115]
    ds_read_b64_tr_b16 v[80:81], v12 offset:5216
    ds_read_b64_tr_b16 v[82:83], v12 offset:7776
    v_mfma_f32_16x16x32_bf16 v[116:119], v[84:87], v[52:55], v[116:119]
    v_mfma_f32_16x16x32_bf16 v[120:123], v[84:87], v[56:59], v[120:123]
    v_mfma_f32_16x16x32_bf16 v[124:127], v[84:87], v[60:63], v[124:127]
    s_waitcnt lgkmcnt(8)
    v_mfma_f32_16x16x32_bf16 v[128:131], v[64:67], v[48:51], v[128:131]
    ds_read_b64_tr_b16 v[84:85], v12 offset:15584
    ds_read_b64_tr_b16 v[86:87], v12 offset:18144
    v_mfma_f32_16x16x32_bf16 v[132:135], v[64:67], v[52:55], v[132:135]
    v_mfma_f32_16x16x32_bf16 v[136:139], v[64:67], v[56:59], v[136:139]
    v_mfma_f32_16x16x32_bf16 v[140:143], v[64:67], v[60:63], v[140:143]
    s_waitcnt lgkmcnt(8)
    v_mfma_f32_16x16x32_bf16 v[144:147], v[68:71], v[48:51], v[144:147]
    ds_read_b64_tr_b16 v[64:65], v12 offset:5248
    ds_read_b64_tr_b16 v[66:67], v12 offset:7808
    v_mfma_f32_16x16x32_bf16 v[148:151], v[68:71], v[52:55], v[148:151]
    v_mfma_f32_16x16x32_bf16 v[152:155], v[68:71], v[56:59], v[152:155]
    v_mfma_f32_16x16x32_bf16 v[156:159], v[68:71], v[60:63], v[156:159]
    s_waitcnt lgkmcnt(8)
    v_mfma_f32_16x16x32_bf16 v[160:163], v[72:75], v[48:51], v[160:163]
    ds_read_b64_tr_b16 v[68:69], v12 offset:15616
    ds_read_b64_tr_b16 v[70:71], v12 offset:18176
    v_mfma_f32_16x16x32_bf16 v[164:167], v[72:75], v[52:55], v[164:167]
    v_mfma_f32_16x16x32_bf16 v[168:171], v[72:75], v[56:59], v[168:171]
    v_mfma_f32_16x16x32_bf16 v[172:175], v[72:75], v[60:63], v[172:175]
    s_waitcnt lgkmcnt(8)
    v_mfma_f32_16x16x32_bf16 v[176:179], v[76:79], v[48:51], v[176:179]
    v_mfma_f32_16x16x32_bf16 v[180:183], v[76:79], v[52:55], v[180:183]
    v_mfma_f32_16x16x32_bf16 v[184:187], v[76:79], v[56:59], v[184:187]
    v_mfma_f32_16x16x32_bf16 v[188:191], v[76:79], v[60:63], v[188:191]
    s_waitcnt lgkmcnt(6)
    v_mfma_f32_16x16x32_bf16 v[192:195], v[80:83], v[48:51], v[192:195]
    v_mfma_f32_16x16x32_bf16 v[196:199], v[80:83], v[52:55], v[196:199]
    v_mfma_f32_16x16x32_bf16 v[200:203], v[80:83], v[56:59], v[200:203]
    v_mfma_f32_16x16x32_bf16 v[204:207], v[80:83], v[60:63], v[204:207]
    s_waitcnt lgkmcnt(0)
    s_barrier
    v_mfma_f32_16x16x32_bf16 v[208:211], v[84:87], v[48:51], v[208:211]
    ds_read_b128 v[32:35], v8 offset:53376
    ds_read_b128 v[36:39], v8 offset:55424
    v_mfma_f32_16x16x32_bf16 v[212:215], v[84:87], v[52:55], v[212:215]
    ds_read_b128 v[40:43], v8 offset:57472
    ds_read_b128 v[44:47], v8 offset:59520
    v_mfma_f32_16x16x32_bf16 v[216:219], v[84:87], v[56:59], v[216:219]
    ds_read_b64_tr_b16 v[72:73], v13 offset:0
    ds_read_b64_tr_b16 v[74:75], v13 offset:2560
    v_mfma_f32_16x16x32_bf16 v[220:223], v[84:87], v[60:63], v[220:223]
    ds_read_b64_tr_b16 v[76:77], v13 offset:10368
    ds_read_b64_tr_b16 v[78:79], v13 offset:12928
    v_mfma_f32_16x16x32_bf16 v[224:227], v[64:67], v[48:51], v[224:227]
    ds_read_b64_tr_b16 v[80:81], v13 offset:32
    ds_read_b64_tr_b16 v[82:83], v13 offset:2592
    v_mfma_f32_16x16x32_bf16 v[228:231], v[64:67], v[52:55], v[228:231]
    ds_read_b64_tr_b16 v[84:85], v13 offset:10400
    ds_read_b64_tr_b16 v[86:87], v13 offset:12960
    v_mfma_f32_16x16x32_bf16 v[232:235], v[64:67], v[56:59], v[232:235]
    v_mfma_f32_16x16x32_bf16 v[236:239], v[64:67], v[60:63], v[236:239]
    v_mfma_f32_16x16x32_bf16 v[240:243], v[68:71], v[48:51], v[240:243]
    ds_read_b64_tr_b16 v[64:65], v13 offset:64
    ds_read_b64_tr_b16 v[66:67], v13 offset:2624
    v_mfma_f32_16x16x32_bf16 v[244:247], v[68:71], v[52:55], v[244:247]
    v_mfma_f32_16x16x32_bf16 v[248:251], v[68:71], v[56:59], v[248:251]
    v_mfma_f32_16x16x32_bf16 v[252:255], v[68:71], v[60:63], v[252:255]
    s_waitcnt lgkmcnt(8)
    v_mfma_f32_16x16x32_bf16 v[96:99], v[72:75], v[32:35], v[96:99]
    ds_read_b64_tr_b16 v[68:69], v13 offset:10432
    ds_read_b64_tr_b16 v[70:71], v13 offset:12992
    v_mfma_f32_16x16x32_bf16 v[100:103], v[72:75], v[36:39], v[100:103]
    ds_read_b128 v[48:51], v9 offset:53376
    ds_read_b128 v[52:55], v9 offset:55424
    v_mfma_f32_16x16x32_bf16 v[104:107], v[72:75], v[40:43], v[104:107]
    ds_read_b128 v[56:59], v9 offset:57472
    ds_read_b128 v[60:63], v9 offset:59520
    v_mfma_f32_16x16x32_bf16 v[108:111], v[72:75], v[44:47], v[108:111]
    v_mov_b32 v31, 0x27fc0
    ds_read_b32 v30, v31
    s_waitcnt lgkmcnt(13)
    v_mfma_f32_16x16x32_bf16 v[112:115], v[76:79], v[32:35], v[112:115]
    ds_read_b64_tr_b16 v[72:73], v13 offset:96
    ds_read_b64_tr_b16 v[74:75], v13 offset:2656
    v_mfma_f32_16x16x32_bf16 v[116:119], v[76:79], v[36:39], v[116:119]
    v_mfma_f32_16x16x32_bf16 v[120:123], v[76:79], v[40:43], v[120:123]
    v_mfma_f32_16x16x32_bf16 v[124:127], v[76:79], v[44:47], v[124:127]
    s_waitcnt lgkmcnt(13)
    v_mfma_f32_16x16x32_bf16 v[128:131], v[80:83], v[32:35], v[128:131]
    ds_read_b64_tr_b16 v[76:77], v13 offset:10464
    ds_read_b64_tr_b16 v[78:79], v13 offset:13024
    v_mfma_f32_16x16x32_bf16 v[132:135], v[80:83], v[36:39], v[132:135]
    v_mfma_f32_16x16x32_bf16 v[136:139], v[80:83], v[40:43], v[136:139]
    v_mfma_f32_16x16x32_bf16 v[140:143], v[80:83], v[44:47], v[140:143]
    s_waitcnt lgkmcnt(13)
    v_mfma_f32_16x16x32_bf16 v[144:147], v[84:87], v[32:35], v[144:147]
    ds_read_b64_tr_b16 v[80:81], v13 offset:128
    ds_read_b64_tr_b16 v[82:83], v13 offset:2688
    v_mfma_f32_16x16x32_bf16 v[148:151], v[84:87], v[36:39], v[148:151]
    v_mfma_f32_16x16x32_bf16 v[152:155], v[84:87], v[40:43], v[152:155]
    v_mfma_f32_16x16x32_bf16 v[156:159], v[84:87], v[44:47], v[156:159]
    s_waitcnt lgkmcnt(13)
    v_mfma_f32_16x16x32_bf16 v[160:163], v[64:67], v[32:35], v[160:163]
    ds_read_b64_tr_b16 v[84:85], v13 offset:10496
    ds_read_b64_tr_b16 v[86:87], v13 offset:13056
    v_mfma_f32_16x16x32_bf16 v[164:167], v[64:67], v[36:39], v[164:167]
    v_mfma_f32_16x16x32_bf16 v[168:171], v[64:67], v[40:43], v[168:171]
    v_mfma_f32_16x16x32_bf16 v[172:175], v[64:67], v[44:47], v[172:175]
    s_waitcnt lgkmcnt(13)
    v_mfma_f32_16x16x32_bf16 v[176:179], v[68:71], v[32:35], v[176:179]
    ds_read_b64_tr_b16 v[64:65], v13 offset:5120
    ds_read_b64_tr_b16 v[66:67], v13 offset:7680
    v_mfma_f32_16x16x32_bf16 v[180:183], v[68:71], v[36:39], v[180:183]
    v_mfma_f32_16x16x32_bf16 v[184:187], v[68:71], v[40:43], v[184:187]
    v_mfma_f32_16x16x32_bf16 v[188:191], v[68:71], v[44:47], v[188:191]
    s_waitcnt lgkmcnt(8)
    v_mfma_f32_16x16x32_bf16 v[192:195], v[72:75], v[32:35], v[192:195]
    ds_read_b64_tr_b16 v[68:69], v13 offset:15488
    ds_read_b64_tr_b16 v[70:71], v13 offset:18048
    v_mfma_f32_16x16x32_bf16 v[196:199], v[72:75], v[36:39], v[196:199]
    v_mfma_f32_16x16x32_bf16 v[200:203], v[72:75], v[40:43], v[200:203]
    v_mfma_f32_16x16x32_bf16 v[204:207], v[72:75], v[44:47], v[204:207]
    s_waitcnt lgkmcnt(8)
    v_mfma_f32_16x16x32_bf16 v[208:211], v[76:79], v[32:35], v[208:211]
    ds_read_b64_tr_b16 v[72:73], v13 offset:5152
    ds_read_b64_tr_b16 v[74:75], v13 offset:7712
    v_mfma_f32_16x16x32_bf16 v[212:215], v[76:79], v[36:39], v[212:215]
    v_mfma_f32_16x16x32_bf16 v[216:219], v[76:79], v[40:43], v[216:219]
    v_mfma_f32_16x16x32_bf16 v[220:223], v[76:79], v[44:47], v[220:223]
    s_waitcnt lgkmcnt(8)
    v_mfma_f32_16x16x32_bf16 v[224:227], v[80:83], v[32:35], v[224:227]
    ds_read_b64_tr_b16 v[76:77], v13 offset:15520
    ds_read_b64_tr_b16 v[78:79], v13 offset:18080
    v_mfma_f32_16x16x32_bf16 v[228:231], v[80:83], v[36:39], v[228:231]
    v_mfma_f32_16x16x32_bf16 v[232:235], v[80:83], v[40:43], v[232:235]
    v_mfma_f32_16x16x32_bf16 v[236:239], v[80:83], v[44:47], v[236:239]
    s_waitcnt lgkmcnt(8)
    v_mfma_f32_16x16x32_bf16 v[240:243], v[84:87], v[32:35], v[240:243]
    ds_read_b64_tr_b16 v[80:81], v13 offset:5184
    ds_read_b64_tr_b16 v[82:83], v13 offset:7744
    v_mfma_f32_16x16x32_bf16 v[244:247], v[84:87], v[36:39], v[244:247]
    v_mfma_f32_16x16x32_bf16 v[248:251], v[84:87], v[40:43], v[248:251]
    v_mfma_f32_16x16x32_bf16 v[252:255], v[84:87], v[44:47], v[252:255]
    s_waitcnt lgkmcnt(8)
    v_mfma_f32_16x16x32_bf16 v[96:99], v[64:67], v[48:51], v[96:99]
    ds_read_b64_tr_b16 v[84:85], v13 offset:15552
    ds_read_b64_tr_b16 v[86:87], v13 offset:18112
    v_mfma_f32_16x16x32_bf16 v[100:103], v[64:67], v[52:55], v[100:103]
    v_mfma_f32_16x16x32_bf16 v[104:107], v[64:67], v[56:59], v[104:107]
    v_mfma_f32_16x16x32_bf16 v[108:111], v[64:67], v[60:63], v[108:111]
    s_waitcnt lgkmcnt(8)
    v_mfma_f32_16x16x32_bf16 v[112:115], v[68:71], v[48:51], v[112:115]
    ds_read_b64_tr_b16 v[64:65], v13 offset:5216
    ds_read_b64_tr_b16 v[66:67], v13 offset:7776
    v_mfma_f32_16x16x32_bf16 v[116:119], v[68:71], v[52:55], v[116:119]
    v_mfma_f32_16x16x32_bf16 v[120:123], v[68:71], v[56:59], v[120:123]
    v_mfma_f32_16x16x32_bf16 v[124:127], v[68:71], v[60:63], v[124:127]
    s_waitcnt lgkmcnt(8)
    v_mfma_f32_16x16x32_bf16 v[128:131], v[72:75], v[48:51], v[128:131]
    ds_read_b64_tr_b16 v[68:69], v13 offset:15584
    ds_read_b64_tr_b16 v[70:71], v13 offset:18144
    v_mfma_f32_16x16x32_bf16 v[132:135], v[72:75], v[52:55], v[132:135]
    v_mfma_f32_16x16x32_bf16 v[136:139], v[72:75], v[56:59], v[136:139]
    v_mfma_f32_16x16x32_bf16 v[140:143], v[72:75], v[60:63], v[140:143]
    s_waitcnt lgkmcnt(8)
    v_mfma_f32_16x16x32_bf16 v[144:147], v[76:79], v[48:51], v[144:147]
    ds_read_b64_tr_b16 v[72:73], v13 offset:5248
    ds_read_b64_tr_b16 v[74:75], v13 offset:7808
    v_mfma_f32_16x16x32_bf16 v[148:151], v[76:79], v[52:55], v[148:151]
    v_mfma_f32_16x16x32_bf16 v[152:155], v[76:79], v[56:59], v[152:155]
    v_mfma_f32_16x16x32_bf16 v[156:159], v[76:79], v[60:63], v[156:159]
    s_waitcnt lgkmcnt(8)
    v_mfma_f32_16x16x32_bf16 v[160:163], v[80:83], v[48:51], v[160:163]
    ds_read_b64_tr_b16 v[76:77], v13 offset:15616
    ds_read_b64_tr_b16 v[78:79], v13 offset:18176
    v_mfma_f32_16x16x32_bf16 v[164:167], v[80:83], v[52:55], v[164:167]
    v_mfma_f32_16x16x32_bf16 v[168:171], v[80:83], v[56:59], v[168:171]
    v_mfma_f32_16x16x32_bf16 v[172:175], v[80:83], v[60:63], v[172:175]
    s_waitcnt lgkmcnt(8)
    v_mfma_f32_16x16x32_bf16 v[176:179], v[84:87], v[48:51], v[176:179]
    v_mfma_f32_16x16x32_bf16 v[180:183], v[84:87], v[52:55], v[180:183]
    v_mfma_f32_16x16x32_bf16 v[184:187], v[84:87], v[56:59], v[184:187]
    v_mfma_f32_16x16x32_bf16 v[188:191], v[84:87], v[60:63], v[188:191]
    s_waitcnt lgkmcnt(6)
    v_mfma_f32_16x16x32_bf16 v[192:195], v[64:67], v[48:51], v[192:195]
    v_mfma_f32_16x16x32_bf16 v[196:199], v[64:67], v[52:55], v[196:199]
    v_mfma_f32_16x16x32_bf16 v[200:203], v[64:67], v[56:59], v[200:203]
    v_mfma_f32_16x16x32_bf16 v[204:207], v[64:67], v[60:63], v[204:207]
    s_waitcnt lgkmcnt(0)
    s_barrier
    v_mfma_f32_16x16x32_bf16 v[208:211], v[68:71], v[48:51], v[208:211]
    ds_read_b128 v[32:35], v10 offset:0
    ds_read_b128 v[36:39], v10 offset:2048
    v_mfma_f32_16x16x32_bf16 v[212:215], v[68:71], v[52:55], v[212:215]
    ds_read_b128 v[40:43], v10 offset:4096
    ds_read_b128 v[44:47], v10 offset:6144
    v_mfma_f32_16x16x32_bf16 v[216:219], v[68:71], v[56:59], v[216:219]
    ds_read_b64_tr_b16 v[80:81], v14 offset:0
    ds_read_b64_tr_b16 v[82:83], v14 offset:2560
    v_mfma_f32_16x16x32_bf16 v[220:223], v[68:71], v[60:63], v[220:223]
    ds_read_b64_tr_b16 v[84:85], v14 offset:10368
    ds_read_b64_tr_b16 v[86:87], v14 offset:12928
    v_mfma_f32_16x16x32_bf16 v[224:227], v[72:75], v[48:51], v[224:227]
    ds_read_b64_tr_b16 v[64:65], v14 offset:32
    ds_read_b64_tr_b16 v[66:67], v14 offset:2592
    v_mfma_f32_16x16x32_bf16 v[228:231], v[72:75], v[52:55], v[228:231]
    ds_read_b64_tr_b16 v[68:69], v14 offset:10400
    ds_read_b64_tr_b16 v[70:71], v14 offset:12960
    v_mfma_f32_16x16x32_bf16 v[232:235], v[72:75], v[56:59], v[232:235]
    v_mfma_f32_16x16x32_bf16 v[236:239], v[72:75], v[60:63], v[236:239]
    v_mfma_f32_16x16x32_bf16 v[240:243], v[76:79], v[48:51], v[240:243]
    ds_read_b64_tr_b16 v[72:73], v14 offset:64
    ds_read_b64_tr_b16 v[74:75], v14 offset:2624
    v_mfma_f32_16x16x32_bf16 v[244:247], v[76:79], v[52:55], v[244:247]
    v_mfma_f32_16x16x32_bf16 v[248:251], v[76:79], v[56:59], v[248:251]
    v_mfma_f32_16x16x32_bf16 v[252:255], v[76:79], v[60:63], v[252:255]
    s_waitcnt lgkmcnt(8)
    v_mfma_f32_16x16x32_bf16 v[96:99], v[80:83], v[32:35], v[96:99]
    ds_read_b64_tr_b16 v[76:77], v14 offset:10432
    ds_read_b64_tr_b16 v[78:79], v14 offset:12992
    v_mfma_f32_16x16x32_bf16 v[100:103], v[80:83], v[36:39], v[100:103]
    ds_read_b128 v[48:51], v11 offset:0
    ds_read_b128 v[52:55], v11 offset:2048
    v_mfma_f32_16x16x32_bf16 v[104:107], v[80:83], v[40:43], v[104:107]
    ds_read_b128 v[56:59], v11 offset:4096
    ds_read_b128 v[60:63], v11 offset:6144
    v_mfma_f32_16x16x32_bf16 v[108:111], v[80:83], v[44:47], v[108:111]
    s_waitcnt lgkmcnt(12)
    v_mfma_f32_16x16x32_bf16 v[112:115], v[84:87], v[32:35], v[112:115]
    ds_read_b64_tr_b16 v[80:81], v14 offset:96
    ds_read_b64_tr_b16 v[82:83], v14 offset:2656
    v_mfma_f32_16x16x32_bf16 v[116:119], v[84:87], v[36:39], v[116:119]
    v_mfma_f32_16x16x32_bf16 v[120:123], v[84:87], v[40:43], v[120:123]
    v_mfma_f32_16x16x32_bf16 v[124:127], v[84:87], v[44:47], v[124:127]
    s_waitcnt lgkmcnt(12)
    v_mfma_f32_16x16x32_bf16 v[128:131], v[64:67], v[32:35], v[128:131]
    ds_read_b64_tr_b16 v[84:85], v14 offset:10464
    ds_read_b64_tr_b16 v[86:87], v14 offset:13024
    v_mfma_f32_16x16x32_bf16 v[132:135], v[64:67], v[36:39], v[132:135]
    v_mfma_f32_16x16x32_bf16 v[136:139], v[64:67], v[40:43], v[136:139]
    v_mfma_f32_16x16x32_bf16 v[140:143], v[64:67], v[44:47], v[140:143]
    s_waitcnt lgkmcnt(12)
    v_mfma_f32_16x16x32_bf16 v[144:147], v[68:71], v[32:35], v[144:147]
    ds_read_b64_tr_b16 v[64:65], v14 offset:128
    ds_read_b64_tr_b16 v[66:67], v14 offset:2688
    v_mfma_f32_16x16x32_bf16 v[148:151], v[68:71], v[36:39], v[148:151]
    v_mfma_f32_16x16x32_bf16 v[152:155], v[68:71], v[40:43], v[152:155]
    v_mfma_f32_16x16x32_bf16 v[156:159], v[68:71], v[44:47], v[156:159]
    s_waitcnt lgkmcnt(12)
    v_mfma_f32_16x16x32_bf16 v[160:163], v[72:75], v[32:35], v[160:163]
    ds_read_b64_tr_b16 v[68:69], v14 offset:10496
    ds_read_b64_tr_b16 v[70:71], v14 offset:13056
    v_mfma_f32_16x16x32_bf16 v[164:167], v[72:75], v[36:39], v[164:167]
    v_mfma_f32_16x16x32_bf16 v[168:171], v[72:75], v[40:43], v[168:171]
    v_mfma_f32_16x16x32_bf16 v[172:175], v[72:75], v[44:47], v[172:175]
    s_waitcnt lgkmcnt(12)
    v_mfma_f32_16x16x32_bf16 v[176:179], v[76:79], v[32:35], v[176:179]
    ds_read_b64_tr_b16 v[72:73], v14 offset:5120
    ds_read_b64_tr_b16 v[74:75], v14 offset:7680
    v_mfma_f32_16x16x32_bf16 v[180:183], v[76:79], v[36:39], v[180:183]
    v_mfma_f32_16x16x32_bf16 v[184:187], v[76:79], v[40:43], v[184:187]
    v_mfma_f32_16x16x32_bf16 v[188:191], v[76:79], v[44:47], v[188:191]
    s_waitcnt lgkmcnt(8)
    v_mfma_f32_16x16x32_bf16 v[192:195], v[80:83], v[32:35], v[192:195]
    ds_read_b64_tr_b16 v[76:77], v14 offset:15488
    ds_read_b64_tr_b16 v[78:79], v14 offset:18048
    v_mfma_f32_16x16x32_bf16 v[196:199], v[80:83], v[36:39], v[196:199]
    v_mfma_f32_16x16x32_bf16 v[200:203], v[80:83], v[40:43], v[200:203]
    v_mfma_f32_16x16x32_bf16 v[204:207], v[80:83], v[44:47], v[204:207]
    s_waitcnt lgkmcnt(8)
    v_mfma_f32_16x16x32_bf16 v[208:211], v[84:87], v[32:35], v[208:211]
    ds_read_b64_tr_b16 v[80:81], v14 offset:5152
    ds_read_b64_tr_b16 v[82:83], v14 offset:7712
    v_mfma_f32_16x16x32_bf16 v[212:215], v[84:87], v[36:39], v[212:215]
    v_mfma_f32_16x16x32_bf16 v[216:219], v[84:87], v[40:43], v[216:219]
    v_mfma_f32_16x16x32_bf16 v[220:223], v[84:87], v[44:47], v[220:223]
    s_waitcnt lgkmcnt(8)
    v_mfma_f32_16x16x32_bf16 v[224:227], v[64:67], v[32:35], v[224:227]
    ds_read_b64_tr_b16 v[84:85], v14 offset:15520
    ds_read_b64_tr_b16 v[86:87], v14 offset:18080
    v_mfma_f32_16x16x32_bf16 v[228:231], v[64:67], v[36:39], v[228:231]
    v_mfma_f32_16x16x32_bf16 v[232:235], v[64:67], v[40:43], v[232:235]
    v_mfma_f32_16x16x32_bf16 v[236:239], v[64:67], v[44:47], v[236:239]
    s_waitcnt lgkmcnt(8)
    v_mfma_f32_16x16x32_bf16 v[240:243], v[68:71], v[32:35], v[240:243]
    ds_read_b64_tr_b16 v[64:65], v14 offset:5184
    ds_read_b64_tr_b16 v[66:67], v14 offset:7744
    v_mfma_f32_16x16x32_bf16 v[244:247], v[68:71], v[36:39], v[244:247]
    v_mfma_f32_16x16x32_bf16 v[248:251], v[68:71], v[40:43], v[248:251]
    v_mfma_f32_16x16x32_bf16 v[252:255], v[68:71], v[44:47], v[252:255]
    s_waitcnt lgkmcnt(8)
    v_mfma_f32_16x16x32_bf16 v[96:99], v[72:75], v[48:51], v[96:99]
    ds_read_b64_tr_b16 v[68:69], v14 offset:15552
    ds_read_b64_tr_b16 v[70:71], v14 offset:18112
    v_mfma_f32_16x16x32_bf16 v[100:103], v[72:75], v[52:55], v[100:103]
    v_mfma_f32_16x16x32_bf16 v[104:107], v[72:75], v[56:59], v[104:107]
    v_mfma_f32_16x16x32_bf16 v[108:111], v[72:75], v[60:63], v[108:111]
    s_waitcnt lgkmcnt(8)
    v_mfma_f32_16x16x32_bf16 v[112:115], v[76:79], v[48:51], v[112:115]
    ds_read_b64_tr_b16 v[72:73], v14 offset:5216
    ds_read_b64_tr_b16 v[74:75], v14 offset:7776
    v_mfma_f32_16x16x32_bf16 v[116:119], v[76:79], v[52:55], v[116:119]
    v_mfma_f32_16x16x32_bf16 v[120:123], v[76:79], v[56:59], v[120:123]
    v_mfma_f32_16x16x32_bf16 v[124:127], v[76:79], v[60:63], v[124:127]
    s_waitcnt lgkmcnt(8)
    v_mfma_f32_16x16x32_bf16 v[128:131], v[80:83], v[48:51], v[128:131]
    ds_read_b64_tr_b16 v[76:77], v14 offset:15584
    ds_read_b64_tr_b16 v[78:79], v14 offset:18144
    v_mfma_f32_16x16x32_bf16 v[132:135], v[80:83], v[52:55], v[132:135]
    v_mfma_f32_16x16x32_bf16 v[136:139], v[80:83], v[56:59], v[136:139]
    v_mfma_f32_16x16x32_bf16 v[140:143], v[80:83], v[60:63], v[140:143]
    s_waitcnt lgkmcnt(8)
    v_mfma_f32_16x16x32_bf16 v[144:147], v[84:87], v[48:51], v[144:147]
    ds_read_b64_tr_b16 v[80:81], v14 offset:5248
    ds_read_b64_tr_b16 v[82:83], v14 offset:7808
    v_mfma_f32_16x16x32_bf16 v[148:151], v[84:87], v[52:55], v[148:151]
    v_mfma_f32_16x16x32_bf16 v[152:155], v[84:87], v[56:59], v[152:155]
    v_mfma_f32_16x16x32_bf16 v[156:159], v[84:87], v[60:63], v[156:159]
    s_waitcnt lgkmcnt(8)
    v_mfma_f32_16x16x32_bf16 v[160:163], v[64:67], v[48:51], v[160:163]
    ds_read_b64_tr_b16 v[84:85], v14 offset:15616
    ds_read_b64_tr_b16 v[86:87], v14 offset:18176
    v_mfma_f32_16x16x32_bf16 v[164:167], v[64:67], v[52:55], v[164:167]
    v_mfma_f32_16x16x32_bf16 v[168:171], v[64:67], v[56:59], v[168:171]
    v_mfma_f32_16x16x32_bf16 v[172:175], v[64:67], v[60:63], v[172:175]
    s_waitcnt lgkmcnt(8)
    v_mfma_f32_16x16x32_bf16 v[176:179], v[68:71], v[48:51], v[176:179]
    v_mfma_f32_16x16x32_bf16 v[180:183], v[68:71], v[52:55], v[180:183]
    v_mfma_f32_16x16x32_bf16 v[184:187], v[68:71], v[56:59], v[184:187]
    v_mfma_f32_16x16x32_bf16 v[188:191], v[68:71], v[60:63], v[188:191]
    s_waitcnt lgkmcnt(6)
    v_mfma_f32_16x16x32_bf16 v[192:195], v[72:75], v[48:51], v[192:195]
    v_mfma_f32_16x16x32_bf16 v[196:199], v[72:75], v[52:55], v[196:199]
    v_mfma_f32_16x16x32_bf16 v[200:203], v[72:75], v[56:59], v[200:203]
    v_mfma_f32_16x16x32_bf16 v[204:207], v[72:75], v[60:63], v[204:207]
    s_waitcnt lgkmcnt(0)
    s_barrier
    v_mfma_f32_16x16x32_bf16 v[208:211], v[76:79], v[48:51], v[208:211]
    ds_read_b128 v[32:35], v8 offset:0
    ds_read_b128 v[36:39], v8 offset:2048
    v_mfma_f32_16x16x32_bf16 v[212:215], v[76:79], v[52:55], v[212:215]
    ds_read_b128 v[40:43], v8 offset:4096
    ds_read_b128 v[44:47], v8 offset:6144
    v_mfma_f32_16x16x32_bf16 v[216:219], v[76:79], v[56:59], v[216:219]
    ds_read_b64_tr_b16 v[64:65], v12 offset:0
    ds_read_b64_tr_b16 v[66:67], v12 offset:2560
    v_mfma_f32_16x16x32_bf16 v[220:223], v[76:79], v[60:63], v[220:223]
    ds_read_b64_tr_b16 v[68:69], v12 offset:10368
    ds_read_b64_tr_b16 v[70:71], v12 offset:12928
    v_mfma_f32_16x16x32_bf16 v[224:227], v[80:83], v[48:51], v[224:227]
    ds_read_b64_tr_b16 v[72:73], v12 offset:32
    ds_read_b64_tr_b16 v[74:75], v12 offset:2592
    v_mfma_f32_16x16x32_bf16 v[228:231], v[80:83], v[52:55], v[228:231]
    ds_read_b64_tr_b16 v[76:77], v12 offset:10400
    ds_read_b64_tr_b16 v[78:79], v12 offset:12960
    v_mfma_f32_16x16x32_bf16 v[232:235], v[80:83], v[56:59], v[232:235]
    v_mfma_f32_16x16x32_bf16 v[236:239], v[80:83], v[60:63], v[236:239]
    v_mfma_f32_16x16x32_bf16 v[240:243], v[84:87], v[48:51], v[240:243]
    ds_read_b64_tr_b16 v[80:81], v12 offset:64
    ds_read_b64_tr_b16 v[82:83], v12 offset:2624
    v_mfma_f32_16x16x32_bf16 v[244:247], v[84:87], v[52:55], v[244:247]
    v_mfma_f32_16x16x32_bf16 v[248:251], v[84:87], v[56:59], v[248:251]
    v_mfma_f32_16x16x32_bf16 v[252:255], v[84:87], v[60:63], v[252:255]
    s_waitcnt lgkmcnt(8)
    v_mfma_f32_16x16x32_bf16 v[96:99], v[64:67], v[32:35], v[96:99]
    ds_read_b64_tr_b16 v[84:85], v12 offset:10432
    ds_read_b64_tr_b16 v[86:87], v12 offset:12992
    v_mfma_f32_16x16x32_bf16 v[100:103], v[64:67], v[36:39], v[100:103]
    ds_read_b128 v[48:51], v9 offset:0
    ds_read_b128 v[52:55], v9 offset:2048
    v_mfma_f32_16x16x32_bf16 v[104:107], v[64:67], v[40:43], v[104:107]
    ds_read_b128 v[56:59], v9 offset:4096
    ds_read_b128 v[60:63], v9 offset:6144
    v_mfma_f32_16x16x32_bf16 v[108:111], v[64:67], v[44:47], v[108:111]
    s_waitcnt lgkmcnt(12)
    v_mfma_f32_16x16x32_bf16 v[112:115], v[68:71], v[32:35], v[112:115]
    ds_read_b64_tr_b16 v[64:65], v12 offset:96
    ds_read_b64_tr_b16 v[66:67], v12 offset:2656
    v_mfma_f32_16x16x32_bf16 v[116:119], v[68:71], v[36:39], v[116:119]
    v_mfma_f32_16x16x32_bf16 v[120:123], v[68:71], v[40:43], v[120:123]
    v_mfma_f32_16x16x32_bf16 v[124:127], v[68:71], v[44:47], v[124:127]
    s_waitcnt lgkmcnt(12)
    v_mfma_f32_16x16x32_bf16 v[128:131], v[72:75], v[32:35], v[128:131]
    ds_read_b64_tr_b16 v[68:69], v12 offset:10464
    ds_read_b64_tr_b16 v[70:71], v12 offset:13024
    v_mfma_f32_16x16x32_bf16 v[132:135], v[72:75], v[36:39], v[132:135]
    v_mfma_f32_16x16x32_bf16 v[136:139], v[72:75], v[40:43], v[136:139]
    v_mfma_f32_16x16x32_bf16 v[140:143], v[72:75], v[44:47], v[140:143]
    s_waitcnt lgkmcnt(12)
    v_mfma_f32_16x16x32_bf16 v[144:147], v[76:79], v[32:35], v[144:147]
    ds_read_b64_tr_b16 v[72:73], v12 offset:128
    ds_read_b64_tr_b16 v[74:75], v12 offset:2688
    v_mfma_f32_16x16x32_bf16 v[148:151], v[76:79], v[36:39], v[148:151]
    v_mfma_f32_16x16x32_bf16 v[152:155], v[76:79], v[40:43], v[152:155]
    v_mfma_f32_16x16x32_bf16 v[156:159], v[76:79], v[44:47], v[156:159]
    s_waitcnt lgkmcnt(12)
    v_mfma_f32_16x16x32_bf16 v[160:163], v[80:83], v[32:35], v[160:163]
    ds_read_b64_tr_b16 v[76:77], v12 offset:10496
    ds_read_b64_tr_b16 v[78:79], v12 offset:13056
    v_mfma_f32_16x16x32_bf16 v[164:167], v[80:83], v[36:39], v[164:167]
    v_mfma_f32_16x16x32_bf16 v[168:171], v[80:83], v[40:43], v[168:171]
    v_mfma_f32_16x16x32_bf16 v[172:175], v[80:83], v[44:47], v[172:175]
    s_waitcnt lgkmcnt(12)
    v_mfma_f32_16x16x32_bf16 v[176:179], v[84:87], v[32:35], v[176:179]
    ds_read_b64_tr_b16 v[80:81], v12 offset:5120
    ds_read_b64_tr_b16 v[82:83], v12 offset:7680
    v_mfma_f32_16x16x32_bf16 v[180:183], v[84:87], v[36:39], v[180:183]
    v_mfma_f32_16x16x32_bf16 v[184:187], v[84:87], v[40:43], v[184:187]
    v_mfma_f32_16x16x32_bf16 v[188:191], v[84:87], v[44:47], v[188:191]
    s_waitcnt lgkmcnt(8)
    v_mfma_f32_16x16x32_bf16 v[192:195], v[64:67], v[32:35], v[192:195]
    ds_read_b64_tr_b16 v[84:85], v12 offset:15488
    ds_read_b64_tr_b16 v[86:87], v12 offset:18048
    v_mfma_f32_16x16x32_bf16 v[196:199], v[64:67], v[36:39], v[196:199]
    v_mfma_f32_16x16x32_bf16 v[200:203], v[64:67], v[40:43], v[200:203]
    v_mfma_f32_16x16x32_bf16 v[204:207], v[64:67], v[44:47], v[204:207]
    s_waitcnt lgkmcnt(8)
    v_mfma_f32_16x16x32_bf16 v[208:211], v[68:71], v[32:35], v[208:211]
    ds_read_b64_tr_b16 v[64:65], v12 offset:5152
    ds_read_b64_tr_b16 v[66:67], v12 offset:7712
    v_mfma_f32_16x16x32_bf16 v[212:215], v[68:71], v[36:39], v[212:215]
    v_mfma_f32_16x16x32_bf16 v[216:219], v[68:71], v[40:43], v[216:219]
    v_mfma_f32_16x16x32_bf16 v[220:223], v[68:71], v[44:47], v[220:223]
    s_waitcnt lgkmcnt(8)
    v_mfma_f32_16x16x32_bf16 v[224:227], v[72:75], v[32:35], v[224:227]
    ds_read_b64_tr_b16 v[68:69], v12 offset:15520
    ds_read_b64_tr_b16 v[70:71], v12 offset:18080
    v_mfma_f32_16x16x32_bf16 v[228:231], v[72:75], v[36:39], v[228:231]
    v_mfma_f32_16x16x32_bf16 v[232:235], v[72:75], v[40:43], v[232:235]
    v_mfma_f32_16x16x32_bf16 v[236:239], v[72:75], v[44:47], v[236:239]
    s_waitcnt lgkmcnt(8)
    v_mfma_f32_16x16x32_bf16 v[240:243], v[76:79], v[32:35], v[240:243]
    ds_read_b64_tr_b16 v[72:73], v12 offset:5184
    ds_read_b64_tr_b16 v[74:75], v12 offset:7744
    v_mfma_f32_16x16x32_bf16 v[244:247], v[76:79], v[36:39], v[244:247]
    v_mfma_f32_16x16x32_bf16 v[248:251], v[76:79], v[40:43], v[248:251]
    v_mfma_f32_16x16x32_bf16 v[252:255], v[76:79], v[44:47], v[252:255]
    s_waitcnt lgkmcnt(8)
    v_mfma_f32_16x16x32_bf16 v[96:99], v[80:83], v[48:51], v[96:99]
    ds_read_b64_tr_b16 v[76:77], v12 offset:15552
    ds_read_b64_tr_b16 v[78:79], v12 offset:18112
    v_mfma_f32_16x16x32_bf16 v[100:103], v[80:83], v[52:55], v[100:103]
    v_mfma_f32_16x16x32_bf16 v[104:107], v[80:83], v[56:59], v[104:107]
    v_mfma_f32_16x16x32_bf16 v[108:111], v[80:83], v[60:63], v[108:111]
    s_waitcnt lgkmcnt(8)
    v_mfma_f32_16x16x32_bf16 v[112:115], v[84:87], v[48:51], v[112:115]
    ds_read_b64_tr_b16 v[80:81], v12 offset:5216
    ds_read_b64_tr_b16 v[82:83], v12 offset:7776
    v_mfma_f32_16x16x32_bf16 v[116:119], v[84:87], v[52:55], v[116:119]
    v_mfma_f32_16x16x32_bf16 v[120:123], v[84:87], v[56:59], v[120:123]
    v_mfma_f32_16x16x32_bf16 v[124:127], v[84:87], v[60:63], v[124:127]
    s_waitcnt lgkmcnt(8)
    v_mfma_f32_16x16x32_bf16 v[128:131], v[64:67], v[48:51], v[128:131]
    ds_read_b64_tr_b16 v[84:85], v12 offset:15584
    ds_read_b64_tr_b16 v[86:87], v12 offset:18144
    v_mfma_f32_16x16x32_bf16 v[132:135], v[64:67], v[52:55], v[132:135]
    v_mfma_f32_16x16x32_bf16 v[136:139], v[64:67], v[56:59], v[136:139]
    v_mfma_f32_16x16x32_bf16 v[140:143], v[64:67], v[60:63], v[140:143]
    s_waitcnt lgkmcnt(8)
    v_mfma_f32_16x16x32_bf16 v[144:147], v[68:71], v[48:51], v[144:147]
    ds_read_b64_tr_b16 v[64:65], v12 offset:5248
    ds_read_b64_tr_b16 v[66:67], v12 offset:7808
    v_mfma_f32_16x16x32_bf16 v[148:151], v[68:71], v[52:55], v[148:151]
    v_mfma_f32_16x16x32_bf16 v[152:155], v[68:71], v[56:59], v[152:155]
    v_mfma_f32_16x16x32_bf16 v[156:159], v[68:71], v[60:63], v[156:159]
    s_waitcnt lgkmcnt(8)
    v_mfma_f32_16x16x32_bf16 v[160:163], v[72:75], v[48:51], v[160:163]
    ds_read_b64_tr_b16 v[68:69], v12 offset:15616
    ds_read_b64_tr_b16 v[70:71], v12 offset:18176
    v_mfma_f32_16x16x32_bf16 v[164:167], v[72:75], v[52:55], v[164:167]
    v_mfma_f32_16x16x32_bf16 v[168:171], v[72:75], v[56:59], v[168:171]
    v_mfma_f32_16x16x32_bf16 v[172:175], v[72:75], v[60:63], v[172:175]
    s_waitcnt lgkmcnt(8)
    v_mfma_f32_16x16x32_bf16 v[176:179], v[76:79], v[48:51], v[176:179]
    v_mfma_f32_16x16x32_bf16 v[180:183], v[76:79], v[52:55], v[180:183]
    v_mfma_f32_16x16x32_bf16 v[184:187], v[76:79], v[56:59], v[184:187]
    v_mfma_f32_16x16x32_bf16 v[188:191], v[76:79], v[60:63], v[188:191]
    s_waitcnt lgkmcnt(6)
    v_mfma_f32_16x16x32_bf16 v[192:195], v[80:83], v[48:51], v[192:195]
    v_mfma_f32_16x16x32_bf16 v[196:199], v[80:83], v[52:55], v[196:199]
    v_mfma_f32_16x16x32_bf16 v[200:203], v[80:83], v[56:59], v[200:203]
    v_mfma_f32_16x16x32_bf16 v[204:207], v[80:83], v[60:63], v[204:207]
    s_barrier
    s_waitcnt lgkmcnt(4)
    v_mfma_f32_16x16x32_bf16 v[208:211], v[84:87], v[48:51], v[208:211]
    v_mfma_f32_16x16x32_bf16 v[212:215], v[84:87], v[52:55], v[212:215]
    v_mfma_f32_16x16x32_bf16 v[216:219], v[84:87], v[56:59], v[216:219]
    v_mfma_f32_16x16x32_bf16 v[220:223], v[84:87], v[60:63], v[220:223]
    s_waitcnt lgkmcnt(2)
    v_mfma_f32_16x16x32_bf16 v[224:227], v[64:67], v[48:51], v[224:227]
    v_mfma_f32_16x16x32_bf16 v[228:231], v[64:67], v[52:55], v[228:231]
    v_mfma_f32_16x16x32_bf16 v[232:235], v[64:67], v[56:59], v[232:235]
    v_mfma_f32_16x16x32_bf16 v[236:239], v[64:67], v[60:63], v[236:239]
    s_waitcnt lgkmcnt(0)
    v_mfma_f32_16x16x32_bf16 v[240:243], v[68:71], v[48:51], v[240:243]
    v_mfma_f32_16x16x32_bf16 v[244:247], v[68:71], v[52:55], v[244:247]
    v_mfma_f32_16x16x32_bf16 v[248:251], v[68:71], v[56:59], v[248:251]
    v_mfma_f32_16x16x32_bf16 v[252:255], v[68:71], v[60:63], v[252:255]
    s_waitcnt vmcnt(0)
    ds_read_b64 v[22:23], v19 offset:0
    ds_read_b64 v[24:25], v19 offset:128
    ds_read_b64 v[26:27], v19 offset:256
    ds_read_b64 v[28:29], v19 offset:384
    ds_read_b128 v[32:35], v20 offset:0
    ds_read_b128 v[36:39], v20 offset:320
    ds_read_b128 v[40:43], v20 offset:64
    ds_read_b128 v[44:47], v20 offset:384
    ds_read_b128 v[48:51], v20 offset:128
    ds_read_b128 v[52:55], v20 offset:448
    ds_read_b128 v[56:59], v20 offset:192
    ds_read_b128 v[60:63], v20 offset:512
    ds_read_b128 v[64:67], v20 offset:256
    ds_read_b128 v[68:71], v20 offset:576
    s_waitcnt lgkmcnt(10)
    v_readfirstlane_b32 s15, v30
    s_waitcnt lgkmcnt(8)
    v_pk_fma_f32 v[96:97], v[22:23], v[32:33], v[96:97] op_sel:[0,0,0] op_sel_hi:[0,1,1] neg_lo:[1,0,0] neg_hi:[1,0,0]
    v_pk_fma_f32 v[98:99], v[22:23], v[34:35], v[98:99] op_sel:[0,0,0] op_sel_hi:[0,1,1] neg_lo:[1,0,0] neg_hi:[1,0,0]
    v_pk_fma_f32 v[112:113], v[22:23], v[36:37], v[112:113] op_sel:[0,0,0] op_sel_hi:[0,1,1] neg_lo:[1,0,0] neg_hi:[1,0,0]
    v_pk_fma_f32 v[114:115], v[22:23], v[38:39], v[114:115] op_sel:[0,0,0] op_sel_hi:[0,1,1] neg_lo:[1,0,0] neg_hi:[1,0,0]
    v_pk_mul_f32 v[96:97], v[96:97], v[112:113]
    v_pk_mul_f32 v[98:99], v[98:99], v[114:115]
    v_cvt_pk_bf16_f32 v72, v96, v97
    v_cvt_pk_bf16_f32 v73, v98, v99
    v_pk_fma_f32 v[100:101], v[24:25], v[32:33], v[100:101] op_sel:[0,0,0] op_sel_hi:[0,1,1] neg_lo:[1,0,0] neg_hi:[1,0,0]
    v_pk_fma_f32 v[102:103], v[24:25], v[34:35], v[102:103] op_sel:[0,0,0] op_sel_hi:[0,1,1] neg_lo:[1,0,0] neg_hi:[1,0,0]
    v_pk_fma_f32 v[116:117], v[24:25], v[36:37], v[116:117] op_sel:[0,0,0] op_sel_hi:[0,1,1] neg_lo:[1,0,0] neg_hi:[1,0,0]
    v_pk_fma_f32 v[118:119], v[24:25], v[38:39], v[118:119] op_sel:[0,0,0] op_sel_hi:[0,1,1] neg_lo:[1,0,0] neg_hi:[1,0,0]
    v_pk_mul_f32 v[100:101], v[100:101], v[116:117]
    v_pk_mul_f32 v[102:103], v[102:103], v[118:119]
    v_cvt_pk_bf16_f32 v74, v100, v101
    v_cvt_pk_bf16_f32 v75, v102, v103
    s_nop 1
    v_permlane32_swap_b32 v72, v74
    v_permlane32_swap_b32 v73, v75
    s_nop 1
    buffer_store_dwordx4 v[72:75], v18, s[56:59], s12 offen offset:0 sc1
    v_pk_fma_f32 v[104:105], v[26:27], v[32:33], v[104:105] op_sel:[0,0,0] op_sel_hi:[0,1,1] neg_lo:[1,0,0] neg_hi:[1,0,0]
    v_pk_fma_f32 v[106:107], v[26:27], v[34:35], v[106:107] op_sel:[0,0,0] op_sel_hi:[0,1,1] neg_lo:[1,0,0] neg_hi:[1,0,0]
    v_pk_fma_f32 v[120:121], v[26:27], v[36:37], v[120:121] op_sel:[0,0,0] op_sel_hi:[0,1,1] neg_lo:[1,0,0] neg_hi:[1,0,0]
    v_pk_fma_f32 v[122:123], v[26:27], v[38:39], v[122:123] op_sel:[0,0,0] op_sel_hi:[0,1,1] neg_lo:[1,0,0] neg_hi:[1,0,0]
    v_pk_mul_f32 v[104:105], v[104:105], v[120:121]
    v_pk_mul_f32 v[106:107], v[106:107], v[122:123]
    v_cvt_pk_bf16_f32 v76, v104, v105
    v_cvt_pk_bf16_f32 v77, v106, v107
    v_pk_fma_f32 v[108:109], v[28:29], v[32:33], v[108:109] op_sel:[0,0,0] op_sel_hi:[0,1,1] neg_lo:[1,0,0] neg_hi:[1,0,0]
    v_pk_fma_f32 v[110:111], v[28:29], v[34:35], v[110:111] op_sel:[0,0,0] op_sel_hi:[0,1,1] neg_lo:[1,0,0] neg_hi:[1,0,0]
    v_pk_fma_f32 v[124:125], v[28:29], v[36:37], v[124:125] op_sel:[0,0,0] op_sel_hi:[0,1,1] neg_lo:[1,0,0] neg_hi:[1,0,0]
    v_pk_fma_f32 v[126:127], v[28:29], v[38:39], v[126:127] op_sel:[0,0,0] op_sel_hi:[0,1,1] neg_lo:[1,0,0] neg_hi:[1,0,0]
    v_pk_mul_f32 v[108:109], v[108:109], v[124:125]
    v_pk_mul_f32 v[110:111], v[110:111], v[126:127]
    v_cvt_pk_bf16_f32 v78, v108, v109
    v_cvt_pk_bf16_f32 v79, v110, v111
    s_nop 1
    v_permlane32_swap_b32 v76, v78
    v_permlane32_swap_b32 v77, v79
    s_nop 1
    buffer_store_dwordx4 v[76:79], v18, s[56:59], s13 offen offset:0 sc1
    s_waitcnt lgkmcnt(6)
    v_pk_fma_f32 v[128:129], v[22:23], v[40:41], v[128:129] op_sel:[0,0,0] op_sel_hi:[0,1,1] neg_lo:[1,0,0] neg_hi:[1,0,0]
    v_pk_fma_f32 v[130:131], v[22:23], v[42:43], v[130:131] op_sel:[0,0,0] op_sel_hi:[0,1,1] neg_lo:[1,0,0] neg_hi:[1,0,0]
    v_pk_fma_f32 v[144:145], v[22:23], v[44:45], v[144:145] op_sel:[0,0,0] op_sel_hi:[0,1,1] neg_lo:[1,0,0] neg_hi:[1,0,0]
    v_pk_fma_f32 v[146:147], v[22:23], v[46:47], v[146:147] op_sel:[0,0,0] op_sel_hi:[0,1,1] neg_lo:[1,0,0] neg_hi:[1,0,0]
    v_pk_mul_f32 v[128:129], v[128:129], v[144:145]
    v_pk_mul_f32 v[130:131], v[130:131], v[146:147]
    v_cvt_pk_bf16_f32 v80, v128, v129
    v_cvt_pk_bf16_f32 v81, v130, v131
    v_pk_fma_f32 v[132:133], v[24:25], v[40:41], v[132:133] op_sel:[0,0,0] op_sel_hi:[0,1,1] neg_lo:[1,0,0] neg_hi:[1,0,0]
    v_pk_fma_f32 v[134:135], v[24:25], v[42:43], v[134:135] op_sel:[0,0,0] op_sel_hi:[0,1,1] neg_lo:[1,0,0] neg_hi:[1,0,0]
    v_pk_fma_f32 v[148:149], v[24:25], v[44:45], v[148:149] op_sel:[0,0,0] op_sel_hi:[0,1,1] neg_lo:[1,0,0] neg_hi:[1,0,0]
    v_pk_fma_f32 v[150:151], v[24:25], v[46:47], v[150:151] op_sel:[0,0,0] op_sel_hi:[0,1,1] neg_lo:[1,0,0] neg_hi:[1,0,0]
    v_pk_mul_f32 v[132:133], v[132:133], v[148:149]
    v_pk_mul_f32 v[134:135], v[134:135], v[150:151]
    v_cvt_pk_bf16_f32 v82, v132, v133
    v_cvt_pk_bf16_f32 v83, v134, v135
    s_nop 1
    v_permlane32_swap_b32 v80, v82
    v_permlane32_swap_b32 v81, v83
    s_nop 1
    buffer_store_dwordx4 v[80:83], v18, s[56:59], s12 offen offset:512 sc1
    v_pk_fma_f32 v[136:137], v[26:27], v[40:41], v[136:137] op_sel:[0,0,0] op_sel_hi:[0,1,1] neg_lo:[1,0,0] neg_hi:[1,0,0]
    v_pk_fma_f32 v[138:139], v[26:27], v[42:43], v[138:139] op_sel:[0,0,0] op_sel_hi:[0,1,1] neg_lo:[1,0,0] neg_hi:[1,0,0]
    v_pk_fma_f32 v[152:153], v[26:27], v[44:45], v[152:153] op_sel:[0,0,0] op_sel_hi:[0,1,1] neg_lo:[1,0,0] neg_hi:[1,0,0]
    v_pk_fma_f32 v[154:155], v[26:27], v[46:47], v[154:155] op_sel:[0,0,0] op_sel_hi:[0,1,1] neg_lo:[1,0,0] neg_hi:[1,0,0]
    v_pk_mul_f32 v[136:137], v[136:137], v[152:153]
    v_pk_mul_f32 v[138:139], v[138:139], v[154:155]
    v_cvt_pk_bf16_f32 v84, v136, v137
    v_cvt_pk_bf16_f32 v85, v138, v139
    v_pk_fma_f32 v[140:141], v[28:29], v[40:41], v[140:141] op_sel:[0,0,0] op_sel_hi:[0,1,1] neg_lo:[1,0,0] neg_hi:[1,0,0]
    v_pk_fma_f32 v[142:143], v[28:29], v[42:43], v[142:143] op_sel:[0,0,0] op_sel_hi:[0,1,1] neg_lo:[1,0,0] neg_hi:[1,0,0]
    v_pk_fma_f32 v[156:157], v[28:29], v[44:45], v[156:157] op_sel:[0,0,0] op_sel_hi:[0,1,1] neg_lo:[1,0,0] neg_hi:[1,0,0]
    v_pk_fma_f32 v[158:159], v[28:29], v[46:47], v[158:159] op_sel:[0,0,0] op_sel_hi:[0,1,1] neg_lo:[1,0,0] neg_hi:[1,0,0]
    v_pk_mul_f32 v[140:141], v[140:141], v[156:157]
    v_pk_mul_f32 v[142:143], v[142:143], v[158:159]
    v_cvt_pk_bf16_f32 v86, v140, v141
    v_cvt_pk_bf16_f32 v87, v142, v143
    s_nop 1
    v_permlane32_swap_b32 v84, v86
    v_permlane32_swap_b32 v85, v87
    s_nop 1
    buffer_store_dwordx4 v[84:87], v18, s[56:59], s13 offen offset:512 sc1
    s_waitcnt lgkmcnt(4)
    v_pk_fma_f32 v[160:161], v[22:23], v[48:49], v[160:161] op_sel:[0,0,0] op_sel_hi:[0,1,1] neg_lo:[1,0,0] neg_hi:[1,0,0]
    v_pk_fma_f32 v[162:163], v[22:23], v[50:51], v[162:163] op_sel:[0,0,0] op_sel_hi:[0,1,1] neg_lo:[1,0,0] neg_hi:[1,0,0]
    v_pk_fma_f32 v[176:177], v[22:23], v[52:53], v[176:177] op_sel:[0,0,0] op_sel_hi:[0,1,1] neg_lo:[1,0,0] neg_hi:[1,0,0]
    v_pk_fma_f32 v[178:179], v[22:23], v[54:55], v[178:179] op_sel:[0,0,0] op_sel_hi:[0,1,1] neg_lo:[1,0,0] neg_hi:[1,0,0]
    v_pk_mul_f32 v[160:161], v[160:161], v[176:177]
    v_pk_mul_f32 v[162:163], v[162:163], v[178:179]
    v_cvt_pk_bf16_f32 v88, v160, v161
    v_cvt_pk_bf16_f32 v89, v162, v163
    v_pk_fma_f32 v[164:165], v[24:25], v[48:49], v[164:165] op_sel:[0,0,0] op_sel_hi:[0,1,1] neg_lo:[1,0,0] neg_hi:[1,0,0]
    v_pk_fma_f32 v[166:167], v[24:25], v[50:51], v[166:167] op_sel:[0,0,0] op_sel_hi:[0,1,1] neg_lo:[1,0,0] neg_hi:[1,0,0]
    v_pk_fma_f32 v[180:181], v[24:25], v[52:53], v[180:181] op_sel:[0,0,0] op_sel_hi:[0,1,1] neg_lo:[1,0,0] neg_hi:[1,0,0]
    v_pk_fma_f32 v[182:183], v[24:25], v[54:55], v[182:183] op_sel:[0,0,0] op_sel_hi:[0,1,1] neg_lo:[1,0,0] neg_hi:[1,0,0]
    v_pk_mul_f32 v[164:165], v[164:165], v[180:181]
    v_pk_mul_f32 v[166:167], v[166:167], v[182:183]
    v_cvt_pk_bf16_f32 v90, v164, v165
    v_cvt_pk_bf16_f32 v91, v166, v167
    s_nop 1
    v_permlane32_swap_b32 v88, v90
    v_permlane32_swap_b32 v89, v91
    s_nop 1
    buffer_store_dwordx4 v[88:91], v18, s[56:59], s12 offen offset:1024 sc1
    v_pk_fma_f32 v[168:169], v[26:27], v[48:49], v[168:169] op_sel:[0,0,0] op_sel_hi:[0,1,1] neg_lo:[1,0,0] neg_hi:[1,0,0]
    v_pk_fma_f32 v[170:171], v[26:27], v[50:51], v[170:171] op_sel:[0,0,0] op_sel_hi:[0,1,1] neg_lo:[1,0,0] neg_hi:[1,0,0]
    v_pk_fma_f32 v[184:185], v[26:27], v[52:53], v[184:185] op_sel:[0,0,0] op_sel_hi:[0,1,1] neg_lo:[1,0,0] neg_hi:[1,0,0]
    v_pk_fma_f32 v[186:187], v[26:27], v[54:55], v[186:187] op_sel:[0,0,0] op_sel_hi:[0,1,1] neg_lo:[1,0,0] neg_hi:[1,0,0]
    v_pk_mul_f32 v[168:169], v[168:169], v[184:185]
    v_pk_mul_f32 v[170:171], v[170:171], v[186:187]
    v_cvt_pk_bf16_f32 v92, v168, v169
    v_cvt_pk_bf16_f32 v93, v170, v171
    v_pk_fma_f32 v[172:173], v[28:29], v[48:49], v[172:173] op_sel:[0,0,0] op_sel_hi:[0,1,1] neg_lo:[1,0,0] neg_hi:[1,0,0]
    v_pk_fma_f32 v[174:175], v[28:29], v[50:51], v[174:175] op_sel:[0,0,0] op_sel_hi:[0,1,1] neg_lo:[1,0,0] neg_hi:[1,0,0]
    v_pk_fma_f32 v[188:189], v[28:29], v[52:53], v[188:189] op_sel:[0,0,0] op_sel_hi:[0,1,1] neg_lo:[1,0,0] neg_hi:[1,0,0]
    v_pk_fma_f32 v[190:191], v[28:29], v[54:55], v[190:191] op_sel:[0,0,0] op_sel_hi:[0,1,1] neg_lo:[1,0,0] neg_hi:[1,0,0]
    v_pk_mul_f32 v[172:173], v[172:173], v[188:189]
    v_pk_mul_f32 v[174:175], v[174:175], v[190:191]
    v_cvt_pk_bf16_f32 v94, v172, v173
    v_cvt_pk_bf16_f32 v95, v174, v175
    s_nop 1
    v_permlane32_swap_b32 v92, v94
    v_permlane32_swap_b32 v93, v95
    s_nop 1
    buffer_store_dwordx4 v[92:95], v18, s[56:59], s13 offen offset:1024 sc1
    s_waitcnt lgkmcnt(2)
    v_pk_fma_f32 v[192:193], v[22:23], v[56:57], v[192:193] op_sel:[0,0,0] op_sel_hi:[0,1,1] neg_lo:[1,0,0] neg_hi:[1,0,0]
    v_pk_fma_f32 v[194:195], v[22:23], v[58:59], v[194:195] op_sel:[0,0,0] op_sel_hi:[0,1,1] neg_lo:[1,0,0] neg_hi:[1,0,0]
    v_pk_fma_f32 v[208:209], v[22:23], v[60:61], v[208:209] op_sel:[0,0,0] op_sel_hi:[0,1,1] neg_lo:[1,0,0] neg_hi:[1,0,0]
    v_pk_fma_f32 v[210:211], v[22:23], v[62:63], v[210:211] op_sel:[0,0,0] op_sel_hi:[0,1,1] neg_lo:[1,0,0] neg_hi:[1,0,0]
    v_pk_mul_f32 v[192:193], v[192:193], v[208:209]
    v_pk_mul_f32 v[194:195], v[194:195], v[210:211]
    v_cvt_pk_bf16_f32 v72, v192, v193
    v_cvt_pk_bf16_f32 v73, v194, v195
    v_pk_fma_f32 v[196:197], v[24:25], v[56:57], v[196:197] op_sel:[0,0,0] op_sel_hi:[0,1,1] neg_lo:[1,0,0] neg_hi:[1,0,0]
    v_pk_fma_f32 v[198:199], v[24:25], v[58:59], v[198:199] op_sel:[0,0,0] op_sel_hi:[0,1,1] neg_lo:[1,0,0] neg_hi:[1,0,0]
    v_pk_fma_f32 v[212:213], v[24:25], v[60:61], v[212:213] op_sel:[0,0,0] op_sel_hi:[0,1,1] neg_lo:[1,0,0] neg_hi:[1,0,0]
    v_pk_fma_f32 v[214:215], v[24:25], v[62:63], v[214:215] op_sel:[0,0,0] op_sel_hi:[0,1,1] neg_lo:[1,0,0] neg_hi:[1,0,0]
    v_pk_mul_f32 v[196:197], v[196:197], v[212:213]
    v_pk_mul_f32 v[198:199], v[198:199], v[214:215]
    v_cvt_pk_bf16_f32 v74, v196, v197
    v_cvt_pk_bf16_f32 v75, v198, v199
    s_nop 1
    v_permlane32_swap_b32 v72, v74
    v_permlane32_swap_b32 v73, v75
    s_nop 1
    buffer_store_dwordx4 v[72:75], v18, s[56:59], s12 offen offset:1536 sc1
    v_pk_fma_f32 v[200:201], v[26:27], v[56:57], v[200:201] op_sel:[0,0,0] op_sel_hi:[0,1,1] neg_lo:[1,0,0] neg_hi:[1,0,0]
    v_pk_fma_f32 v[202:203], v[26:27], v[58:59], v[202:203] op_sel:[0,0,0] op_sel_hi:[0,1,1] neg_lo:[1,0,0] neg_hi:[1,0,0]
    v_pk_fma_f32 v[216:217], v[26:27], v[60:61], v[216:217] op_sel:[0,0,0] op_sel_hi:[0,1,1] neg_lo:[1,0,0] neg_hi:[1,0,0]
    v_pk_fma_f32 v[218:219], v[26:27], v[62:63], v[218:219] op_sel:[0,0,0] op_sel_hi:[0,1,1] neg_lo:[1,0,0] neg_hi:[1,0,0]
    v_pk_mul_f32 v[200:201], v[200:201], v[216:217]
    v_pk_mul_f32 v[202:203], v[202:203], v[218:219]
    v_cvt_pk_bf16_f32 v76, v200, v201
    v_cvt_pk_bf16_f32 v77, v202, v203
    v_pk_fma_f32 v[204:205], v[28:29], v[56:57], v[204:205] op_sel:[0,0,0] op_sel_hi:[0,1,1] neg_lo:[1,0,0] neg_hi:[1,0,0]
    v_pk_fma_f32 v[206:207], v[28:29], v[58:59], v[206:207] op_sel:[0,0,0] op_sel_hi:[0,1,1] neg_lo:[1,0,0] neg_hi:[1,0,0]
    v_pk_fma_f32 v[220:221], v[28:29], v[60:61], v[220:221] op_sel:[0,0,0] op_sel_hi:[0,1,1] neg_lo:[1,0,0] neg_hi:[1,0,0]
    v_pk_fma_f32 v[222:223], v[28:29], v[62:63], v[222:223] op_sel:[0,0,0] op_sel_hi:[0,1,1] neg_lo:[1,0,0] neg_hi:[1,0,0]
    v_pk_mul_f32 v[204:205], v[204:205], v[220:221]
    v_pk_mul_f32 v[206:207], v[206:207], v[222:223]
    v_cvt_pk_bf16_f32 v78, v204, v205
    v_cvt_pk_bf16_f32 v79, v206, v207
    s_nop 1
    v_permlane32_swap_b32 v76, v78
    v_permlane32_swap_b32 v77, v79
    s_nop 1
    buffer_store_dwordx4 v[76:79], v18, s[56:59], s13 offen offset:1536 sc1
    s_waitcnt lgkmcnt(0)
    v_pk_fma_f32 v[224:225], v[22:23], v[64:65], v[224:225] op_sel:[0,0,0] op_sel_hi:[0,1,1] neg_lo:[1,0,0] neg_hi:[1,0,0]
    v_pk_fma_f32 v[226:227], v[22:23], v[66:67], v[226:227] op_sel:[0,0,0] op_sel_hi:[0,1,1] neg_lo:[1,0,0] neg_hi:[1,0,0]
    v_pk_fma_f32 v[240:241], v[22:23], v[68:69], v[240:241] op_sel:[0,0,0] op_sel_hi:[0,1,1] neg_lo:[1,0,0] neg_hi:[1,0,0]
    v_pk_fma_f32 v[242:243], v[22:23], v[70:71], v[242:243] op_sel:[0,0,0] op_sel_hi:[0,1,1] neg_lo:[1,0,0] neg_hi:[1,0,0]
    v_pk_mul_f32 v[224:225], v[224:225], v[240:241]
    v_pk_mul_f32 v[226:227], v[226:227], v[242:243]
    v_cvt_pk_bf16_f32 v80, v224, v225
    v_cvt_pk_bf16_f32 v81, v226, v227
    v_pk_fma_f32 v[228:229], v[24:25], v[64:65], v[228:229] op_sel:[0,0,0] op_sel_hi:[0,1,1] neg_lo:[1,0,0] neg_hi:[1,0,0]
    v_pk_fma_f32 v[230:231], v[24:25], v[66:67], v[230:231] op_sel:[0,0,0] op_sel_hi:[0,1,1] neg_lo:[1,0,0] neg_hi:[1,0,0]
    v_pk_fma_f32 v[244:245], v[24:25], v[68:69], v[244:245] op_sel:[0,0,0] op_sel_hi:[0,1,1] neg_lo:[1,0,0] neg_hi:[1,0,0]
    v_pk_fma_f32 v[246:247], v[24:25], v[70:71], v[246:247] op_sel:[0,0,0] op_sel_hi:[0,1,1] neg_lo:[1,0,0] neg_hi:[1,0,0]
    v_pk_mul_f32 v[228:229], v[228:229], v[244:245]
    v_pk_mul_f32 v[230:231], v[230:231], v[246:247]
    v_cvt_pk_bf16_f32 v82, v228, v229
    v_cvt_pk_bf16_f32 v83, v230, v231
    s_nop 1
    v_permlane32_swap_b32 v80, v82
    v_permlane32_swap_b32 v81, v83
    s_nop 1
    buffer_store_dwordx4 v[80:83], v18, s[56:59], s12 offen offset:2048 sc1
    v_pk_fma_f32 v[232:233], v[26:27], v[64:65], v[232:233] op_sel:[0,0,0] op_sel_hi:[0,1,1] neg_lo:[1,0,0] neg_hi:[1,0,0]
    v_pk_fma_f32 v[234:235], v[26:27], v[66:67], v[234:235] op_sel:[0,0,0] op_sel_hi:[0,1,1] neg_lo:[1,0,0] neg_hi:[1,0,0]
    v_pk_fma_f32 v[248:249], v[26:27], v[68:69], v[248:249] op_sel:[0,0,0] op_sel_hi:[0,1,1] neg_lo:[1,0,0] neg_hi:[1,0,0]
    v_pk_fma_f32 v[250:251], v[26:27], v[70:71], v[250:251] op_sel:[0,0,0] op_sel_hi:[0,1,1] neg_lo:[1,0,0] neg_hi:[1,0,0]
    v_pk_mul_f32 v[232:233], v[232:233], v[248:249]
    v_pk_mul_f32 v[234:235], v[234:235], v[250:251]
    v_cvt_pk_bf16_f32 v84, v232, v233
    v_cvt_pk_bf16_f32 v85, v234, v235
    v_pk_fma_f32 v[236:237], v[28:29], v[64:65], v[236:237] op_sel:[0,0,0] op_sel_hi:[0,1,1] neg_lo:[1,0,0] neg_hi:[1,0,0]
    v_pk_fma_f32 v[238:239], v[28:29], v[66:67], v[238:239] op_sel:[0,0,0] op_sel_hi:[0,1,1] neg_lo:[1,0,0] neg_hi:[1,0,0]
    v_pk_fma_f32 v[252:253], v[28:29], v[68:69], v[252:253] op_sel:[0,0,0] op_sel_hi:[0,1,1] neg_lo:[1,0,0] neg_hi:[1,0,0]
    v_pk_fma_f32 v[254:255], v[28:29], v[70:71], v[254:255] op_sel:[0,0,0] op_sel_hi:[0,1,1] neg_lo:[1,0,0] neg_hi:[1,0,0]
    v_pk_mul_f32 v[236:237], v[236:237], v[252:253]
    v_pk_mul_f32 v[238:239], v[238:239], v[254:255]
    v_cvt_pk_bf16_f32 v86, v236, v237
    v_cvt_pk_bf16_f32 v87, v238, v239
    s_nop 1
    v_permlane32_swap_b32 v84, v86
    v_permlane32_swap_b32 v85, v87
    s_nop 1
    buffer_store_dwordx4 v[84:87], v18, s[56:59], s13 offen offset:2048 sc1
    s_movk_i32 s101, 88
    s_branch parallel_sum__ssm_conv_s5__glu_gated_bilinear__prompt_kernel_p2c
parallel_sum__ssm_conv_s5__glu_gated_bilinear__prompt_kernel_ssm_b:
    s_and_b32 s80, s14, 1
    s_cmp_lt_u32 s14, 2
    s_cselect_b32 s52, s22, s24
    s_cselect_b32 s53, s23, s25
    s_mov_b32 s54, 0xc8000
    s_mov_b32 s55, 0x00020000
    s_lshl_b32 s100, s14, 12
    s_add_u32 s100, s100, 32768
    s_mul_i32 s101, s7, 81920
    v_lshrrev_b32 v2, 3, v1
    s_lshl_b32 s11, s80, 5
    v_add_u32 v3, s11, v2
    v_mul_u32_u24 v3, 1280, v3
    v_lshl_add_u32 v6, v4, 4, v3
    v_lshl_add_u32 v7, v5, 4, v3
    v_add_u32 v240, 0, v6
    v_add_u32 v241, 9216, v6
    v_add_u32 v242, 18432, v7
    v_add_u32 v243, 27648, v7
    s_cmp_lt_u32 s5, 4
    s_cbranch_scc1 parallel_sum__ssm_conv_s5__glu_gated_bilinear__prompt_kernel_cssm
    s_mov_b32 m0, s100
    buffer_load_dwordx4 v240, s[52:55], s101 offen offset:0 lds
    buffer_load_dwordx4 v241, s[52:55], s101 offen offset:1024 lds
    buffer_load_dwordx4 v242, s[52:55], s101 offen offset:2048 lds
    buffer_load_dwordx4 v243, s[52:55], s101 offen offset:3072 lds
    s_branch parallel_sum__ssm_conv_s5__glu_gated_bilinear__prompt_kernel_hssm
parallel_sum__ssm_conv_s5__glu_gated_bilinear__prompt_kernel_cssm:
    s_setprio 2
    v_and_b32 v7, 31, v1
    s_lshl_b32 s11, s7, 6
    v_add_u32 v3, s11, v7
    v_lshlrev_b32 v3, 1, v3
    s_mov_b32 s68, s18
    s_mov_b32 s69, s19
    s_mov_b32 s70, 0x500
    s_mov_b32 s71, 0x00020000
    buffer_load_ushort v80, v3, s[68:71], 0 offen offset:0
    buffer_load_ushort v83, v3, s[68:71], 0 offen offset:64
    s_mov_b32 s68, s20
    s_mov_b32 s69, s21
    s_mov_b32 s70, 0x500
    s_mov_b32 s71, 0x00020000
    buffer_load_ushort v81, v3, s[68:71], 0 offen offset:0
    buffer_load_ushort v84, v3, s[68:71], 0 offen offset:64
    s_mov_b32 s68, s30
    s_mov_b32 s69, s31
    s_mov_b32 s70, 0x500
    s_mov_b32 s71, 0x00020000
    buffer_load_ushort v82, v3, s[68:71], 0 offen offset:0
    buffer_load_ushort v85, v3, s[68:71], 0 offen offset:64
    v_lshrrev_b32 v2, 5, v1
    v_and_b32 v7, 31, v1
    v_bfe_u32 v3, v7, 2, 1
    v_lshlrev_b32 v3, 5, v3
    v_and_b32 v4, 1, v7
    v_lshl_or_b32 v3, v4, 4, v3
    v_bfe_u32 v4, v7, 3, 2
    v_lshl_or_b32 v3, v4, 1, v3
    v_bfe_u32 v4, v7, 1, 1
    v_or_b32 v3, v3, v4
    s_lshl_b32 s11, s5, 6
    v_add_u32 v3, s11, v3
    v_bfe_u32 v4, v3, 1, 2
    v_bfe_u32 v5, v3, 4, 1
    v_lshl_or_b32 v4, v5, 2, v4
    v_xor_b32 v4, v4, v2
    v_lshlrev_b32 v5, 7, v3
    v_xor_b32 v6, 0, v4
    v_lshl_add_u32 v8, v6, 4, v5
    v_add_u32 v12, 0x1a100, v8
    v_xor_b32 v6, 2, v4
    v_lshl_add_u32 v9, v6, 4, v5
    v_add_u32 v13, 0x1a100, v9
    v_xor_b32 v6, 4, v4
    v_lshl_add_u32 v10, v6, 4, v5
    v_add_u32 v14, 0x1a100, v10
    v_xor_b32 v6, 6, v4
    v_lshl_add_u32 v11, v6, 4, v5
    v_add_u32 v15, 0x1a100, v11
    v_bfe_u32 v4, v7, 1, 2
    v_bfe_u32 v5, v7, 4, 1
    v_lshl_or_b32 v4, v5, 2, v4
    v_xor_b32 v4, v4, v2
    v_lshlrev_b32 v5, 7, v7
    v_add_u32 v5, 32768, v5
    v_xor_b32 v6, 0, v4
    v_lshl_add_u32 v16, v6, 4, v5
    v_add_u32 v20, 0xd080, v16
    v_add_u32 v24, 0x1a100, v16
    v_xor_b32 v6, 2, v4
    v_lshl_add_u32 v17, v6, 4, v5
    v_add_u32 v21, 0xd080, v17
    v_add_u32 v25, 0x1a100, v17
    v_xor_b32 v6, 4, v4
    v_lshl_add_u32 v18, v6, 4, v5
    v_add_u32 v22, 0xd080, v18
    v_add_u32 v26, 0x1a100, v18
    v_xor_b32 v6, 6, v4
    v_lshl_add_u32 v19, v6, 4, v5
    v_add_u32 v23, 0xd080, v19
    v_add_u32 v27, 0x1a100, v19
    s_lshl_b32 s11, s5, 8
    v_lshl_add_u32 v108, v2, 7, s11
    v_add_u32 v108, 0xd080, v108
    v_lshlrev_b32 v109, 2, v7
    v_add_u32 v109, 0xd880, v109
    s_lshl_b32 s11, s5, 4
    s_add_u32 s11, s11, 0x9000
    v_lshl_add_u32 v110, v2, 3, s11
    v_lshl_add_u32 v110, v7, 6, v110
    v_lshlrev_b32 v111, 6, v1
    v_add_u32 v111, 0x9000, v111
    s_mul_i32 s11, s5, 9216
    v_mul_u32_u24 v112, 144, v7
    v_lshl_add_u32 v112, v2, 6, v112
    v_add_u32 v112, s11, v112
    v_lshrrev_b32 v4, 4, v1
    v_bfe_u32 v5, v1, 2, 2
    v_lshl_add_u32 v4, v4, 3, v5
    v_mul_u32_u24 v113, 144, v4
    v_and_b32 v4, 3, v1
    v_lshl_add_u32 v113, v4, 3, v113
    v_add_u32 v113, s11, v113
    v_lshlrev_b32 v114, 4, v1
    s_lshl_b32 s12, s6, 4
    s_lshl_b32 s13, s5, 2
    s_add_u32 s12, s12, s13
    s_mul_i32 s12, s12, 96256
    s_lshl_b32 s13, s7, 11
    s_add_u32 s12, s12, s13
    s_waitcnt vmcnt(0)
    v_lshlrev_b32 v80, 16, v80
    v_lshlrev_b32 v81, 16, v81
    v_lshlrev_b32 v82, 16, v82
    v_mul_f32 v116, 0x3fb8aa3b, v82
    v_exp_f32 v116, v116
    s_nop 0
    v_cvt_pk_bf16_f32 v116, v116, v116
    v_lshlrev_b32 v116, 16, v116
    v_mul_f32 v117, v116, v80
    v_mul_f32 v118, v116, v81
    v_mul_f32 v117, 0x3fb8aa3b, v117
    v_exp_f32 v117, v117
    v_mul_f32 v118, 0x3e22f983, v118
    v_fract_f32 v118, v118
    v_cos_f32 v119, v118
    v_sin_f32 v118, v118
    s_nop 0
    v_mul_f32 v88, v117, v119
    v_mul_f32 v89, v117, v118
    v_add_f32 v116, -1.0, v88
    v_mul_f32 v117, v80, v80
    v_fmac_f32 v117, v81, v81
    v_rcp_f32 v117, v117
    v_mul_f32 v118, v116, v80
    v_fmac_f32 v118, v89, v81
    v_mul_f32 v119, v89, v80
    v_fma_f32 v119, -v116, v81, v119
    v_add_f32 v117, v117, v117
    v_mul_f32 v94, v118, v117
    v_mul_f32 v95, v119, v117
    v_mul_f32 v116, v89, v89
    v_mul_f32 v117, v88, v89
    v_fma_f32 v90, v88, v88, -v116
    v_add_f32 v91, v117, v117
    v_mul_f32 v116, v91, v91
    v_mul_f32 v117, v90, v91
    v_fma_f32 v90, v90, v90, -v116
    v_add_f32 v91, v117, v117
    v_mul_f32 v116, v91, v91
    v_mul_f32 v117, v90, v91
    v_fma_f32 v90, v90, v90, -v116
    v_add_f32 v91, v117, v117
    v_mul_f32 v116, v91, v91
    v_mul_f32 v117, v90, v91
    v_fma_f32 v90, v90, v90, -v116
    v_add_f32 v91, v117, v117
    v_mul_f32 v116, v91, v91
    v_mul_f32 v117, v90, v91
    v_fma_f32 v92, v90, v90, -v116
    v_add_f32 v93, v117, v117
    v_mul_f32 v116, v93, v93
    v_mul_f32 v117, v92, v93
    v_fma_f32 v92, v92, v92, -v116
    v_add_f32 v93, v117, v117
    v_mul_f32 v116, v93, v93
    v_mul_f32 v117, v92, v93
    v_fma_f32 v92, v92, v92, -v116
    v_add_f32 v93, v117, v117
    v_mul_f32 v116, v93, v93
    v_mul_f32 v117, v92, v93
    v_fma_f32 v92, v92, v92, -v116
    v_add_f32 v93, v117, v117
    v_lshlrev_b32 v83, 16, v83
    v_lshlrev_b32 v84, 16, v84
    v_lshlrev_b32 v85, 16, v85
    v_mul_f32 v116, 0x3fb8aa3b, v85
    v_exp_f32 v116, v116
    s_nop 0
    v_cvt_pk_bf16_f32 v116, v116, v116
    v_lshlrev_b32 v116, 16, v116
    v_mul_f32 v117, v116, v83
    v_mul_f32 v118, v116, v84
    v_mul_f32 v117, 0x3fb8aa3b, v117
    v_exp_f32 v117, v117
    v_mul_f32 v118, 0x3e22f983, v118
    v_fract_f32 v118, v118
    v_cos_f32 v119, v118
    v_sin_f32 v118, v118
    s_nop 0
    v_mul_f32 v96, v117, v119
    v_mul_f32 v97, v117, v118
    v_add_f32 v116, -1.0, v96
    v_mul_f32 v117, v83, v83
    v_fmac_f32 v117, v84, v84
    v_rcp_f32 v117, v117
    v_mul_f32 v118, v116, v83
    v_fmac_f32 v118, v97, v84
    v_mul_f32 v119, v97, v83
    v_fma_f32 v119, -v116, v84, v119
    v_add_f32 v117, v117, v117
    v_mul_f32 v102, v118, v117
    v_mul_f32 v103, v119, v117
    v_mul_f32 v116, v97, v97
    v_mul_f32 v117, v96, v97
    v_fma_f32 v98, v96, v96, -v116
    v_add_f32 v99, v117, v117
    v_mul_f32 v116, v99, v99
    v_mul_f32 v117, v98, v99
    v_fma_f32 v98, v98, v98, -v116
    v_add_f32 v99, v117, v117
    v_mul_f32 v116, v99, v99
    v_mul_f32 v117, v98, v99
    v_fma_f32 v98, v98, v98, -v116
    v_add_f32 v99, v117, v117
    v_mul_f32 v116, v99, v99
    v_mul_f32 v117, v98, v99
    v_fma_f32 v98, v98, v98, -v116
    v_add_f32 v99, v117, v117
    v_mul_f32 v116, v99, v99
    v_mul_f32 v117, v98, v99
    v_fma_f32 v100, v98, v98, -v116
    v_add_f32 v101, v117, v117
    v_mul_f32 v116, v101, v101
    v_mul_f32 v117, v100, v101
    v_fma_f32 v100, v100, v100, -v116
    v_add_f32 v101, v117, v117
    v_mul_f32 v116, v101, v101
    v_mul_f32 v117, v100, v101
    v_fma_f32 v100, v100, v100, -v116
    v_add_f32 v101, v117, v117
    v_mul_f32 v116, v101, v101
    v_mul_f32 v117, v100, v101
    v_fma_f32 v100, v100, v100, -v116
    v_add_f32 v101, v117, v117
    v_cmp_eq_u32 vcc, 1, v2
    s_nop 1
    v_cndmask_b32 v104, v90, v98, vcc
    v_cndmask_b32 v105, v91, v99, vcc
    v_cndmask_b32 v106, v92, v100, vcc
    v_cndmask_b32 v107, v93, v101, vcc
    s_cmp_lg_u32 s5, 0
    s_cbranch_scc1 tw_2
    s_mov_b32 s72, s46
    s_mov_b32 s73, s47
    s_mov_b32 s74, 0x1a00000
    s_mov_b32 s75, 0x00020000
    s_mov_b32 s76, s42
    s_mov_b32 s77, s43
    s_mov_b32 s78, 0x500000
    s_mov_b32 s79, 0x00020000
    v_lshlrev_b32 v120, 21, v1
    v_min_u32 v121, 0x4ffffc, v120
    s_mov_b64 exec, 0x1fff
    buffer_load_dword v120, v120, s[72:75], 0 offen
    s_mov_b64 exec, 15
    buffer_load_dword v121, v121, s[76:79], 0 offen
    s_mov_b64 exec, -1
tw_2:
    s_barrier
    ds_read_b128 v[32:35], v8 offset:0
    ds_read_b128 v[40:43], v16 offset:0
    ds_read_b128 v[36:39], v8 offset:1024
    ds_read_b128 v[44:47], v16 offset:8192
    ds_read_b128 v[48:51], v16 offset:4096
    ds_read_b128 v[52:55], v16 offset:12288
    s_waitcnt lgkmcnt(5)
    s_waitcnt lgkmcnt(4)
    v_mfma_f32_32x32x16_bf16 v[128:143], v[32:35], v[40:43], 0
    ds_read_b128 v[56:59], v9 offset:0
    s_waitcnt lgkmcnt(4)
    v_mfma_f32_32x32x16_bf16 v[144:159], v[36:39], v[40:43], 0
    ds_read_b128 v[64:67], v17 offset:0
    s_waitcnt lgkmcnt(4)
    v_mfma_f32_32x32x16_bf16 v[160:175], v[32:35], v[44:47], 0
    ds_read_b128 v[60:63], v9 offset:1024
    v_mfma_f32_32x32x16_bf16 v[176:191], v[36:39], v[44:47], 0
    ds_read_b128 v[68:71], v17 offset:8192
    s_waitcnt lgkmcnt(5)
    v_mfma_f32_32x32x16_bf16 v[192:207], v[32:35], v[48:51], 0
    ds_read_b128 v[72:75], v17 offset:4096
    v_mfma_f32_32x32x16_bf16 v[208:223], v[36:39], v[48:51], 0
    ds_read_b128 v[76:79], v17 offset:12288
    s_waitcnt lgkmcnt(6)
    v_mfma_f32_32x32x16_bf16 v[224:239], v[32:35], v[52:55], 0
    v_mfma_f32_32x32x16_bf16 v[240:255], v[36:39], v[52:55], 0
    s_waitcnt lgkmcnt(5)
    s_waitcnt lgkmcnt(4)
    v_mfma_f32_32x32x16_bf16 v[128:143], v[56:59], v[64:67], v[128:143]
    ds_read_b128 v[32:35], v10 offset:0
    s_waitcnt lgkmcnt(4)
    v_mfma_f32_32x32x16_bf16 v[144:159], v[60:63], v[64:67], v[144:159]
    ds_read_b128 v[40:43], v18 offset:0
    s_waitcnt lgkmcnt(4)
    v_mfma_f32_32x32x16_bf16 v[160:175], v[56:59], v[68:71], v[160:175]
    ds_read_b128 v[36:39], v10 offset:1024
    v_mfma_f32_32x32x16_bf16 v[176:191], v[60:63], v[68:71], v[176:191]
    ds_read_b128 v[44:47], v18 offset:8192
    s_waitcnt lgkmcnt(5)
    v_mfma_f32_32x32x16_bf16 v[192:207], v[56:59], v[72:75], v[192:207]
    ds_read_b128 v[48:51], v18 offset:4096
    v_mfma_f32_32x32x16_bf16 v[208:223], v[60:63], v[72:75], v[208:223]
    ds_read_b128 v[52:55], v18 offset:12288
    s_waitcnt lgkmcnt(6)
    v_mfma_f32_32x32x16_bf16 v[224:239], v[56:59], v[76:79], v[224:239]
    v_mfma_f32_32x32x16_bf16 v[240:255], v[60:63], v[76:79], v[240:255]
    s_waitcnt lgkmcnt(5)
    s_waitcnt lgkmcnt(4)
    v_mfma_f32_32x32x16_bf16 v[128:143], v[32:35], v[40:43], v[128:143]
    ds_read_b128 v[56:59], v11 offset:0
    s_waitcnt lgkmcnt(4)
    v_mfma_f32_32x32x16_bf16 v[144:159], v[36:39], v[40:43], v[144:159]
    ds_read_b128 v[64:67], v19 offset:0
    s_waitcnt lgkmcnt(4)
    v_mfma_f32_32x32x16_bf16 v[160:175], v[32:35], v[44:47], v[160:175]
    ds_read_b128 v[60:63], v11 offset:1024
    v_mfma_f32_32x32x16_bf16 v[176:191], v[36:39], v[44:47], v[176:191]
    ds_read_b128 v[68:71], v19 offset:8192
    s_waitcnt lgkmcnt(5)
    v_mfma_f32_32x32x16_bf16 v[192:207], v[32:35], v[48:51], v[192:207]
    ds_read_b128 v[72:75], v19 offset:4096
    v_mfma_f32_32x32x16_bf16 v[208:223], v[36:39], v[48:51], v[208:223]
    ds_read_b128 v[76:79], v19 offset:12288
    s_waitcnt lgkmcnt(6)
    v_mfma_f32_32x32x16_bf16 v[224:239], v[32:35], v[52:55], v[224:239]
    v_mfma_f32_32x32x16_bf16 v[240:255], v[36:39], v[52:55], v[240:255]
    s_waitcnt lgkmcnt(5)
    s_waitcnt lgkmcnt(4)
    v_mfma_f32_32x32x16_bf16 v[128:143], v[56:59], v[64:67], v[128:143]
    s_waitcnt lgkmcnt(3)
    v_mfma_f32_32x32x16_bf16 v[144:159], v[60:63], v[64:67], v[144:159]
    s_waitcnt lgkmcnt(0)
    s_barrier
    v_mfma_f32_32x32x16_bf16 v[160:175], v[56:59], v[68:71], v[160:175]
    ds_read_b128 v[32:35], v8 offset:53376
    ds_read_b128 v[40:43], v20 offset:0
    v_mfma_f32_32x32x16_bf16 v[176:191], v[60:63], v[68:71], v[176:191]
    ds_read_b128 v[36:39], v8 offset:54400
    v_mfma_f32_32x32x16_bf16 v[192:207], v[56:59], v[72:75], v[192:207]
    ds_read_b128 v[44:47], v20 offset:8192
    v_mfma_f32_32x32x16_bf16 v[208:223], v[60:63], v[72:75], v[208:223]
    ds_read_b128 v[48:51], v20 offset:4096
    v_mfma_f32_32x32x16_bf16 v[224:239], v[56:59], v[76:79], v[224:239]
    ds_read_b128 v[52:55], v20 offset:12288
    v_mfma_f32_32x32x16_bf16 v[240:255], v[60:63], v[76:79], v[240:255]
    s_waitcnt lgkmcnt(5)
    s_waitcnt lgkmcnt(4)
    v_mfma_f32_32x32x16_bf16 v[128:143], v[32:35], v[40:43], v[128:143]
    ds_read_b128 v[56:59], v9 offset:53376
    s_waitcnt lgkmcnt(4)
    v_mfma_f32_32x32x16_bf16 v[144:159], v[36:39], v[40:43], v[144:159]
    ds_read_b128 v[64:67], v21 offset:0
    s_waitcnt lgkmcnt(4)
    v_mfma_f32_32x32x16_bf16 v[160:175], v[32:35], v[44:47], v[160:175]
    ds_read_b128 v[60:63], v9 offset:54400
    v_mfma_f32_32x32x16_bf16 v[176:191], v[36:39], v[44:47], v[176:191]
    ds_read_b128 v[68:71], v21 offset:8192
    s_waitcnt lgkmcnt(5)
    v_mfma_f32_32x32x16_bf16 v[192:207], v[32:35], v[48:51], v[192:207]
    ds_read_b128 v[72:75], v21 offset:4096
    v_mfma_f32_32x32x16_bf16 v[208:223], v[36:39], v[48:51], v[208:223]
    ds_read_b128 v[76:79], v21 offset:12288
    s_waitcnt lgkmcnt(6)
    v_mfma_f32_32x32x16_bf16 v[224:239], v[32:35], v[52:55], v[224:239]
    v_mfma_f32_32x32x16_bf16 v[240:255], v[36:39], v[52:55], v[240:255]
    s_waitcnt lgkmcnt(5)
    s_waitcnt lgkmcnt(4)
    v_mfma_f32_32x32x16_bf16 v[128:143], v[56:59], v[64:67], v[128:143]
    ds_read_b128 v[32:35], v10 offset:53376
    s_waitcnt lgkmcnt(4)
    v_mfma_f32_32x32x16_bf16 v[144:159], v[60:63], v[64:67], v[144:159]
    ds_read_b128 v[40:43], v22 offset:0
    s_waitcnt lgkmcnt(4)
    v_mfma_f32_32x32x16_bf16 v[160:175], v[56:59], v[68:71], v[160:175]
    ds_read_b128 v[36:39], v10 offset:54400
    v_mfma_f32_32x32x16_bf16 v[176:191], v[60:63], v[68:71], v[176:191]
    ds_read_b128 v[44:47], v22 offset:8192
    s_waitcnt lgkmcnt(5)
    v_mfma_f32_32x32x16_bf16 v[192:207], v[56:59], v[72:75], v[192:207]
    ds_read_b128 v[48:51], v22 offset:4096
    v_mfma_f32_32x32x16_bf16 v[208:223], v[60:63], v[72:75], v[208:223]
    ds_read_b128 v[52:55], v22 offset:12288
    s_waitcnt lgkmcnt(6)
    v_mfma_f32_32x32x16_bf16 v[224:239], v[56:59], v[76:79], v[224:239]
    v_mfma_f32_32x32x16_bf16 v[240:255], v[60:63], v[76:79], v[240:255]
    s_waitcnt lgkmcnt(5)
    s_waitcnt lgkmcnt(4)
    v_mfma_f32_32x32x16_bf16 v[128:143], v[32:35], v[40:43], v[128:143]
    ds_read_b128 v[56:59], v11 offset:53376
    s_waitcnt lgkmcnt(4)
    v_mfma_f32_32x32x16_bf16 v[144:159], v[36:39], v[40:43], v[144:159]
    ds_read_b128 v[64:67], v23 offset:0
    s_waitcnt lgkmcnt(4)
    v_mfma_f32_32x32x16_bf16 v[160:175], v[32:35], v[44:47], v[160:175]
    ds_read_b128 v[60:63], v11 offset:54400
    v_mfma_f32_32x32x16_bf16 v[176:191], v[36:39], v[44:47], v[176:191]
    ds_read_b128 v[68:71], v23 offset:8192
    s_waitcnt lgkmcnt(5)
    v_mfma_f32_32x32x16_bf16 v[192:207], v[32:35], v[48:51], v[192:207]
    ds_read_b128 v[72:75], v23 offset:4096
    v_mfma_f32_32x32x16_bf16 v[208:223], v[36:39], v[48:51], v[208:223]
    ds_read_b128 v[76:79], v23 offset:12288
    s_waitcnt lgkmcnt(6)
    v_mfma_f32_32x32x16_bf16 v[224:239], v[32:35], v[52:55], v[224:239]
    v_mfma_f32_32x32x16_bf16 v[240:255], v[36:39], v[52:55], v[240:255]
    s_waitcnt lgkmcnt(5)
    s_waitcnt lgkmcnt(4)
    v_mfma_f32_32x32x16_bf16 v[128:143], v[56:59], v[64:67], v[128:143]
    s_waitcnt lgkmcnt(3)
    v_mfma_f32_32x32x16_bf16 v[144:159], v[60:63], v[64:67], v[144:159]
    s_waitcnt lgkmcnt(0)
    s_barrier
    v_mfma_f32_32x32x16_bf16 v[160:175], v[56:59], v[68:71], v[160:175]
    ds_read_b128 v[32:35], v12 offset:0
    ds_read_b128 v[40:43], v24 offset:0
    v_mfma_f32_32x32x16_bf16 v[176:191], v[60:63], v[68:71], v[176:191]
    ds_read_b128 v[36:39], v12 offset:1024
    v_mfma_f32_32x32x16_bf16 v[192:207], v[56:59], v[72:75], v[192:207]
    ds_read_b128 v[44:47], v24 offset:8192
    v_mfma_f32_32x32x16_bf16 v[208:223], v[60:63], v[72:75], v[208:223]
    ds_read_b128 v[48:51], v24 offset:4096
    v_mfma_f32_32x32x16_bf16 v[224:239], v[56:59], v[76:79], v[224:239]
    ds_read_b128 v[52:55], v24 offset:12288
    v_mfma_f32_32x32x16_bf16 v[240:255], v[60:63], v[76:79], v[240:255]
    s_waitcnt lgkmcnt(5)
    s_waitcnt lgkmcnt(4)
    v_mfma_f32_32x32x16_bf16 v[128:143], v[32:35], v[40:43], v[128:143]
    ds_read_b128 v[56:59], v13 offset:0
    s_waitcnt lgkmcnt(4)
    v_mfma_f32_32x32x16_bf16 v[144:159], v[36:39], v[40:43], v[144:159]
    ds_read_b128 v[64:67], v25 offset:0
    s_waitcnt lgkmcnt(4)
    v_mfma_f32_32x32x16_bf16 v[160:175], v[32:35], v[44:47], v[160:175]
    ds_read_b128 v[60:63], v13 offset:1024
    v_mfma_f32_32x32x16_bf16 v[176:191], v[36:39], v[44:47], v[176:191]
    ds_read_b128 v[68:71], v25 offset:8192
    s_waitcnt lgkmcnt(5)
    v_mfma_f32_32x32x16_bf16 v[192:207], v[32:35], v[48:51], v[192:207]
    ds_read_b128 v[72:75], v25 offset:4096
    v_mfma_f32_32x32x16_bf16 v[208:223], v[36:39], v[48:51], v[208:223]
    ds_read_b128 v[76:79], v25 offset:12288
    s_waitcnt lgkmcnt(6)
    v_mfma_f32_32x32x16_bf16 v[224:239], v[32:35], v[52:55], v[224:239]
    v_mfma_f32_32x32x16_bf16 v[240:255], v[36:39], v[52:55], v[240:255]
    s_waitcnt lgkmcnt(5)
    s_waitcnt lgkmcnt(4)
    v_mfma_f32_32x32x16_bf16 v[128:143], v[56:59], v[64:67], v[128:143]
    ds_read_b128 v[32:35], v14 offset:0
    s_waitcnt lgkmcnt(4)
    v_mfma_f32_32x32x16_bf16 v[144:159], v[60:63], v[64:67], v[144:159]
    ds_read_b128 v[40:43], v26 offset:0
    s_waitcnt lgkmcnt(4)
    v_mfma_f32_32x32x16_bf16 v[160:175], v[56:59], v[68:71], v[160:175]
    ds_read_b128 v[36:39], v14 offset:1024
    v_mfma_f32_32x32x16_bf16 v[176:191], v[60:63], v[68:71], v[176:191]
    ds_read_b128 v[44:47], v26 offset:8192
    s_waitcnt lgkmcnt(5)
    v_mfma_f32_32x32x16_bf16 v[192:207], v[56:59], v[72:75], v[192:207]
    ds_read_b128 v[48:51], v26 offset:4096
    v_mfma_f32_32x32x16_bf16 v[208:223], v[60:63], v[72:75], v[208:223]
    ds_read_b128 v[52:55], v26 offset:12288
    s_waitcnt lgkmcnt(6)
    v_mfma_f32_32x32x16_bf16 v[224:239], v[56:59], v[76:79], v[224:239]
    v_mfma_f32_32x32x16_bf16 v[240:255], v[60:63], v[76:79], v[240:255]
    s_waitcnt lgkmcnt(5)
    s_waitcnt lgkmcnt(4)
    v_mfma_f32_32x32x16_bf16 v[128:143], v[32:35], v[40:43], v[128:143]
    ds_read_b128 v[56:59], v15 offset:0
    s_waitcnt lgkmcnt(4)
    v_mfma_f32_32x32x16_bf16 v[144:159], v[36:39], v[40:43], v[144:159]
    ds_read_b128 v[64:67], v27 offset:0
    s_waitcnt lgkmcnt(4)
    v_mfma_f32_32x32x16_bf16 v[160:175], v[32:35], v[44:47], v[160:175]
    ds_read_b128 v[60:63], v15 offset:1024
    v_mfma_f32_32x32x16_bf16 v[176:191], v[36:39], v[44:47], v[176:191]
    ds_read_b128 v[68:71], v27 offset:8192
    s_waitcnt lgkmcnt(5)
    v_mfma_f32_32x32x16_bf16 v[192:207], v[32:35], v[48:51], v[192:207]
    ds_read_b128 v[72:75], v27 offset:4096
    v_mfma_f32_32x32x16_bf16 v[208:223], v[36:39], v[48:51], v[208:223]
    ds_read_b128 v[76:79], v27 offset:12288
    s_waitcnt lgkmcnt(6)
    v_mfma_f32_32x32x16_bf16 v[224:239], v[32:35], v[52:55], v[224:239]
    v_mfma_f32_32x32x16_bf16 v[240:255], v[36:39], v[52:55], v[240:255]
    s_waitcnt lgkmcnt(5)
    s_waitcnt lgkmcnt(4)
    v_mfma_f32_32x32x16_bf16 v[128:143], v[56:59], v[64:67], v[128:143]
    s_waitcnt lgkmcnt(3)
    v_mfma_f32_32x32x16_bf16 v[144:159], v[60:63], v[64:67], v[144:159]
    s_waitcnt lgkmcnt(0)
    s_barrier
    v_mfma_f32_32x32x16_bf16 v[160:175], v[56:59], v[68:71], v[160:175]
    ds_read_b128 v[32:35], v8 offset:0
    ds_read_b128 v[40:43], v16 offset:0
    v_mfma_f32_32x32x16_bf16 v[176:191], v[60:63], v[68:71], v[176:191]
    ds_read_b128 v[36:39], v8 offset:1024
    v_mfma_f32_32x32x16_bf16 v[192:207], v[56:59], v[72:75], v[192:207]
    ds_read_b128 v[44:47], v16 offset:8192
    v_mfma_f32_32x32x16_bf16 v[208:223], v[60:63], v[72:75], v[208:223]
    ds_read_b128 v[48:51], v16 offset:4096
    v_mfma_f32_32x32x16_bf16 v[224:239], v[56:59], v[76:79], v[224:239]
    ds_read_b128 v[52:55], v16 offset:12288
    v_mfma_f32_32x32x16_bf16 v[240:255], v[60:63], v[76:79], v[240:255]
    s_waitcnt lgkmcnt(5)
    s_waitcnt lgkmcnt(4)
    v_mfma_f32_32x32x16_bf16 v[128:143], v[32:35], v[40:43], v[128:143]
    ds_read_b128 v[56:59], v9 offset:0
    s_waitcnt lgkmcnt(4)
    v_mfma_f32_32x32x16_bf16 v[144:159], v[36:39], v[40:43], v[144:159]
    ds_read_b128 v[64:67], v17 offset:0
    s_waitcnt lgkmcnt(4)
    v_mfma_f32_32x32x16_bf16 v[160:175], v[32:35], v[44:47], v[160:175]
    ds_read_b128 v[60:63], v9 offset:1024
    v_mfma_f32_32x32x16_bf16 v[176:191], v[36:39], v[44:47], v[176:191]
    ds_read_b128 v[68:71], v17 offset:8192
    s_waitcnt lgkmcnt(5)
    v_mfma_f32_32x32x16_bf16 v[192:207], v[32:35], v[48:51], v[192:207]
    ds_read_b128 v[72:75], v17 offset:4096
    v_mfma_f32_32x32x16_bf16 v[208:223], v[36:39], v[48:51], v[208:223]
    ds_read_b128 v[76:79], v17 offset:12288
    s_waitcnt lgkmcnt(6)
    v_mfma_f32_32x32x16_bf16 v[224:239], v[32:35], v[52:55], v[224:239]
    v_mfma_f32_32x32x16_bf16 v[240:255], v[36:39], v[52:55], v[240:255]
    s_waitcnt lgkmcnt(5)
    s_waitcnt lgkmcnt(4)
    v_mfma_f32_32x32x16_bf16 v[128:143], v[56:59], v[64:67], v[128:143]
    ds_read_b128 v[32:35], v10 offset:0
    s_waitcnt lgkmcnt(4)
    v_mfma_f32_32x32x16_bf16 v[144:159], v[60:63], v[64:67], v[144:159]
    ds_read_b128 v[40:43], v18 offset:0
    s_waitcnt lgkmcnt(4)
    v_mfma_f32_32x32x16_bf16 v[160:175], v[56:59], v[68:71], v[160:175]
    ds_read_b128 v[36:39], v10 offset:1024
    v_mfma_f32_32x32x16_bf16 v[176:191], v[60:63], v[68:71], v[176:191]
    ds_read_b128 v[44:47], v18 offset:8192
    s_waitcnt lgkmcnt(5)
    v_mfma_f32_32x32x16_bf16 v[192:207], v[56:59], v[72:75], v[192:207]
    ds_read_b128 v[48:51], v18 offset:4096
    v_mfma_f32_32x32x16_bf16 v[208:223], v[60:63], v[72:75], v[208:223]
    ds_read_b128 v[52:55], v18 offset:12288
    s_waitcnt lgkmcnt(6)
    v_mfma_f32_32x32x16_bf16 v[224:239], v[56:59], v[76:79], v[224:239]
    v_mfma_f32_32x32x16_bf16 v[240:255], v[60:63], v[76:79], v[240:255]
    s_waitcnt lgkmcnt(5)
    s_waitcnt lgkmcnt(4)
    v_mfma_f32_32x32x16_bf16 v[128:143], v[32:35], v[40:43], v[128:143]
    ds_read_b128 v[56:59], v11 offset:0
    s_waitcnt lgkmcnt(4)
    v_mfma_f32_32x32x16_bf16 v[144:159], v[36:39], v[40:43], v[144:159]
    ds_read_b128 v[64:67], v19 offset:0
    s_waitcnt lgkmcnt(4)
    v_mfma_f32_32x32x16_bf16 v[160:175], v[32:35], v[44:47], v[160:175]
    ds_read_b128 v[60:63], v11 offset:1024
    v_mfma_f32_32x32x16_bf16 v[176:191], v[36:39], v[44:47], v[176:191]
    ds_read_b128 v[68:71], v19 offset:8192
    s_waitcnt lgkmcnt(5)
    v_mfma_f32_32x32x16_bf16 v[192:207], v[32:35], v[48:51], v[192:207]
    ds_read_b128 v[72:75], v19 offset:4096
    v_mfma_f32_32x32x16_bf16 v[208:223], v[36:39], v[48:51], v[208:223]
    ds_read_b128 v[76:79], v19 offset:12288
    s_waitcnt lgkmcnt(6)
    v_mfma_f32_32x32x16_bf16 v[224:239], v[32:35], v[52:55], v[224:239]
    v_mfma_f32_32x32x16_bf16 v[240:255], v[36:39], v[52:55], v[240:255]
    s_waitcnt lgkmcnt(5)
    s_waitcnt lgkmcnt(4)
    v_mfma_f32_32x32x16_bf16 v[128:143], v[56:59], v[64:67], v[128:143]
    s_waitcnt lgkmcnt(3)
    v_mfma_f32_32x32x16_bf16 v[144:159], v[60:63], v[64:67], v[144:159]
    s_waitcnt lgkmcnt(0)
    s_barrier
    v_mfma_f32_32x32x16_bf16 v[160:175], v[56:59], v[68:71], v[160:175]
    ds_read_b128 v[32:35], v8 offset:53376
    ds_read_b128 v[40:43], v20 offset:0
    v_mfma_f32_32x32x16_bf16 v[176:191], v[60:63], v[68:71], v[176:191]
    ds_read_b128 v[36:39], v8 offset:54400
    v_mfma_f32_32x32x16_bf16 v[192:207], v[56:59], v[72:75], v[192:207]
    ds_read_b128 v[44:47], v20 offset:8192
    v_mfma_f32_32x32x16_bf16 v[208:223], v[60:63], v[72:75], v[208:223]
    ds_read_b128 v[48:51], v20 offset:4096
    v_mfma_f32_32x32x16_bf16 v[224:239], v[56:59], v[76:79], v[224:239]
    ds_read_b128 v[52:55], v20 offset:12288
    v_mfma_f32_32x32x16_bf16 v[240:255], v[60:63], v[76:79], v[240:255]
    s_waitcnt lgkmcnt(5)
    s_waitcnt lgkmcnt(4)
    v_mfma_f32_32x32x16_bf16 v[128:143], v[32:35], v[40:43], v[128:143]
    ds_read_b128 v[56:59], v9 offset:53376
    s_waitcnt lgkmcnt(4)
    v_mfma_f32_32x32x16_bf16 v[144:159], v[36:39], v[40:43], v[144:159]
    ds_read_b128 v[64:67], v21 offset:0
    s_waitcnt lgkmcnt(4)
    v_mfma_f32_32x32x16_bf16 v[160:175], v[32:35], v[44:47], v[160:175]
    ds_read_b128 v[60:63], v9 offset:54400
    v_mfma_f32_32x32x16_bf16 v[176:191], v[36:39], v[44:47], v[176:191]
    ds_read_b128 v[68:71], v21 offset:8192
    s_waitcnt lgkmcnt(5)
    v_mfma_f32_32x32x16_bf16 v[192:207], v[32:35], v[48:51], v[192:207]
    ds_read_b128 v[72:75], v21 offset:4096
    v_mfma_f32_32x32x16_bf16 v[208:223], v[36:39], v[48:51], v[208:223]
    ds_read_b128 v[76:79], v21 offset:12288
    s_waitcnt lgkmcnt(6)
    v_mfma_f32_32x32x16_bf16 v[224:239], v[32:35], v[52:55], v[224:239]
    v_mfma_f32_32x32x16_bf16 v[240:255], v[36:39], v[52:55], v[240:255]
    s_waitcnt lgkmcnt(5)
    s_waitcnt lgkmcnt(4)
    v_mfma_f32_32x32x16_bf16 v[128:143], v[56:59], v[64:67], v[128:143]
    ds_read_b128 v[32:35], v10 offset:53376
    s_waitcnt lgkmcnt(4)
    v_mfma_f32_32x32x16_bf16 v[144:159], v[60:63], v[64:67], v[144:159]
    ds_read_b128 v[40:43], v22 offset:0
    s_waitcnt lgkmcnt(4)
    v_mfma_f32_32x32x16_bf16 v[160:175], v[56:59], v[68:71], v[160:175]
    ds_read_b128 v[36:39], v10 offset:54400
    v_mfma_f32_32x32x16_bf16 v[176:191], v[60:63], v[68:71], v[176:191]
    ds_read_b128 v[44:47], v22 offset:8192
    s_waitcnt lgkmcnt(5)
    v_mfma_f32_32x32x16_bf16 v[192:207], v[56:59], v[72:75], v[192:207]
    ds_read_b128 v[48:51], v22 offset:4096
    v_mfma_f32_32x32x16_bf16 v[208:223], v[60:63], v[72:75], v[208:223]
    ds_read_b128 v[52:55], v22 offset:12288
    s_waitcnt lgkmcnt(6)
    v_mfma_f32_32x32x16_bf16 v[224:239], v[56:59], v[76:79], v[224:239]
    v_mfma_f32_32x32x16_bf16 v[240:255], v[60:63], v[76:79], v[240:255]
    s_waitcnt lgkmcnt(5)
    s_waitcnt lgkmcnt(4)
    v_mfma_f32_32x32x16_bf16 v[128:143], v[32:35], v[40:43], v[128:143]
    ds_read_b128 v[56:59], v11 offset:53376
    s_waitcnt lgkmcnt(4)
    v_mfma_f32_32x32x16_bf16 v[144:159], v[36:39], v[40:43], v[144:159]
    ds_read_b128 v[64:67], v23 offset:0
    s_waitcnt lgkmcnt(4)
    v_mfma_f32_32x32x16_bf16 v[160:175], v[32:35], v[44:47], v[160:175]
    ds_read_b128 v[60:63], v11 offset:54400
    v_mfma_f32_32x32x16_bf16 v[176:191], v[36:39], v[44:47], v[176:191]
    ds_read_b128 v[68:71], v23 offset:8192
    s_waitcnt lgkmcnt(5)
    v_mfma_f32_32x32x16_bf16 v[192:207], v[32:35], v[48:51], v[192:207]
    ds_read_b128 v[72:75], v23 offset:4096
    v_mfma_f32_32x32x16_bf16 v[208:223], v[36:39], v[48:51], v[208:223]
    ds_read_b128 v[76:79], v23 offset:12288
    s_waitcnt lgkmcnt(6)
    v_mfma_f32_32x32x16_bf16 v[224:239], v[32:35], v[52:55], v[224:239]
    v_mfma_f32_32x32x16_bf16 v[240:255], v[36:39], v[52:55], v[240:255]
    s_waitcnt lgkmcnt(5)
    s_waitcnt lgkmcnt(4)
    v_mfma_f32_32x32x16_bf16 v[128:143], v[56:59], v[64:67], v[128:143]
    s_waitcnt lgkmcnt(3)
    v_mfma_f32_32x32x16_bf16 v[144:159], v[60:63], v[64:67], v[144:159]
    s_waitcnt lgkmcnt(0)
    s_barrier
    v_mfma_f32_32x32x16_bf16 v[160:175], v[56:59], v[68:71], v[160:175]
    ds_read_b128 v[32:35], v12 offset:0
    ds_read_b128 v[40:43], v24 offset:0
    v_mfma_f32_32x32x16_bf16 v[176:191], v[60:63], v[68:71], v[176:191]
    ds_read_b128 v[36:39], v12 offset:1024
    v_mfma_f32_32x32x16_bf16 v[192:207], v[56:59], v[72:75], v[192:207]
    ds_read_b128 v[44:47], v24 offset:8192
    v_mfma_f32_32x32x16_bf16 v[208:223], v[60:63], v[72:75], v[208:223]
    ds_read_b128 v[48:51], v24 offset:4096
    v_mfma_f32_32x32x16_bf16 v[224:239], v[56:59], v[76:79], v[224:239]
    ds_read_b128 v[52:55], v24 offset:12288
    v_mfma_f32_32x32x16_bf16 v[240:255], v[60:63], v[76:79], v[240:255]
    s_waitcnt lgkmcnt(5)
    s_waitcnt lgkmcnt(4)
    v_mfma_f32_32x32x16_bf16 v[128:143], v[32:35], v[40:43], v[128:143]
    ds_read_b128 v[56:59], v13 offset:0
    s_waitcnt lgkmcnt(4)
    v_mfma_f32_32x32x16_bf16 v[144:159], v[36:39], v[40:43], v[144:159]
    ds_read_b128 v[64:67], v25 offset:0
    s_waitcnt lgkmcnt(4)
    v_mfma_f32_32x32x16_bf16 v[160:175], v[32:35], v[44:47], v[160:175]
    ds_read_b128 v[60:63], v13 offset:1024
    v_mfma_f32_32x32x16_bf16 v[176:191], v[36:39], v[44:47], v[176:191]
    ds_read_b128 v[68:71], v25 offset:8192
    s_waitcnt lgkmcnt(5)
    v_mfma_f32_32x32x16_bf16 v[192:207], v[32:35], v[48:51], v[192:207]
    ds_read_b128 v[72:75], v25 offset:4096
    v_mfma_f32_32x32x16_bf16 v[208:223], v[36:39], v[48:51], v[208:223]
    ds_read_b128 v[76:79], v25 offset:12288
    s_waitcnt lgkmcnt(6)
    v_mfma_f32_32x32x16_bf16 v[224:239], v[32:35], v[52:55], v[224:239]
    v_mfma_f32_32x32x16_bf16 v[240:255], v[36:39], v[52:55], v[240:255]
    s_waitcnt lgkmcnt(5)
    s_waitcnt lgkmcnt(4)
    v_mfma_f32_32x32x16_bf16 v[128:143], v[56:59], v[64:67], v[128:143]
    ds_read_b128 v[32:35], v14 offset:0
    s_waitcnt lgkmcnt(4)
    v_mfma_f32_32x32x16_bf16 v[144:159], v[60:63], v[64:67], v[144:159]
    ds_read_b128 v[40:43], v26 offset:0
    s_waitcnt lgkmcnt(4)
    v_mfma_f32_32x32x16_bf16 v[160:175], v[56:59], v[68:71], v[160:175]
    ds_read_b128 v[36:39], v14 offset:1024
    v_mfma_f32_32x32x16_bf16 v[176:191], v[60:63], v[68:71], v[176:191]
    ds_read_b128 v[44:47], v26 offset:8192
    s_waitcnt lgkmcnt(5)
    v_mfma_f32_32x32x16_bf16 v[192:207], v[56:59], v[72:75], v[192:207]
    ds_read_b128 v[48:51], v26 offset:4096
    v_mfma_f32_32x32x16_bf16 v[208:223], v[60:63], v[72:75], v[208:223]
    ds_read_b128 v[52:55], v26 offset:12288
    s_waitcnt lgkmcnt(6)
    v_mfma_f32_32x32x16_bf16 v[224:239], v[56:59], v[76:79], v[224:239]
    v_mfma_f32_32x32x16_bf16 v[240:255], v[60:63], v[76:79], v[240:255]
    s_waitcnt lgkmcnt(5)
    s_waitcnt lgkmcnt(4)
    v_mfma_f32_32x32x16_bf16 v[128:143], v[32:35], v[40:43], v[128:143]
    ds_read_b128 v[56:59], v15 offset:0
    s_waitcnt lgkmcnt(4)
    v_mfma_f32_32x32x16_bf16 v[144:159], v[36:39], v[40:43], v[144:159]
    ds_read_b128 v[64:67], v27 offset:0
    s_waitcnt lgkmcnt(4)
    v_mfma_f32_32x32x16_bf16 v[160:175], v[32:35], v[44:47], v[160:175]
    ds_read_b128 v[60:63], v15 offset:1024
    v_mfma_f32_32x32x16_bf16 v[176:191], v[36:39], v[44:47], v[176:191]
    ds_read_b128 v[68:71], v27 offset:8192
    s_waitcnt lgkmcnt(5)
    v_mfma_f32_32x32x16_bf16 v[192:207], v[32:35], v[48:51], v[192:207]
    ds_read_b128 v[72:75], v27 offset:4096
    v_mfma_f32_32x32x16_bf16 v[208:223], v[36:39], v[48:51], v[208:223]
    ds_read_b128 v[76:79], v27 offset:12288
    s_waitcnt lgkmcnt(6)
    v_mfma_f32_32x32x16_bf16 v[224:239], v[32:35], v[52:55], v[224:239]
    v_mfma_f32_32x32x16_bf16 v[240:255], v[36:39], v[52:55], v[240:255]
    s_waitcnt lgkmcnt(5)
    s_waitcnt lgkmcnt(4)
    v_mfma_f32_32x32x16_bf16 v[128:143], v[56:59], v[64:67], v[128:143]
    s_waitcnt lgkmcnt(3)
    v_mfma_f32_32x32x16_bf16 v[144:159], v[60:63], v[64:67], v[144:159]
    s_waitcnt lgkmcnt(0)
    s_barrier
    v_mfma_f32_32x32x16_bf16 v[160:175], v[56:59], v[68:71], v[160:175]
    ds_read_b128 v[32:35], v8 offset:0
    ds_read_b128 v[40:43], v16 offset:0
    v_mfma_f32_32x32x16_bf16 v[176:191], v[60:63], v[68:71], v[176:191]
    ds_read_b128 v[36:39], v8 offset:1024
    v_mfma_f32_32x32x16_bf16 v[192:207], v[56:59], v[72:75], v[192:207]
    ds_read_b128 v[44:47], v16 offset:8192
    v_mfma_f32_32x32x16_bf16 v[208:223], v[60:63], v[72:75], v[208:223]
    ds_read_b128 v[48:51], v16 offset:4096
    v_mfma_f32_32x32x16_bf16 v[224:239], v[56:59], v[76:79], v[224:239]
    ds_read_b128 v[52:55], v16 offset:12288
    v_mfma_f32_32x32x16_bf16 v[240:255], v[60:63], v[76:79], v[240:255]
    s_waitcnt lgkmcnt(5)
    s_waitcnt lgkmcnt(4)
    v_mfma_f32_32x32x16_bf16 v[128:143], v[32:35], v[40:43], v[128:143]
    ds_read_b128 v[56:59], v9 offset:0
    s_waitcnt lgkmcnt(4)
    v_mfma_f32_32x32x16_bf16 v[144:159], v[36:39], v[40:43], v[144:159]
    ds_read_b128 v[64:67], v17 offset:0
    s_waitcnt lgkmcnt(4)
    v_mfma_f32_32x32x16_bf16 v[160:175], v[32:35], v[44:47], v[160:175]
    ds_read_b128 v[60:63], v9 offset:1024
    v_mfma_f32_32x32x16_bf16 v[176:191], v[36:39], v[44:47], v[176:191]
    ds_read_b128 v[68:71], v17 offset:8192
    s_waitcnt lgkmcnt(5)
    v_mfma_f32_32x32x16_bf16 v[192:207], v[32:35], v[48:51], v[192:207]
    ds_read_b128 v[72:75], v17 offset:4096
    v_mfma_f32_32x32x16_bf16 v[208:223], v[36:39], v[48:51], v[208:223]
    ds_read_b128 v[76:79], v17 offset:12288
    s_waitcnt lgkmcnt(6)
    v_mfma_f32_32x32x16_bf16 v[224:239], v[32:35], v[52:55], v[224:239]
    v_mfma_f32_32x32x16_bf16 v[240:255], v[36:39], v[52:55], v[240:255]
    s_waitcnt lgkmcnt(5)
    s_waitcnt lgkmcnt(4)
    v_mfma_f32_32x32x16_bf16 v[128:143], v[56:59], v[64:67], v[128:143]
    ds_read_b128 v[32:35], v10 offset:0
    s_waitcnt lgkmcnt(4)
    v_mfma_f32_32x32x16_bf16 v[144:159], v[60:63], v[64:67], v[144:159]
    ds_read_b128 v[40:43], v18 offset:0
    s_waitcnt lgkmcnt(4)
    v_mfma_f32_32x32x16_bf16 v[160:175], v[56:59], v[68:71], v[160:175]
    ds_read_b128 v[36:39], v10 offset:1024
    v_mfma_f32_32x32x16_bf16 v[176:191], v[60:63], v[68:71], v[176:191]
    ds_read_b128 v[44:47], v18 offset:8192
    s_waitcnt lgkmcnt(5)
    v_mfma_f32_32x32x16_bf16 v[192:207], v[56:59], v[72:75], v[192:207]
    ds_read_b128 v[48:51], v18 offset:4096
    v_mfma_f32_32x32x16_bf16 v[208:223], v[60:63], v[72:75], v[208:223]
    ds_read_b128 v[52:55], v18 offset:12288
    s_waitcnt lgkmcnt(6)
    v_mfma_f32_32x32x16_bf16 v[224:239], v[56:59], v[76:79], v[224:239]
    v_mfma_f32_32x32x16_bf16 v[240:255], v[60:63], v[76:79], v[240:255]
    s_waitcnt lgkmcnt(5)
    s_waitcnt lgkmcnt(4)
    v_mfma_f32_32x32x16_bf16 v[128:143], v[32:35], v[40:43], v[128:143]
    ds_read_b128 v[56:59], v11 offset:0
    s_waitcnt lgkmcnt(4)
    v_mfma_f32_32x32x16_bf16 v[144:159], v[36:39], v[40:43], v[144:159]
    ds_read_b128 v[64:67], v19 offset:0
    s_waitcnt lgkmcnt(4)
    v_mfma_f32_32x32x16_bf16 v[160:175], v[32:35], v[44:47], v[160:175]
    ds_read_b128 v[60:63], v11 offset:1024
    v_mfma_f32_32x32x16_bf16 v[176:191], v[36:39], v[44:47], v[176:191]
    ds_read_b128 v[68:71], v19 offset:8192
    s_waitcnt lgkmcnt(5)
    v_mfma_f32_32x32x16_bf16 v[192:207], v[32:35], v[48:51], v[192:207]
    ds_read_b128 v[72:75], v19 offset:4096
    v_mfma_f32_32x32x16_bf16 v[208:223], v[36:39], v[48:51], v[208:223]
    ds_read_b128 v[76:79], v19 offset:12288
    s_waitcnt lgkmcnt(6)
    v_mfma_f32_32x32x16_bf16 v[224:239], v[32:35], v[52:55], v[224:239]
    v_mfma_f32_32x32x16_bf16 v[240:255], v[36:39], v[52:55], v[240:255]
    s_waitcnt lgkmcnt(5)
    s_waitcnt lgkmcnt(4)
    v_mfma_f32_32x32x16_bf16 v[128:143], v[56:59], v[64:67], v[128:143]
    s_waitcnt lgkmcnt(3)
    v_mfma_f32_32x32x16_bf16 v[144:159], v[60:63], v[64:67], v[144:159]
    s_waitcnt lgkmcnt(0)
    s_barrier
    v_mfma_f32_32x32x16_bf16 v[160:175], v[56:59], v[68:71], v[160:175]
    ds_read_b128 v[32:35], v8 offset:53376
    ds_read_b128 v[40:43], v20 offset:0
    v_mfma_f32_32x32x16_bf16 v[176:191], v[60:63], v[68:71], v[176:191]
    ds_read_b128 v[36:39], v8 offset:54400
    v_mfma_f32_32x32x16_bf16 v[192:207], v[56:59], v[72:75], v[192:207]
    ds_read_b128 v[44:47], v20 offset:8192
    v_mfma_f32_32x32x16_bf16 v[208:223], v[60:63], v[72:75], v[208:223]
    ds_read_b128 v[48:51], v20 offset:4096
    v_mfma_f32_32x32x16_bf16 v[224:239], v[56:59], v[76:79], v[224:239]
    ds_read_b128 v[52:55], v20 offset:12288
    v_mfma_f32_32x32x16_bf16 v[240:255], v[60:63], v[76:79], v[240:255]
    s_waitcnt lgkmcnt(5)
    s_waitcnt lgkmcnt(4)
    v_mfma_f32_32x32x16_bf16 v[128:143], v[32:35], v[40:43], v[128:143]
    ds_read_b128 v[56:59], v9 offset:53376
    s_waitcnt lgkmcnt(4)
    v_mfma_f32_32x32x16_bf16 v[144:159], v[36:39], v[40:43], v[144:159]
    ds_read_b128 v[64:67], v21 offset:0
    s_waitcnt lgkmcnt(4)
    v_mfma_f32_32x32x16_bf16 v[160:175], v[32:35], v[44:47], v[160:175]
    ds_read_b128 v[60:63], v9 offset:54400
    v_mfma_f32_32x32x16_bf16 v[176:191], v[36:39], v[44:47], v[176:191]
    ds_read_b128 v[68:71], v21 offset:8192
    s_waitcnt lgkmcnt(5)
    v_mfma_f32_32x32x16_bf16 v[192:207], v[32:35], v[48:51], v[192:207]
    ds_read_b128 v[72:75], v21 offset:4096
    v_mfma_f32_32x32x16_bf16 v[208:223], v[36:39], v[48:51], v[208:223]
    ds_read_b128 v[76:79], v21 offset:12288
    s_waitcnt lgkmcnt(6)
    v_mfma_f32_32x32x16_bf16 v[224:239], v[32:35], v[52:55], v[224:239]
    v_mfma_f32_32x32x16_bf16 v[240:255], v[36:39], v[52:55], v[240:255]
    v_mov_b32 v31, 0x27fc0
    ds_read_b32 v30, v31
    s_waitcnt lgkmcnt(6)
    s_waitcnt lgkmcnt(5)
    v_mfma_f32_32x32x16_bf16 v[128:143], v[56:59], v[64:67], v[128:143]
    ds_read_b128 v[32:35], v10 offset:53376
    s_waitcnt lgkmcnt(5)
    v_mfma_f32_32x32x16_bf16 v[144:159], v[60:63], v[64:67], v[144:159]
    ds_read_b128 v[40:43], v22 offset:0
    s_waitcnt lgkmcnt(5)
    v_mfma_f32_32x32x16_bf16 v[160:175], v[56:59], v[68:71], v[160:175]
    ds_read_b128 v[36:39], v10 offset:54400
    v_mfma_f32_32x32x16_bf16 v[176:191], v[60:63], v[68:71], v[176:191]
    ds_read_b128 v[44:47], v22 offset:8192
    s_waitcnt lgkmcnt(6)
    v_mfma_f32_32x32x16_bf16 v[192:207], v[56:59], v[72:75], v[192:207]
    ds_read_b128 v[48:51], v22 offset:4096
    v_mfma_f32_32x32x16_bf16 v[208:223], v[60:63], v[72:75], v[208:223]
    ds_read_b128 v[52:55], v22 offset:12288
    s_waitcnt lgkmcnt(7)
    v_mfma_f32_32x32x16_bf16 v[224:239], v[56:59], v[76:79], v[224:239]
    v_mfma_f32_32x32x16_bf16 v[240:255], v[60:63], v[76:79], v[240:255]
    s_waitcnt lgkmcnt(5)
    s_waitcnt lgkmcnt(4)
    v_mfma_f32_32x32x16_bf16 v[128:143], v[32:35], v[40:43], v[128:143]
    ds_read_b128 v[56:59], v11 offset:53376
    s_waitcnt lgkmcnt(4)
    v_mfma_f32_32x32x16_bf16 v[144:159], v[36:39], v[40:43], v[144:159]
    ds_read_b128 v[64:67], v23 offset:0
    s_waitcnt lgkmcnt(4)
    v_mfma_f32_32x32x16_bf16 v[160:175], v[32:35], v[44:47], v[160:175]
    ds_read_b128 v[60:63], v11 offset:54400
    v_mfma_f32_32x32x16_bf16 v[176:191], v[36:39], v[44:47], v[176:191]
    ds_read_b128 v[68:71], v23 offset:8192
    s_waitcnt lgkmcnt(5)
    v_mfma_f32_32x32x16_bf16 v[192:207], v[32:35], v[48:51], v[192:207]
    ds_read_b128 v[72:75], v23 offset:4096
    v_mfma_f32_32x32x16_bf16 v[208:223], v[36:39], v[48:51], v[208:223]
    ds_read_b128 v[76:79], v23 offset:12288
    s_waitcnt lgkmcnt(6)
    v_mfma_f32_32x32x16_bf16 v[224:239], v[32:35], v[52:55], v[224:239]
    v_mfma_f32_32x32x16_bf16 v[240:255], v[36:39], v[52:55], v[240:255]
    s_waitcnt lgkmcnt(5)
    s_waitcnt lgkmcnt(4)
    v_mfma_f32_32x32x16_bf16 v[128:143], v[56:59], v[64:67], v[128:143]
    s_waitcnt lgkmcnt(3)
    v_mfma_f32_32x32x16_bf16 v[144:159], v[60:63], v[64:67], v[144:159]
    s_waitcnt lgkmcnt(0)
    s_barrier
    v_mfma_f32_32x32x16_bf16 v[160:175], v[56:59], v[68:71], v[160:175]
    ds_read_b128 v[32:35], v12 offset:0
    ds_read_b128 v[40:43], v24 offset:0
    v_mfma_f32_32x32x16_bf16 v[176:191], v[60:63], v[68:71], v[176:191]
    ds_read_b128 v[36:39], v12 offset:1024
    v_mfma_f32_32x32x16_bf16 v[192:207], v[56:59], v[72:75], v[192:207]
    ds_read_b128 v[44:47], v24 offset:8192
    v_mfma_f32_32x32x16_bf16 v[208:223], v[60:63], v[72:75], v[208:223]
    ds_read_b128 v[48:51], v24 offset:4096
    v_mfma_f32_32x32x16_bf16 v[224:239], v[56:59], v[76:79], v[224:239]
    ds_read_b128 v[52:55], v24 offset:12288
    v_mfma_f32_32x32x16_bf16 v[240:255], v[60:63], v[76:79], v[240:255]
    s_waitcnt lgkmcnt(5)
    s_waitcnt lgkmcnt(4)
    v_mfma_f32_32x32x16_bf16 v[128:143], v[32:35], v[40:43], v[128:143]
    ds_read_b128 v[56:59], v13 offset:0
    s_waitcnt lgkmcnt(4)
    v_mfma_f32_32x32x16_bf16 v[144:159], v[36:39], v[40:43], v[144:159]
    ds_read_b128 v[64:67], v25 offset:0
    s_waitcnt lgkmcnt(4)
    v_mfma_f32_32x32x16_bf16 v[160:175], v[32:35], v[44:47], v[160:175]
    ds_read_b128 v[60:63], v13 offset:1024
    v_mfma_f32_32x32x16_bf16 v[176:191], v[36:39], v[44:47], v[176:191]
    ds_read_b128 v[68:71], v25 offset:8192
    s_waitcnt lgkmcnt(5)
    v_mfma_f32_32x32x16_bf16 v[192:207], v[32:35], v[48:51], v[192:207]
    ds_read_b128 v[72:75], v25 offset:4096
    v_mfma_f32_32x32x16_bf16 v[208:223], v[36:39], v[48:51], v[208:223]
    ds_read_b128 v[76:79], v25 offset:12288
    s_waitcnt lgkmcnt(6)
    v_mfma_f32_32x32x16_bf16 v[224:239], v[32:35], v[52:55], v[224:239]
    v_mfma_f32_32x32x16_bf16 v[240:255], v[36:39], v[52:55], v[240:255]
    s_waitcnt lgkmcnt(5)
    s_waitcnt lgkmcnt(4)
    v_mfma_f32_32x32x16_bf16 v[128:143], v[56:59], v[64:67], v[128:143]
    ds_read_b128 v[32:35], v14 offset:0
    s_waitcnt lgkmcnt(4)
    v_mfma_f32_32x32x16_bf16 v[144:159], v[60:63], v[64:67], v[144:159]
    ds_read_b128 v[40:43], v26 offset:0
    s_waitcnt lgkmcnt(4)
    v_mfma_f32_32x32x16_bf16 v[160:175], v[56:59], v[68:71], v[160:175]
    ds_read_b128 v[36:39], v14 offset:1024
    v_mfma_f32_32x32x16_bf16 v[176:191], v[60:63], v[68:71], v[176:191]
    ds_read_b128 v[44:47], v26 offset:8192
    s_waitcnt lgkmcnt(5)
    v_mfma_f32_32x32x16_bf16 v[192:207], v[56:59], v[72:75], v[192:207]
    ds_read_b128 v[48:51], v26 offset:4096
    v_mfma_f32_32x32x16_bf16 v[208:223], v[60:63], v[72:75], v[208:223]
    ds_read_b128 v[52:55], v26 offset:12288
    s_waitcnt lgkmcnt(6)
    v_mfma_f32_32x32x16_bf16 v[224:239], v[56:59], v[76:79], v[224:239]
    v_mfma_f32_32x32x16_bf16 v[240:255], v[60:63], v[76:79], v[240:255]
    s_waitcnt lgkmcnt(5)
    s_waitcnt lgkmcnt(4)
    v_mfma_f32_32x32x16_bf16 v[128:143], v[32:35], v[40:43], v[128:143]
    ds_read_b128 v[56:59], v15 offset:0
    s_waitcnt lgkmcnt(4)
    v_mfma_f32_32x32x16_bf16 v[144:159], v[36:39], v[40:43], v[144:159]
    ds_read_b128 v[64:67], v27 offset:0
    s_waitcnt lgkmcnt(4)
    v_mfma_f32_32x32x16_bf16 v[160:175], v[32:35], v[44:47], v[160:175]
    ds_read_b128 v[60:63], v15 offset:1024
    v_mfma_f32_32x32x16_bf16 v[176:191], v[36:39], v[44:47], v[176:191]
    ds_read_b128 v[68:71], v27 offset:8192
    s_waitcnt lgkmcnt(5)
    v_mfma_f32_32x32x16_bf16 v[192:207], v[32:35], v[48:51], v[192:207]
    ds_read_b128 v[72:75], v27 offset:4096
    v_mfma_f32_32x32x16_bf16 v[208:223], v[36:39], v[48:51], v[208:223]
    ds_read_b128 v[76:79], v27 offset:12288
    s_waitcnt lgkmcnt(6)
    v_mfma_f32_32x32x16_bf16 v[224:239], v[32:35], v[52:55], v[224:239]
    v_mfma_f32_32x32x16_bf16 v[240:255], v[36:39], v[52:55], v[240:255]
    s_waitcnt lgkmcnt(5)
    s_waitcnt lgkmcnt(4)
    v_mfma_f32_32x32x16_bf16 v[128:143], v[56:59], v[64:67], v[128:143]
    s_waitcnt lgkmcnt(3)
    v_mfma_f32_32x32x16_bf16 v[144:159], v[60:63], v[64:67], v[144:159]
    s_waitcnt lgkmcnt(0)
    s_barrier
    v_mfma_f32_32x32x16_bf16 v[160:175], v[56:59], v[68:71], v[160:175]
    ds_read_b128 v[32:35], v8 offset:0
    ds_read_b128 v[40:43], v16 offset:0
    v_mfma_f32_32x32x16_bf16 v[176:191], v[60:63], v[68:71], v[176:191]
    ds_read_b128 v[36:39], v8 offset:1024
    v_mfma_f32_32x32x16_bf16 v[192:207], v[56:59], v[72:75], v[192:207]
    ds_read_b128 v[44:47], v16 offset:8192
    v_mfma_f32_32x32x16_bf16 v[208:223], v[60:63], v[72:75], v[208:223]
    ds_read_b128 v[48:51], v16 offset:4096
    v_mfma_f32_32x32x16_bf16 v[224:239], v[56:59], v[76:79], v[224:239]
    ds_read_b128 v[52:55], v16 offset:12288
    v_mfma_f32_32x32x16_bf16 v[240:255], v[60:63], v[76:79], v[240:255]
    s_waitcnt lgkmcnt(5)
    s_waitcnt lgkmcnt(4)
    v_mfma_f32_32x32x16_bf16 v[128:143], v[32:35], v[40:43], v[128:143]
    ds_read_b128 v[56:59], v9 offset:0
    s_waitcnt lgkmcnt(4)
    v_mfma_f32_32x32x16_bf16 v[144:159], v[36:39], v[40:43], v[144:159]
    ds_read_b128 v[64:67], v17 offset:0
    s_waitcnt lgkmcnt(4)
    v_mfma_f32_32x32x16_bf16 v[160:175], v[32:35], v[44:47], v[160:175]
    ds_read_b128 v[60:63], v9 offset:1024
    v_mfma_f32_32x32x16_bf16 v[176:191], v[36:39], v[44:47], v[176:191]
    ds_read_b128 v[68:71], v17 offset:8192
    s_waitcnt lgkmcnt(5)
    v_mfma_f32_32x32x16_bf16 v[192:207], v[32:35], v[48:51], v[192:207]
    ds_read_b128 v[72:75], v17 offset:4096
    v_mfma_f32_32x32x16_bf16 v[208:223], v[36:39], v[48:51], v[208:223]
    ds_read_b128 v[76:79], v17 offset:12288
    s_waitcnt lgkmcnt(6)
    v_mfma_f32_32x32x16_bf16 v[224:239], v[32:35], v[52:55], v[224:239]
    v_mfma_f32_32x32x16_bf16 v[240:255], v[36:39], v[52:55], v[240:255]
    s_waitcnt lgkmcnt(5)
    s_waitcnt lgkmcnt(4)
    v_mfma_f32_32x32x16_bf16 v[128:143], v[56:59], v[64:67], v[128:143]
    ds_read_b128 v[32:35], v10 offset:0
    s_waitcnt lgkmcnt(4)
    v_mfma_f32_32x32x16_bf16 v[144:159], v[60:63], v[64:67], v[144:159]
    ds_read_b128 v[40:43], v18 offset:0
    s_waitcnt lgkmcnt(4)
    v_mfma_f32_32x32x16_bf16 v[160:175], v[56:59], v[68:71], v[160:175]
    ds_read_b128 v[36:39], v10 offset:1024
    v_mfma_f32_32x32x16_bf16 v[176:191], v[60:63], v[68:71], v[176:191]
    ds_read_b128 v[44:47], v18 offset:8192
    s_waitcnt lgkmcnt(5)
    v_mfma_f32_32x32x16_bf16 v[192:207], v[56:59], v[72:75], v[192:207]
    ds_read_b128 v[48:51], v18 offset:4096
    v_mfma_f32_32x32x16_bf16 v[208:223], v[60:63], v[72:75], v[208:223]
    ds_read_b128 v[52:55], v18 offset:12288
    s_waitcnt lgkmcnt(6)
    v_mfma_f32_32x32x16_bf16 v[224:239], v[56:59], v[76:79], v[224:239]
    v_mfma_f32_32x32x16_bf16 v[240:255], v[60:63], v[76:79], v[240:255]
    s_waitcnt lgkmcnt(5)
    s_waitcnt lgkmcnt(4)
    v_mfma_f32_32x32x16_bf16 v[128:143], v[32:35], v[40:43], v[128:143]
    ds_read_b128 v[56:59], v11 offset:0
    s_waitcnt lgkmcnt(4)
    v_mfma_f32_32x32x16_bf16 v[144:159], v[36:39], v[40:43], v[144:159]
    ds_read_b128 v[64:67], v19 offset:0
    s_waitcnt lgkmcnt(4)
    v_mfma_f32_32x32x16_bf16 v[160:175], v[32:35], v[44:47], v[160:175]
    ds_read_b128 v[60:63], v11 offset:1024
    v_mfma_f32_32x32x16_bf16 v[176:191], v[36:39], v[44:47], v[176:191]
    ds_read_b128 v[68:71], v19 offset:8192
    s_waitcnt lgkmcnt(5)
    v_mfma_f32_32x32x16_bf16 v[192:207], v[32:35], v[48:51], v[192:207]
    ds_read_b128 v[72:75], v19 offset:4096
    v_mfma_f32_32x32x16_bf16 v[208:223], v[36:39], v[48:51], v[208:223]
    ds_read_b128 v[76:79], v19 offset:12288
    s_waitcnt lgkmcnt(6)
    v_mfma_f32_32x32x16_bf16 v[224:239], v[32:35], v[52:55], v[224:239]
    v_mfma_f32_32x32x16_bf16 v[240:255], v[36:39], v[52:55], v[240:255]
    s_waitcnt lgkmcnt(5)
    s_waitcnt lgkmcnt(4)
    v_mfma_f32_32x32x16_bf16 v[128:143], v[56:59], v[64:67], v[128:143]
    s_waitcnt lgkmcnt(3)
    v_mfma_f32_32x32x16_bf16 v[144:159], v[60:63], v[64:67], v[144:159]
    s_waitcnt lgkmcnt(2)
    v_mfma_f32_32x32x16_bf16 v[160:175], v[56:59], v[68:71], v[160:175]
    v_mfma_f32_32x32x16_bf16 v[176:191], v[60:63], v[68:71], v[176:191]
    s_waitcnt lgkmcnt(1)
    v_mfma_f32_32x32x16_bf16 v[192:207], v[56:59], v[72:75], v[192:207]
    v_mfma_f32_32x32x16_bf16 v[208:223], v[60:63], v[72:75], v[208:223]
    s_waitcnt lgkmcnt(0)
    v_mfma_f32_32x32x16_bf16 v[224:239], v[56:59], v[76:79], v[224:239]
    v_mfma_f32_32x32x16_bf16 v[240:255], v[60:63], v[76:79], v[240:255]
    s_barrier
    s_waitcnt vmcnt(0) lgkmcnt(0)
    v_readfirstlane_b32 s15, v30
    ds_read_b128 v[16:19], v108 offset:0
    ds_read_b128 v[20:23], v108 offset:16
    ds_read_b128 v[24:27], v108 offset:32
    ds_read_b128 v[28:31], v108 offset:48
    ds_read_b128 v[32:35], v108 offset:64
    ds_read_b128 v[36:39], v108 offset:80
    ds_read_b128 v[40:43], v108 offset:96
    ds_read_b128 v[44:47], v108 offset:112
    ds_read_b32 v80, v109 offset:0
    ds_read_b32 v81, v109 offset:256
    ds_read_b32 v82, v109 offset:128
    ds_read_b32 v83, v109 offset:384
    s_waitcnt lgkmcnt(0)
    ds_read_b128 v[48:51], v108 offset:1024
    ds_read_b128 v[52:55], v108 offset:1040
    ds_read_b128 v[56:59], v108 offset:1056
    ds_read_b128 v[60:63], v108 offset:1072
    ds_read_b128 v[64:67], v108 offset:1088
    ds_read_b128 v[68:71], v108 offset:1104
    ds_read_b128 v[72:75], v108 offset:1120
    ds_read_b128 v[76:79], v108 offset:1136
    v_pk_fma_f32 v[128:129], v[16:17], v[80:81], v[128:129] op_sel:[0,0,0] op_sel_hi:[1,0,1] neg_lo:[1,0,0] neg_hi:[1,0,0]
    v_pk_fma_f32 v[130:131], v[18:19], v[80:81], v[130:131] op_sel:[0,0,0] op_sel_hi:[1,0,1] neg_lo:[1,0,0] neg_hi:[1,0,0]
    v_pk_fma_f32 v[132:133], v[20:21], v[80:81], v[132:133] op_sel:[0,0,0] op_sel_hi:[1,0,1] neg_lo:[1,0,0] neg_hi:[1,0,0]
    v_pk_fma_f32 v[134:135], v[22:23], v[80:81], v[134:135] op_sel:[0,0,0] op_sel_hi:[1,0,1] neg_lo:[1,0,0] neg_hi:[1,0,0]
    v_pk_fma_f32 v[136:137], v[24:25], v[80:81], v[136:137] op_sel:[0,0,0] op_sel_hi:[1,0,1] neg_lo:[1,0,0] neg_hi:[1,0,0]
    v_pk_fma_f32 v[138:139], v[26:27], v[80:81], v[138:139] op_sel:[0,0,0] op_sel_hi:[1,0,1] neg_lo:[1,0,0] neg_hi:[1,0,0]
    v_pk_fma_f32 v[140:141], v[28:29], v[80:81], v[140:141] op_sel:[0,0,0] op_sel_hi:[1,0,1] neg_lo:[1,0,0] neg_hi:[1,0,0]
    v_pk_fma_f32 v[142:143], v[30:31], v[80:81], v[142:143] op_sel:[0,0,0] op_sel_hi:[1,0,1] neg_lo:[1,0,0] neg_hi:[1,0,0]
    v_pk_fma_f32 v[144:145], v[32:33], v[80:81], v[144:145] op_sel:[0,0,0] op_sel_hi:[1,0,1] neg_lo:[1,0,0] neg_hi:[1,0,0]
    v_pk_fma_f32 v[146:147], v[34:35], v[80:81], v[146:147] op_sel:[0,0,0] op_sel_hi:[1,0,1] neg_lo:[1,0,0] neg_hi:[1,0,0]
    v_pk_fma_f32 v[148:149], v[36:37], v[80:81], v[148:149] op_sel:[0,0,0] op_sel_hi:[1,0,1] neg_lo:[1,0,0] neg_hi:[1,0,0]
    v_pk_fma_f32 v[150:151], v[38:39], v[80:81], v[150:151] op_sel:[0,0,0] op_sel_hi:[1,0,1] neg_lo:[1,0,0] neg_hi:[1,0,0]
    v_pk_fma_f32 v[152:153], v[40:41], v[80:81], v[152:153] op_sel:[0,0,0] op_sel_hi:[1,0,1] neg_lo:[1,0,0] neg_hi:[1,0,0]
    v_pk_fma_f32 v[154:155], v[42:43], v[80:81], v[154:155] op_sel:[0,0,0] op_sel_hi:[1,0,1] neg_lo:[1,0,0] neg_hi:[1,0,0]
    v_pk_fma_f32 v[156:157], v[44:45], v[80:81], v[156:157] op_sel:[0,0,0] op_sel_hi:[1,0,1] neg_lo:[1,0,0] neg_hi:[1,0,0]
    v_pk_fma_f32 v[158:159], v[46:47], v[80:81], v[158:159] op_sel:[0,0,0] op_sel_hi:[1,0,1] neg_lo:[1,0,0] neg_hi:[1,0,0]
    v_pk_fma_f32 v[160:161], v[16:17], v[80:81], v[160:161] op_sel:[0,1,0] op_sel_hi:[1,1,1] neg_lo:[1,0,0] neg_hi:[1,0,0]
    v_pk_fma_f32 v[162:163], v[18:19], v[80:81], v[162:163] op_sel:[0,1,0] op_sel_hi:[1,1,1] neg_lo:[1,0,0] neg_hi:[1,0,0]
    v_pk_fma_f32 v[164:165], v[20:21], v[80:81], v[164:165] op_sel:[0,1,0] op_sel_hi:[1,1,1] neg_lo:[1,0,0] neg_hi:[1,0,0]
    v_pk_fma_f32 v[166:167], v[22:23], v[80:81], v[166:167] op_sel:[0,1,0] op_sel_hi:[1,1,1] neg_lo:[1,0,0] neg_hi:[1,0,0]
    v_pk_fma_f32 v[168:169], v[24:25], v[80:81], v[168:169] op_sel:[0,1,0] op_sel_hi:[1,1,1] neg_lo:[1,0,0] neg_hi:[1,0,0]
    v_pk_fma_f32 v[170:171], v[26:27], v[80:81], v[170:171] op_sel:[0,1,0] op_sel_hi:[1,1,1] neg_lo:[1,0,0] neg_hi:[1,0,0]
    v_pk_fma_f32 v[172:173], v[28:29], v[80:81], v[172:173] op_sel:[0,1,0] op_sel_hi:[1,1,1] neg_lo:[1,0,0] neg_hi:[1,0,0]
    v_pk_fma_f32 v[174:175], v[30:31], v[80:81], v[174:175] op_sel:[0,1,0] op_sel_hi:[1,1,1] neg_lo:[1,0,0] neg_hi:[1,0,0]
    v_pk_fma_f32 v[176:177], v[32:33], v[80:81], v[176:177] op_sel:[0,1,0] op_sel_hi:[1,1,1] neg_lo:[1,0,0] neg_hi:[1,0,0]
    v_pk_fma_f32 v[178:179], v[34:35], v[80:81], v[178:179] op_sel:[0,1,0] op_sel_hi:[1,1,1] neg_lo:[1,0,0] neg_hi:[1,0,0]
    v_pk_fma_f32 v[180:181], v[36:37], v[80:81], v[180:181] op_sel:[0,1,0] op_sel_hi:[1,1,1] neg_lo:[1,0,0] neg_hi:[1,0,0]
    v_pk_fma_f32 v[182:183], v[38:39], v[80:81], v[182:183] op_sel:[0,1,0] op_sel_hi:[1,1,1] neg_lo:[1,0,0] neg_hi:[1,0,0]
    v_pk_fma_f32 v[184:185], v[40:41], v[80:81], v[184:185] op_sel:[0,1,0] op_sel_hi:[1,1,1] neg_lo:[1,0,0] neg_hi:[1,0,0]
    v_pk_fma_f32 v[186:187], v[42:43], v[80:81], v[186:187] op_sel:[0,1,0] op_sel_hi:[1,1,1] neg_lo:[1,0,0] neg_hi:[1,0,0]
    v_pk_fma_f32 v[188:189], v[44:45], v[80:81], v[188:189] op_sel:[0,1,0] op_sel_hi:[1,1,1] neg_lo:[1,0,0] neg_hi:[1,0,0]
    v_pk_fma_f32 v[190:191], v[46:47], v[80:81], v[190:191] op_sel:[0,1,0] op_sel_hi:[1,1,1] neg_lo:[1,0,0] neg_hi:[1,0,0]
    v_pk_fma_f32 v[192:193], v[16:17], v[82:83], v[192:193] op_sel:[0,0,0] op_sel_hi:[1,0,1] neg_lo:[1,0,0] neg_hi:[1,0,0]
    v_pk_fma_f32 v[194:195], v[18:19], v[82:83], v[194:195] op_sel:[0,0,0] op_sel_hi:[1,0,1] neg_lo:[1,0,0] neg_hi:[1,0,0]
    v_pk_fma_f32 v[196:197], v[20:21], v[82:83], v[196:197] op_sel:[0,0,0] op_sel_hi:[1,0,1] neg_lo:[1,0,0] neg_hi:[1,0,0]
    v_pk_fma_f32 v[198:199], v[22:23], v[82:83], v[198:199] op_sel:[0,0,0] op_sel_hi:[1,0,1] neg_lo:[1,0,0] neg_hi:[1,0,0]
    v_pk_fma_f32 v[200:201], v[24:25], v[82:83], v[200:201] op_sel:[0,0,0] op_sel_hi:[1,0,1] neg_lo:[1,0,0] neg_hi:[1,0,0]
    v_pk_fma_f32 v[202:203], v[26:27], v[82:83], v[202:203] op_sel:[0,0,0] op_sel_hi:[1,0,1] neg_lo:[1,0,0] neg_hi:[1,0,0]
    v_pk_fma_f32 v[204:205], v[28:29], v[82:83], v[204:205] op_sel:[0,0,0] op_sel_hi:[1,0,1] neg_lo:[1,0,0] neg_hi:[1,0,0]
    v_pk_fma_f32 v[206:207], v[30:31], v[82:83], v[206:207] op_sel:[0,0,0] op_sel_hi:[1,0,1] neg_lo:[1,0,0] neg_hi:[1,0,0]
    v_pk_fma_f32 v[208:209], v[32:33], v[82:83], v[208:209] op_sel:[0,0,0] op_sel_hi:[1,0,1] neg_lo:[1,0,0] neg_hi:[1,0,0]
    v_pk_fma_f32 v[210:211], v[34:35], v[82:83], v[210:211] op_sel:[0,0,0] op_sel_hi:[1,0,1] neg_lo:[1,0,0] neg_hi:[1,0,0]
    v_pk_fma_f32 v[212:213], v[36:37], v[82:83], v[212:213] op_sel:[0,0,0] op_sel_hi:[1,0,1] neg_lo:[1,0,0] neg_hi:[1,0,0]
    v_pk_fma_f32 v[214:215], v[38:39], v[82:83], v[214:215] op_sel:[0,0,0] op_sel_hi:[1,0,1] neg_lo:[1,0,0] neg_hi:[1,0,0]
    v_pk_fma_f32 v[216:217], v[40:41], v[82:83], v[216:217] op_sel:[0,0,0] op_sel_hi:[1,0,1] neg_lo:[1,0,0] neg_hi:[1,0,0]
    v_pk_fma_f32 v[218:219], v[42:43], v[82:83], v[218:219] op_sel:[0,0,0] op_sel_hi:[1,0,1] neg_lo:[1,0,0] neg_hi:[1,0,0]
    v_pk_fma_f32 v[220:221], v[44:45], v[82:83], v[220:221] op_sel:[0,0,0] op_sel_hi:[1,0,1] neg_lo:[1,0,0] neg_hi:[1,0,0]
    v_pk_fma_f32 v[222:223], v[46:47], v[82:83], v[222:223] op_sel:[0,0,0] op_sel_hi:[1,0,1] neg_lo:[1,0,0] neg_hi:[1,0,0]
    v_pk_fma_f32 v[224:225], v[16:17], v[82:83], v[224:225] op_sel:[0,1,0] op_sel_hi:[1,1,1] neg_lo:[1,0,0] neg_hi:[1,0,0]
    v_pk_fma_f32 v[226:227], v[18:19], v[82:83], v[226:227] op_sel:[0,1,0] op_sel_hi:[1,1,1] neg_lo:[1,0,0] neg_hi:[1,0,0]
    v_pk_fma_f32 v[228:229], v[20:21], v[82:83], v[228:229] op_sel:[0,1,0] op_sel_hi:[1,1,1] neg_lo:[1,0,0] neg_hi:[1,0,0]
    v_pk_fma_f32 v[230:231], v[22:23], v[82:83], v[230:231] op_sel:[0,1,0] op_sel_hi:[1,1,1] neg_lo:[1,0,0] neg_hi:[1,0,0]
    v_pk_fma_f32 v[232:233], v[24:25], v[82:83], v[232:233] op_sel:[0,1,0] op_sel_hi:[1,1,1] neg_lo:[1,0,0] neg_hi:[1,0,0]
    v_pk_fma_f32 v[234:235], v[26:27], v[82:83], v[234:235] op_sel:[0,1,0] op_sel_hi:[1,1,1] neg_lo:[1,0,0] neg_hi:[1,0,0]
    v_pk_fma_f32 v[236:237], v[28:29], v[82:83], v[236:237] op_sel:[0,1,0] op_sel_hi:[1,1,1] neg_lo:[1,0,0] neg_hi:[1,0,0]
    v_pk_fma_f32 v[238:239], v[30:31], v[82:83], v[238:239] op_sel:[0,1,0] op_sel_hi:[1,1,1] neg_lo:[1,0,0] neg_hi:[1,0,0]
    v_pk_fma_f32 v[240:241], v[32:33], v[82:83], v[240:241] op_sel:[0,1,0] op_sel_hi:[1,1,1] neg_lo:[1,0,0] neg_hi:[1,0,0]
    v_pk_fma_f32 v[242:243], v[34:35], v[82:83], v[242:243] op_sel:[0,1,0] op_sel_hi:[1,1,1] neg_lo:[1,0,0] neg_hi:[1,0,0]
    v_pk_fma_f32 v[244:245], v[36:37], v[82:83], v[244:245] op_sel:[0,1,0] op_sel_hi:[1,1,1] neg_lo:[1,0,0] neg_hi:[1,0,0]
    v_pk_fma_f32 v[246:247], v[38:39], v[82:83], v[246:247] op_sel:[0,1,0] op_sel_hi:[1,1,1] neg_lo:[1,0,0] neg_hi:[1,0,0]
    v_pk_fma_f32 v[248:249], v[40:41], v[82:83], v[248:249] op_sel:[0,1,0] op_sel_hi:[1,1,1] neg_lo:[1,0,0] neg_hi:[1,0,0]
    v_pk_fma_f32 v[250:251], v[42:43], v[82:83], v[250:251] op_sel:[0,1,0] op_sel_hi:[1,1,1] neg_lo:[1,0,0] neg_hi:[1,0,0]
    v_pk_fma_f32 v[252:253], v[44:45], v[82:83], v[252:253] op_sel:[0,1,0] op_sel_hi:[1,1,1] neg_lo:[1,0,0] neg_hi:[1,0,0]
    v_pk_fma_f32 v[254:255], v[46:47], v[82:83], v[254:255] op_sel:[0,1,0] op_sel_hi:[1,1,1] neg_lo:[1,0,0] neg_hi:[1,0,0]
    s_waitcnt lgkmcnt(0)
    v_pk_mul_f32 v[128:129], v[128:129], v[48:49]
    v_pk_mul_f32 v[160:161], v[160:161], v[48:49]
    v_pk_mul_f32 v[192:193], v[192:193], v[48:49]
    v_pk_mul_f32 v[224:225], v[224:225], v[48:49]
    v_pk_mul_f32 v[130:131], v[130:131], v[50:51]
    v_pk_mul_f32 v[162:163], v[162:163], v[50:51]
    v_pk_mul_f32 v[194:195], v[194:195], v[50:51]
    v_pk_mul_f32 v[226:227], v[226:227], v[50:51]
    v_pk_fma_f32 v[116:117], v[88:89], v[160:161], v[130:131] op_sel:[1,0,0] op_sel_hi:[1,1,1] neg_lo:[1,0,0] neg_hi:[1,0,0]
    v_pk_fma_f32 v[118:119], v[88:89], v[128:129], v[162:163] op_sel:[1,0,0] op_sel_hi:[1,1,1]
    v_pk_fma_f32 v[120:121], v[96:97], v[224:225], v[194:195] op_sel:[1,0,0] op_sel_hi:[1,1,1] neg_lo:[1,0,0] neg_hi:[1,0,0]
    v_pk_fma_f32 v[122:123], v[96:97], v[192:193], v[226:227] op_sel:[1,0,0] op_sel_hi:[1,1,1]
    v_pk_fma_f32 v[8:9], v[88:89], v[128:129], v[116:117] op_sel:[0,0,0] op_sel_hi:[0,1,1]
    v_pk_fma_f32 v[10:11], v[88:89], v[160:161], v[118:119] op_sel:[0,0,0] op_sel_hi:[0,1,1]
    v_pk_fma_f32 v[12:13], v[96:97], v[192:193], v[120:121] op_sel:[0,0,0] op_sel_hi:[0,1,1]
    v_pk_fma_f32 v[14:15], v[96:97], v[224:225], v[122:123] op_sel:[0,0,0] op_sel_hi:[0,1,1]
    v_pk_mul_f32 v[132:133], v[132:133], v[52:53]
    v_pk_mul_f32 v[164:165], v[164:165], v[52:53]
    v_pk_mul_f32 v[196:197], v[196:197], v[52:53]
    v_pk_mul_f32 v[228:229], v[228:229], v[52:53]
    v_pk_fma_f32 v[116:117], v[88:89], v[10:11], v[132:133] op_sel:[1,0,0] op_sel_hi:[1,1,1] neg_lo:[1,0,0] neg_hi:[1,0,0]
    v_pk_fma_f32 v[118:119], v[88:89], v[8:9], v[164:165] op_sel:[1,0,0] op_sel_hi:[1,1,1]
    v_pk_fma_f32 v[120:121], v[96:97], v[14:15], v[196:197] op_sel:[1,0,0] op_sel_hi:[1,1,1] neg_lo:[1,0,0] neg_hi:[1,0,0]
    v_pk_fma_f32 v[122:123], v[96:97], v[12:13], v[228:229] op_sel:[1,0,0] op_sel_hi:[1,1,1]
    v_pk_fma_f32 v[8:9], v[88:89], v[8:9], v[116:117] op_sel:[0,0,0] op_sel_hi:[0,1,1]
    v_pk_fma_f32 v[10:11], v[88:89], v[10:11], v[118:119] op_sel:[0,0,0] op_sel_hi:[0,1,1]
    v_pk_fma_f32 v[12:13], v[96:97], v[12:13], v[120:121] op_sel:[0,0,0] op_sel_hi:[0,1,1]
    v_pk_fma_f32 v[14:15], v[96:97], v[14:15], v[122:123] op_sel:[0,0,0] op_sel_hi:[0,1,1]
    v_pk_mul_f32 v[134:135], v[134:135], v[54:55]
    v_pk_mul_f32 v[166:167], v[166:167], v[54:55]
    v_pk_mul_f32 v[198:199], v[198:199], v[54:55]
    v_pk_mul_f32 v[230:231], v[230:231], v[54:55]
    v_pk_fma_f32 v[116:117], v[88:89], v[10:11], v[134:135] op_sel:[1,0,0] op_sel_hi:[1,1,1] neg_lo:[1,0,0] neg_hi:[1,0,0]
    v_pk_fma_f32 v[118:119], v[88:89], v[8:9], v[166:167] op_sel:[1,0,0] op_sel_hi:[1,1,1]
    v_pk_fma_f32 v[120:121], v[96:97], v[14:15], v[198:199] op_sel:[1,0,0] op_sel_hi:[1,1,1] neg_lo:[1,0,0] neg_hi:[1,0,0]
    v_pk_fma_f32 v[122:123], v[96:97], v[12:13], v[230:231] op_sel:[1,0,0] op_sel_hi:[1,1,1]
    v_pk_fma_f32 v[8:9], v[88:89], v[8:9], v[116:117] op_sel:[0,0,0] op_sel_hi:[0,1,1]
    v_pk_fma_f32 v[10:11], v[88:89], v[10:11], v[118:119] op_sel:[0,0,0] op_sel_hi:[0,1,1]
    v_pk_fma_f32 v[12:13], v[96:97], v[12:13], v[120:121] op_sel:[0,0,0] op_sel_hi:[0,1,1]
    v_pk_fma_f32 v[14:15], v[96:97], v[14:15], v[122:123] op_sel:[0,0,0] op_sel_hi:[0,1,1]
    v_pk_mul_f32 v[136:137], v[136:137], v[56:57]
    v_pk_mul_f32 v[168:169], v[168:169], v[56:57]
    v_pk_mul_f32 v[200:201], v[200:201], v[56:57]
    v_pk_mul_f32 v[232:233], v[232:233], v[56:57]
    v_pk_fma_f32 v[116:117], v[88:89], v[10:11], v[136:137] op_sel:[1,0,0] op_sel_hi:[1,1,1] neg_lo:[1,0,0] neg_hi:[1,0,0]
    v_pk_fma_f32 v[118:119], v[88:89], v[8:9], v[168:169] op_sel:[1,0,0] op_sel_hi:[1,1,1]
    v_pk_fma_f32 v[120:121], v[96:97], v[14:15], v[200:201] op_sel:[1,0,0] op_sel_hi:[1,1,1] neg_lo:[1,0,0] neg_hi:[1,0,0]
    v_pk_fma_f32 v[122:123], v[96:97], v[12:13], v[232:233] op_sel:[1,0,0] op_sel_hi:[1,1,1]
    v_pk_fma_f32 v[8:9], v[88:89], v[8:9], v[116:117] op_sel:[0,0,0] op_sel_hi:[0,1,1]
    v_pk_fma_f32 v[10:11], v[88:89], v[10:11], v[118:119] op_sel:[0,0,0] op_sel_hi:[0,1,1]
    v_pk_fma_f32 v[12:13], v[96:97], v[12:13], v[120:121] op_sel:[0,0,0] op_sel_hi:[0,1,1]
    v_pk_fma_f32 v[14:15], v[96:97], v[14:15], v[122:123] op_sel:[0,0,0] op_sel_hi:[0,1,1]
    v_pk_mul_f32 v[138:139], v[138:139], v[58:59]
    v_pk_mul_f32 v[170:171], v[170:171], v[58:59]
    v_pk_mul_f32 v[202:203], v[202:203], v[58:59]
    v_pk_mul_f32 v[234:235], v[234:235], v[58:59]
    v_pk_fma_f32 v[116:117], v[88:89], v[10:11], v[138:139] op_sel:[1,0,0] op_sel_hi:[1,1,1] neg_lo:[1,0,0] neg_hi:[1,0,0]
    v_pk_fma_f32 v[118:119], v[88:89], v[8:9], v[170:171] op_sel:[1,0,0] op_sel_hi:[1,1,1]
    v_pk_fma_f32 v[120:121], v[96:97], v[14:15], v[202:203] op_sel:[1,0,0] op_sel_hi:[1,1,1] neg_lo:[1,0,0] neg_hi:[1,0,0]
    v_pk_fma_f32 v[122:123], v[96:97], v[12:13], v[234:235] op_sel:[1,0,0] op_sel_hi:[1,1,1]
    v_pk_fma_f32 v[8:9], v[88:89], v[8:9], v[116:117] op_sel:[0,0,0] op_sel_hi:[0,1,1]
    v_pk_fma_f32 v[10:11], v[88:89], v[10:11], v[118:119] op_sel:[0,0,0] op_sel_hi:[0,1,1]
    v_pk_fma_f32 v[12:13], v[96:97], v[12:13], v[120:121] op_sel:[0,0,0] op_sel_hi:[0,1,1]
    v_pk_fma_f32 v[14:15], v[96:97], v[14:15], v[122:123] op_sel:[0,0,0] op_sel_hi:[0,1,1]
    v_pk_mul_f32 v[140:141], v[140:141], v[60:61]
    v_pk_mul_f32 v[172:173], v[172:173], v[60:61]
    v_pk_mul_f32 v[204:205], v[204:205], v[60:61]
    v_pk_mul_f32 v[236:237], v[236:237], v[60:61]
    v_pk_fma_f32 v[116:117], v[88:89], v[10:11], v[140:141] op_sel:[1,0,0] op_sel_hi:[1,1,1] neg_lo:[1,0,0] neg_hi:[1,0,0]
    v_pk_fma_f32 v[118:119], v[88:89], v[8:9], v[172:173] op_sel:[1,0,0] op_sel_hi:[1,1,1]
    v_pk_fma_f32 v[120:121], v[96:97], v[14:15], v[204:205] op_sel:[1,0,0] op_sel_hi:[1,1,1] neg_lo:[1,0,0] neg_hi:[1,0,0]
    v_pk_fma_f32 v[122:123], v[96:97], v[12:13], v[236:237] op_sel:[1,0,0] op_sel_hi:[1,1,1]
    v_pk_fma_f32 v[8:9], v[88:89], v[8:9], v[116:117] op_sel:[0,0,0] op_sel_hi:[0,1,1]
    v_pk_fma_f32 v[10:11], v[88:89], v[10:11], v[118:119] op_sel:[0,0,0] op_sel_hi:[0,1,1]
    v_pk_fma_f32 v[12:13], v[96:97], v[12:13], v[120:121] op_sel:[0,0,0] op_sel_hi:[0,1,1]
    v_pk_fma_f32 v[14:15], v[96:97], v[14:15], v[122:123] op_sel:[0,0,0] op_sel_hi:[0,1,1]
    v_pk_mul_f32 v[142:143], v[142:143], v[62:63]
    v_pk_mul_f32 v[174:175], v[174:175], v[62:63]
    v_pk_mul_f32 v[206:207], v[206:207], v[62:63]
    v_pk_mul_f32 v[238:239], v[238:239], v[62:63]
    v_pk_fma_f32 v[116:117], v[88:89], v[10:11], v[142:143] op_sel:[1,0,0] op_sel_hi:[1,1,1] neg_lo:[1,0,0] neg_hi:[1,0,0]
    v_pk_fma_f32 v[118:119], v[88:89], v[8:9], v[174:175] op_sel:[1,0,0] op_sel_hi:[1,1,1]
    v_pk_fma_f32 v[120:121], v[96:97], v[14:15], v[206:207] op_sel:[1,0,0] op_sel_hi:[1,1,1] neg_lo:[1,0,0] neg_hi:[1,0,0]
    v_pk_fma_f32 v[122:123], v[96:97], v[12:13], v[238:239] op_sel:[1,0,0] op_sel_hi:[1,1,1]
    v_pk_fma_f32 v[8:9], v[88:89], v[8:9], v[116:117] op_sel:[0,0,0] op_sel_hi:[0,1,1]
    v_pk_fma_f32 v[10:11], v[88:89], v[10:11], v[118:119] op_sel:[0,0,0] op_sel_hi:[0,1,1]
    v_pk_fma_f32 v[12:13], v[96:97], v[12:13], v[120:121] op_sel:[0,0,0] op_sel_hi:[0,1,1]
    v_pk_fma_f32 v[14:15], v[96:97], v[14:15], v[122:123] op_sel:[0,0,0] op_sel_hi:[0,1,1]
    v_pk_mul_f32 v[144:145], v[144:145], v[64:65]
    v_pk_mul_f32 v[176:177], v[176:177], v[64:65]
    v_pk_mul_f32 v[208:209], v[208:209], v[64:65]
    v_pk_mul_f32 v[240:241], v[240:241], v[64:65]
    v_pk_fma_f32 v[116:117], v[88:89], v[10:11], v[144:145] op_sel:[1,0,0] op_sel_hi:[1,1,1] neg_lo:[1,0,0] neg_hi:[1,0,0]
    v_pk_fma_f32 v[118:119], v[88:89], v[8:9], v[176:177] op_sel:[1,0,0] op_sel_hi:[1,1,1]
    v_pk_fma_f32 v[120:121], v[96:97], v[14:15], v[208:209] op_sel:[1,0,0] op_sel_hi:[1,1,1] neg_lo:[1,0,0] neg_hi:[1,0,0]
    v_pk_fma_f32 v[122:123], v[96:97], v[12:13], v[240:241] op_sel:[1,0,0] op_sel_hi:[1,1,1]
    v_pk_fma_f32 v[8:9], v[88:89], v[8:9], v[116:117] op_sel:[0,0,0] op_sel_hi:[0,1,1]
    v_pk_fma_f32 v[10:11], v[88:89], v[10:11], v[118:119] op_sel:[0,0,0] op_sel_hi:[0,1,1]
    v_pk_fma_f32 v[12:13], v[96:97], v[12:13], v[120:121] op_sel:[0,0,0] op_sel_hi:[0,1,1]
    v_pk_fma_f32 v[14:15], v[96:97], v[14:15], v[122:123] op_sel:[0,0,0] op_sel_hi:[0,1,1]
    v_pk_mul_f32 v[146:147], v[146:147], v[66:67]
    v_pk_mul_f32 v[178:179], v[178:179], v[66:67]
    v_pk_mul_f32 v[210:211], v[210:211], v[66:67]
    v_pk_mul_f32 v[242:243], v[242:243], v[66:67]
    v_pk_fma_f32 v[116:117], v[88:89], v[10:11], v[146:147] op_sel:[1,0,0] op_sel_hi:[1,1,1] neg_lo:[1,0,0] neg_hi:[1,0,0]
    v_pk_fma_f32 v[118:119], v[88:89], v[8:9], v[178:179] op_sel:[1,0,0] op_sel_hi:[1,1,1]
    v_pk_fma_f32 v[120:121], v[96:97], v[14:15], v[210:211] op_sel:[1,0,0] op_sel_hi:[1,1,1] neg_lo:[1,0,0] neg_hi:[1,0,0]
    v_pk_fma_f32 v[122:123], v[96:97], v[12:13], v[242:243] op_sel:[1,0,0] op_sel_hi:[1,1,1]
    v_pk_fma_f32 v[8:9], v[88:89], v[8:9], v[116:117] op_sel:[0,0,0] op_sel_hi:[0,1,1]
    v_pk_fma_f32 v[10:11], v[88:89], v[10:11], v[118:119] op_sel:[0,0,0] op_sel_hi:[0,1,1]
    v_pk_fma_f32 v[12:13], v[96:97], v[12:13], v[120:121] op_sel:[0,0,0] op_sel_hi:[0,1,1]
    v_pk_fma_f32 v[14:15], v[96:97], v[14:15], v[122:123] op_sel:[0,0,0] op_sel_hi:[0,1,1]
    v_pk_mul_f32 v[148:149], v[148:149], v[68:69]
    v_pk_mul_f32 v[180:181], v[180:181], v[68:69]
    v_pk_mul_f32 v[212:213], v[212:213], v[68:69]
    v_pk_mul_f32 v[244:245], v[244:245], v[68:69]
    v_pk_fma_f32 v[116:117], v[88:89], v[10:11], v[148:149] op_sel:[1,0,0] op_sel_hi:[1,1,1] neg_lo:[1,0,0] neg_hi:[1,0,0]
    v_pk_fma_f32 v[118:119], v[88:89], v[8:9], v[180:181] op_sel:[1,0,0] op_sel_hi:[1,1,1]
    v_pk_fma_f32 v[120:121], v[96:97], v[14:15], v[212:213] op_sel:[1,0,0] op_sel_hi:[1,1,1] neg_lo:[1,0,0] neg_hi:[1,0,0]
    v_pk_fma_f32 v[122:123], v[96:97], v[12:13], v[244:245] op_sel:[1,0,0] op_sel_hi:[1,1,1]
    v_pk_fma_f32 v[8:9], v[88:89], v[8:9], v[116:117] op_sel:[0,0,0] op_sel_hi:[0,1,1]
    v_pk_fma_f32 v[10:11], v[88:89], v[10:11], v[118:119] op_sel:[0,0,0] op_sel_hi:[0,1,1]
    v_pk_fma_f32 v[12:13], v[96:97], v[12:13], v[120:121] op_sel:[0,0,0] op_sel_hi:[0,1,1]
    v_pk_fma_f32 v[14:15], v[96:97], v[14:15], v[122:123] op_sel:[0,0,0] op_sel_hi:[0,1,1]
    v_pk_mul_f32 v[150:151], v[150:151], v[70:71]
    v_pk_mul_f32 v[182:183], v[182:183], v[70:71]
    v_pk_mul_f32 v[214:215], v[214:215], v[70:71]
    v_pk_mul_f32 v[246:247], v[246:247], v[70:71]
    v_pk_fma_f32 v[116:117], v[88:89], v[10:11], v[150:151] op_sel:[1,0,0] op_sel_hi:[1,1,1] neg_lo:[1,0,0] neg_hi:[1,0,0]
    v_pk_fma_f32 v[118:119], v[88:89], v[8:9], v[182:183] op_sel:[1,0,0] op_sel_hi:[1,1,1]
    v_pk_fma_f32 v[120:121], v[96:97], v[14:15], v[214:215] op_sel:[1,0,0] op_sel_hi:[1,1,1] neg_lo:[1,0,0] neg_hi:[1,0,0]
    v_pk_fma_f32 v[122:123], v[96:97], v[12:13], v[246:247] op_sel:[1,0,0] op_sel_hi:[1,1,1]
    v_pk_fma_f32 v[8:9], v[88:89], v[8:9], v[116:117] op_sel:[0,0,0] op_sel_hi:[0,1,1]
    v_pk_fma_f32 v[10:11], v[88:89], v[10:11], v[118:119] op_sel:[0,0,0] op_sel_hi:[0,1,1]
    v_pk_fma_f32 v[12:13], v[96:97], v[12:13], v[120:121] op_sel:[0,0,0] op_sel_hi:[0,1,1]
    v_pk_fma_f32 v[14:15], v[96:97], v[14:15], v[122:123] op_sel:[0,0,0] op_sel_hi:[0,1,1]
    v_pk_mul_f32 v[152:153], v[152:153], v[72:73]
    v_pk_mul_f32 v[184:185], v[184:185], v[72:73]
    v_pk_mul_f32 v[216:217], v[216:217], v[72:73]
    v_pk_mul_f32 v[248:249], v[248:249], v[72:73]
    v_pk_fma_f32 v[116:117], v[88:89], v[10:11], v[152:153] op_sel:[1,0,0] op_sel_hi:[1,1,1] neg_lo:[1,0,0] neg_hi:[1,0,0]
    v_pk_fma_f32 v[118:119], v[88:89], v[8:9], v[184:185] op_sel:[1,0,0] op_sel_hi:[1,1,1]
    v_pk_fma_f32 v[120:121], v[96:97], v[14:15], v[216:217] op_sel:[1,0,0] op_sel_hi:[1,1,1] neg_lo:[1,0,0] neg_hi:[1,0,0]
    v_pk_fma_f32 v[122:123], v[96:97], v[12:13], v[248:249] op_sel:[1,0,0] op_sel_hi:[1,1,1]
    v_pk_fma_f32 v[8:9], v[88:89], v[8:9], v[116:117] op_sel:[0,0,0] op_sel_hi:[0,1,1]
    v_pk_fma_f32 v[10:11], v[88:89], v[10:11], v[118:119] op_sel:[0,0,0] op_sel_hi:[0,1,1]
    v_pk_fma_f32 v[12:13], v[96:97], v[12:13], v[120:121] op_sel:[0,0,0] op_sel_hi:[0,1,1]
    v_pk_fma_f32 v[14:15], v[96:97], v[14:15], v[122:123] op_sel:[0,0,0] op_sel_hi:[0,1,1]
    v_pk_mul_f32 v[154:155], v[154:155], v[74:75]
    v_pk_mul_f32 v[186:187], v[186:187], v[74:75]
    v_pk_mul_f32 v[218:219], v[218:219], v[74:75]
    v_pk_mul_f32 v[250:251], v[250:251], v[74:75]
    v_pk_fma_f32 v[116:117], v[88:89], v[10:11], v[154:155] op_sel:[1,0,0] op_sel_hi:[1,1,1] neg_lo:[1,0,0] neg_hi:[1,0,0]
    v_pk_fma_f32 v[118:119], v[88:89], v[8:9], v[186:187] op_sel:[1,0,0] op_sel_hi:[1,1,1]
    v_pk_fma_f32 v[120:121], v[96:97], v[14:15], v[218:219] op_sel:[1,0,0] op_sel_hi:[1,1,1] neg_lo:[1,0,0] neg_hi:[1,0,0]
    v_pk_fma_f32 v[122:123], v[96:97], v[12:13], v[250:251] op_sel:[1,0,0] op_sel_hi:[1,1,1]
    v_pk_fma_f32 v[8:9], v[88:89], v[8:9], v[116:117] op_sel:[0,0,0] op_sel_hi:[0,1,1]
    v_pk_fma_f32 v[10:11], v[88:89], v[10:11], v[118:119] op_sel:[0,0,0] op_sel_hi:[0,1,1]
    v_pk_fma_f32 v[12:13], v[96:97], v[12:13], v[120:121] op_sel:[0,0,0] op_sel_hi:[0,1,1]
    v_pk_fma_f32 v[14:15], v[96:97], v[14:15], v[122:123] op_sel:[0,0,0] op_sel_hi:[0,1,1]
    v_pk_mul_f32 v[156:157], v[156:157], v[76:77]
    v_pk_mul_f32 v[188:189], v[188:189], v[76:77]
    v_pk_mul_f32 v[220:221], v[220:221], v[76:77]
    v_pk_mul_f32 v[252:253], v[252:253], v[76:77]
    v_pk_fma_f32 v[116:117], v[88:89], v[10:11], v[156:157] op_sel:[1,0,0] op_sel_hi:[1,1,1] neg_lo:[1,0,0] neg_hi:[1,0,0]
    v_pk_fma_f32 v[118:119], v[88:89], v[8:9], v[188:189] op_sel:[1,0,0] op_sel_hi:[1,1,1]
    v_pk_fma_f32 v[120:121], v[96:97], v[14:15], v[220:221] op_sel:[1,0,0] op_sel_hi:[1,1,1] neg_lo:[1,0,0] neg_hi:[1,0,0]
    v_pk_fma_f32 v[122:123], v[96:97], v[12:13], v[252:253] op_sel:[1,0,0] op_sel_hi:[1,1,1]
    v_pk_fma_f32 v[8:9], v[88:89], v[8:9], v[116:117] op_sel:[0,0,0] op_sel_hi:[0,1,1]
    v_pk_fma_f32 v[10:11], v[88:89], v[10:11], v[118:119] op_sel:[0,0,0] op_sel_hi:[0,1,1]
    v_pk_fma_f32 v[12:13], v[96:97], v[12:13], v[120:121] op_sel:[0,0,0] op_sel_hi:[0,1,1]
    v_pk_fma_f32 v[14:15], v[96:97], v[14:15], v[122:123] op_sel:[0,0,0] op_sel_hi:[0,1,1]
    v_pk_mul_f32 v[158:159], v[158:159], v[78:79]
    v_pk_mul_f32 v[190:191], v[190:191], v[78:79]
    v_pk_mul_f32 v[222:223], v[222:223], v[78:79]
    v_pk_mul_f32 v[254:255], v[254:255], v[78:79]
    v_pk_fma_f32 v[116:117], v[88:89], v[10:11], v[158:159] op_sel:[1,0,0] op_sel_hi:[1,1,1] neg_lo:[1,0,0] neg_hi:[1,0,0]
    v_pk_fma_f32 v[118:119], v[88:89], v[8:9], v[190:191] op_sel:[1,0,0] op_sel_hi:[1,1,1]
    v_pk_fma_f32 v[120:121], v[96:97], v[14:15], v[222:223] op_sel:[1,0,0] op_sel_hi:[1,1,1] neg_lo:[1,0,0] neg_hi:[1,0,0]
    v_pk_fma_f32 v[122:123], v[96:97], v[12:13], v[254:255] op_sel:[1,0,0] op_sel_hi:[1,1,1]
    v_pk_fma_f32 v[8:9], v[88:89], v[8:9], v[116:117] op_sel:[0,0,0] op_sel_hi:[0,1,1]
    v_pk_fma_f32 v[10:11], v[88:89], v[10:11], v[118:119] op_sel:[0,0,0] op_sel_hi:[0,1,1]
    v_pk_fma_f32 v[12:13], v[96:97], v[12:13], v[120:121] op_sel:[0,0,0] op_sel_hi:[0,1,1]
    v_pk_fma_f32 v[14:15], v[96:97], v[14:15], v[122:123] op_sel:[0,0,0] op_sel_hi:[0,1,1]
    ds_write_b64 v110, v[8:9] offset:0
    ds_write_b64 v110, v[10:11] offset:4096
    ds_write_b64 v110, v[12:13] offset:2048
    ds_write_b64 v110, v[14:15] offset:6144
    s_waitcnt lgkmcnt(0)
    s_barrier
    s_cmp_eq_u32 s5, 0
    s_cbranch_scc1 parallel_sum__ssm_conv_s5__glu_gated_bilinear__prompt_kernel_ssm_w0
    v_pk_mul_f32 v[116:117], v[94:95], v[160:161] op_sel:[1,0] op_sel_hi:[1,1]
    v_pk_mul_f32 v[118:119], v[94:95], v[128:129] op_sel:[1,0] op_sel_hi:[1,1]
    v_pk_mul_f32 v[120:121], v[102:103], v[224:225] op_sel:[1,0] op_sel_hi:[1,1]
    v_pk_mul_f32 v[122:123], v[102:103], v[192:193] op_sel:[1,0] op_sel_hi:[1,1]
    v_pk_fma_f32 v[128:129], v[94:95], v[128:129], v[116:117] op_sel:[0,0,0] op_sel_hi:[0,1,1] neg_lo:[0,0,1] neg_hi:[0,0,1]
    v_pk_fma_f32 v[160:161], v[94:95], v[160:161], v[118:119] op_sel:[0,0,0] op_sel_hi:[0,1,1]
    v_pk_fma_f32 v[192:193], v[102:103], v[192:193], v[120:121] op_sel:[0,0,0] op_sel_hi:[0,1,1] neg_lo:[0,0,1] neg_hi:[0,0,1]
    v_pk_fma_f32 v[224:225], v[102:103], v[224:225], v[122:123] op_sel:[0,0,0] op_sel_hi:[0,1,1]
    v_pk_mul_f32 v[116:117], v[94:95], v[162:163] op_sel:[1,0] op_sel_hi:[1,1]
    v_pk_mul_f32 v[118:119], v[94:95], v[130:131] op_sel:[1,0] op_sel_hi:[1,1]
    v_pk_mul_f32 v[120:121], v[102:103], v[226:227] op_sel:[1,0] op_sel_hi:[1,1]
    v_pk_mul_f32 v[122:123], v[102:103], v[194:195] op_sel:[1,0] op_sel_hi:[1,1]
    v_pk_fma_f32 v[130:131], v[94:95], v[130:131], v[116:117] op_sel:[0,0,0] op_sel_hi:[0,1,1] neg_lo:[0,0,1] neg_hi:[0,0,1]
    v_pk_fma_f32 v[162:163], v[94:95], v[162:163], v[118:119] op_sel:[0,0,0] op_sel_hi:[0,1,1]
    v_pk_fma_f32 v[194:195], v[102:103], v[194:195], v[120:121] op_sel:[0,0,0] op_sel_hi:[0,1,1] neg_lo:[0,0,1] neg_hi:[0,0,1]
    v_pk_fma_f32 v[226:227], v[102:103], v[226:227], v[122:123] op_sel:[0,0,0] op_sel_hi:[0,1,1]
    v_pk_mul_f32 v[116:117], v[94:95], v[164:165] op_sel:[1,0] op_sel_hi:[1,1]
    v_pk_mul_f32 v[118:119], v[94:95], v[132:133] op_sel:[1,0] op_sel_hi:[1,1]
    v_pk_mul_f32 v[120:121], v[102:103], v[228:229] op_sel:[1,0] op_sel_hi:[1,1]
    v_pk_mul_f32 v[122:123], v[102:103], v[196:197] op_sel:[1,0] op_sel_hi:[1,1]
    v_pk_fma_f32 v[132:133], v[94:95], v[132:133], v[116:117] op_sel:[0,0,0] op_sel_hi:[0,1,1] neg_lo:[0,0,1] neg_hi:[0,0,1]
    v_pk_fma_f32 v[164:165], v[94:95], v[164:165], v[118:119] op_sel:[0,0,0] op_sel_hi:[0,1,1]
    v_pk_fma_f32 v[196:197], v[102:103], v[196:197], v[120:121] op_sel:[0,0,0] op_sel_hi:[0,1,1] neg_lo:[0,0,1] neg_hi:[0,0,1]
    v_pk_fma_f32 v[228:229], v[102:103], v[228:229], v[122:123] op_sel:[0,0,0] op_sel_hi:[0,1,1]
    v_pk_mul_f32 v[116:117], v[94:95], v[166:167] op_sel:[1,0] op_sel_hi:[1,1]
    v_pk_mul_f32 v[118:119], v[94:95], v[134:135] op_sel:[1,0] op_sel_hi:[1,1]
    v_pk_mul_f32 v[120:121], v[102:103], v[230:231] op_sel:[1,0] op_sel_hi:[1,1]
    v_pk_mul_f32 v[122:123], v[102:103], v[198:199] op_sel:[1,0] op_sel_hi:[1,1]
    v_pk_fma_f32 v[134:135], v[94:95], v[134:135], v[116:117] op_sel:[0,0,0] op_sel_hi:[0,1,1] neg_lo:[0,0,1] neg_hi:[0,0,1]
    v_pk_fma_f32 v[166:167], v[94:95], v[166:167], v[118:119] op_sel:[0,0,0] op_sel_hi:[0,1,1]
    v_pk_fma_f32 v[198:199], v[102:103], v[198:199], v[120:121] op_sel:[0,0,0] op_sel_hi:[0,1,1] neg_lo:[0,0,1] neg_hi:[0,0,1]
    v_pk_fma_f32 v[230:231], v[102:103], v[230:231], v[122:123] op_sel:[0,0,0] op_sel_hi:[0,1,1]
    v_pk_mul_f32 v[116:117], v[94:95], v[168:169] op_sel:[1,0] op_sel_hi:[1,1]
    v_pk_mul_f32 v[118:119], v[94:95], v[136:137] op_sel:[1,0] op_sel_hi:[1,1]
    v_pk_mul_f32 v[120:121], v[102:103], v[232:233] op_sel:[1,0] op_sel_hi:[1,1]
    v_pk_mul_f32 v[122:123], v[102:103], v[200:201] op_sel:[1,0] op_sel_hi:[1,1]
    v_pk_fma_f32 v[136:137], v[94:95], v[136:137], v[116:117] op_sel:[0,0,0] op_sel_hi:[0,1,1] neg_lo:[0,0,1] neg_hi:[0,0,1]
    v_pk_fma_f32 v[168:169], v[94:95], v[168:169], v[118:119] op_sel:[0,0,0] op_sel_hi:[0,1,1]
    v_pk_fma_f32 v[200:201], v[102:103], v[200:201], v[120:121] op_sel:[0,0,0] op_sel_hi:[0,1,1] neg_lo:[0,0,1] neg_hi:[0,0,1]
    v_pk_fma_f32 v[232:233], v[102:103], v[232:233], v[122:123] op_sel:[0,0,0] op_sel_hi:[0,1,1]
    v_pk_mul_f32 v[116:117], v[94:95], v[170:171] op_sel:[1,0] op_sel_hi:[1,1]
    v_pk_mul_f32 v[118:119], v[94:95], v[138:139] op_sel:[1,0] op_sel_hi:[1,1]
    v_pk_mul_f32 v[120:121], v[102:103], v[234:235] op_sel:[1,0] op_sel_hi:[1,1]
    v_pk_mul_f32 v[122:123], v[102:103], v[202:203] op_sel:[1,0] op_sel_hi:[1,1]
    v_pk_fma_f32 v[138:139], v[94:95], v[138:139], v[116:117] op_sel:[0,0,0] op_sel_hi:[0,1,1] neg_lo:[0,0,1] neg_hi:[0,0,1]
    v_pk_fma_f32 v[170:171], v[94:95], v[170:171], v[118:119] op_sel:[0,0,0] op_sel_hi:[0,1,1]
    v_pk_fma_f32 v[202:203], v[102:103], v[202:203], v[120:121] op_sel:[0,0,0] op_sel_hi:[0,1,1] neg_lo:[0,0,1] neg_hi:[0,0,1]
    v_pk_fma_f32 v[234:235], v[102:103], v[234:235], v[122:123] op_sel:[0,0,0] op_sel_hi:[0,1,1]
    v_pk_mul_f32 v[116:117], v[94:95], v[172:173] op_sel:[1,0] op_sel_hi:[1,1]
    v_pk_mul_f32 v[118:119], v[94:95], v[140:141] op_sel:[1,0] op_sel_hi:[1,1]
    v_pk_mul_f32 v[120:121], v[102:103], v[236:237] op_sel:[1,0] op_sel_hi:[1,1]
    v_pk_mul_f32 v[122:123], v[102:103], v[204:205] op_sel:[1,0] op_sel_hi:[1,1]
    v_pk_fma_f32 v[140:141], v[94:95], v[140:141], v[116:117] op_sel:[0,0,0] op_sel_hi:[0,1,1] neg_lo:[0,0,1] neg_hi:[0,0,1]
    v_pk_fma_f32 v[172:173], v[94:95], v[172:173], v[118:119] op_sel:[0,0,0] op_sel_hi:[0,1,1]
    v_pk_fma_f32 v[204:205], v[102:103], v[204:205], v[120:121] op_sel:[0,0,0] op_sel_hi:[0,1,1] neg_lo:[0,0,1] neg_hi:[0,0,1]
    v_pk_fma_f32 v[236:237], v[102:103], v[236:237], v[122:123] op_sel:[0,0,0] op_sel_hi:[0,1,1]
    v_pk_mul_f32 v[116:117], v[94:95], v[174:175] op_sel:[1,0] op_sel_hi:[1,1]
    v_pk_mul_f32 v[118:119], v[94:95], v[142:143] op_sel:[1,0] op_sel_hi:[1,1]
    v_pk_mul_f32 v[120:121], v[102:103], v[238:239] op_sel:[1,0] op_sel_hi:[1,1]
    v_pk_mul_f32 v[122:123], v[102:103], v[206:207] op_sel:[1,0] op_sel_hi:[1,1]
    v_pk_fma_f32 v[142:143], v[94:95], v[142:143], v[116:117] op_sel:[0,0,0] op_sel_hi:[0,1,1] neg_lo:[0,0,1] neg_hi:[0,0,1]
    v_pk_fma_f32 v[174:175], v[94:95], v[174:175], v[118:119] op_sel:[0,0,0] op_sel_hi:[0,1,1]
    v_pk_fma_f32 v[206:207], v[102:103], v[206:207], v[120:121] op_sel:[0,0,0] op_sel_hi:[0,1,1] neg_lo:[0,0,1] neg_hi:[0,0,1]
    v_pk_fma_f32 v[238:239], v[102:103], v[238:239], v[122:123] op_sel:[0,0,0] op_sel_hi:[0,1,1]
    v_pk_mul_f32 v[116:117], v[94:95], v[176:177] op_sel:[1,0] op_sel_hi:[1,1]
    v_pk_mul_f32 v[118:119], v[94:95], v[144:145] op_sel:[1,0] op_sel_hi:[1,1]
    v_pk_mul_f32 v[120:121], v[102:103], v[240:241] op_sel:[1,0] op_sel_hi:[1,1]
    v_pk_mul_f32 v[122:123], v[102:103], v[208:209] op_sel:[1,0] op_sel_hi:[1,1]
    v_pk_fma_f32 v[144:145], v[94:95], v[144:145], v[116:117] op_sel:[0,0,0] op_sel_hi:[0,1,1] neg_lo:[0,0,1] neg_hi:[0,0,1]
    v_pk_fma_f32 v[176:177], v[94:95], v[176:177], v[118:119] op_sel:[0,0,0] op_sel_hi:[0,1,1]
    v_pk_fma_f32 v[208:209], v[102:103], v[208:209], v[120:121] op_sel:[0,0,0] op_sel_hi:[0,1,1] neg_lo:[0,0,1] neg_hi:[0,0,1]
    v_pk_fma_f32 v[240:241], v[102:103], v[240:241], v[122:123] op_sel:[0,0,0] op_sel_hi:[0,1,1]
    v_pk_mul_f32 v[116:117], v[94:95], v[178:179] op_sel:[1,0] op_sel_hi:[1,1]
    v_pk_mul_f32 v[118:119], v[94:95], v[146:147] op_sel:[1,0] op_sel_hi:[1,1]
    v_pk_mul_f32 v[120:121], v[102:103], v[242:243] op_sel:[1,0] op_sel_hi:[1,1]
    v_pk_mul_f32 v[122:123], v[102:103], v[210:211] op_sel:[1,0] op_sel_hi:[1,1]
    v_pk_fma_f32 v[146:147], v[94:95], v[146:147], v[116:117] op_sel:[0,0,0] op_sel_hi:[0,1,1] neg_lo:[0,0,1] neg_hi:[0,0,1]
    v_pk_fma_f32 v[178:179], v[94:95], v[178:179], v[118:119] op_sel:[0,0,0] op_sel_hi:[0,1,1]
    v_pk_fma_f32 v[210:211], v[102:103], v[210:211], v[120:121] op_sel:[0,0,0] op_sel_hi:[0,1,1] neg_lo:[0,0,1] neg_hi:[0,0,1]
    v_pk_fma_f32 v[242:243], v[102:103], v[242:243], v[122:123] op_sel:[0,0,0] op_sel_hi:[0,1,1]
    v_pk_mul_f32 v[116:117], v[94:95], v[180:181] op_sel:[1,0] op_sel_hi:[1,1]
    v_pk_mul_f32 v[118:119], v[94:95], v[148:149] op_sel:[1,0] op_sel_hi:[1,1]
    v_pk_mul_f32 v[120:121], v[102:103], v[244:245] op_sel:[1,0] op_sel_hi:[1,1]
    v_pk_mul_f32 v[122:123], v[102:103], v[212:213] op_sel:[1,0] op_sel_hi:[1,1]
    v_pk_fma_f32 v[148:149], v[94:95], v[148:149], v[116:117] op_sel:[0,0,0] op_sel_hi:[0,1,1] neg_lo:[0,0,1] neg_hi:[0,0,1]
    v_pk_fma_f32 v[180:181], v[94:95], v[180:181], v[118:119] op_sel:[0,0,0] op_sel_hi:[0,1,1]
    v_pk_fma_f32 v[212:213], v[102:103], v[212:213], v[120:121] op_sel:[0,0,0] op_sel_hi:[0,1,1] neg_lo:[0,0,1] neg_hi:[0,0,1]
    v_pk_fma_f32 v[244:245], v[102:103], v[244:245], v[122:123] op_sel:[0,0,0] op_sel_hi:[0,1,1]
    v_pk_mul_f32 v[116:117], v[94:95], v[182:183] op_sel:[1,0] op_sel_hi:[1,1]
    v_pk_mul_f32 v[118:119], v[94:95], v[150:151] op_sel:[1,0] op_sel_hi:[1,1]
    v_pk_mul_f32 v[120:121], v[102:103], v[246:247] op_sel:[1,0] op_sel_hi:[1,1]
    v_pk_mul_f32 v[122:123], v[102:103], v[214:215] op_sel:[1,0] op_sel_hi:[1,1]
    v_pk_fma_f32 v[150:151], v[94:95], v[150:151], v[116:117] op_sel:[0,0,0] op_sel_hi:[0,1,1] neg_lo:[0,0,1] neg_hi:[0,0,1]
    v_pk_fma_f32 v[182:183], v[94:95], v[182:183], v[118:119] op_sel:[0,0,0] op_sel_hi:[0,1,1]
    v_pk_fma_f32 v[214:215], v[102:103], v[214:215], v[120:121] op_sel:[0,0,0] op_sel_hi:[0,1,1] neg_lo:[0,0,1] neg_hi:[0,0,1]
    v_pk_fma_f32 v[246:247], v[102:103], v[246:247], v[122:123] op_sel:[0,0,0] op_sel_hi:[0,1,1]
    v_pk_mul_f32 v[116:117], v[94:95], v[184:185] op_sel:[1,0] op_sel_hi:[1,1]
    v_pk_mul_f32 v[118:119], v[94:95], v[152:153] op_sel:[1,0] op_sel_hi:[1,1]
    v_pk_mul_f32 v[120:121], v[102:103], v[248:249] op_sel:[1,0] op_sel_hi:[1,1]
    v_pk_mul_f32 v[122:123], v[102:103], v[216:217] op_sel:[1,0] op_sel_hi:[1,1]
    v_pk_fma_f32 v[152:153], v[94:95], v[152:153], v[116:117] op_sel:[0,0,0] op_sel_hi:[0,1,1] neg_lo:[0,0,1] neg_hi:[0,0,1]
    v_pk_fma_f32 v[184:185], v[94:95], v[184:185], v[118:119] op_sel:[0,0,0] op_sel_hi:[0,1,1]
    v_pk_fma_f32 v[216:217], v[102:103], v[216:217], v[120:121] op_sel:[0,0,0] op_sel_hi:[0,1,1] neg_lo:[0,0,1] neg_hi:[0,0,1]
    v_pk_fma_f32 v[248:249], v[102:103], v[248:249], v[122:123] op_sel:[0,0,0] op_sel_hi:[0,1,1]
    v_pk_mul_f32 v[116:117], v[94:95], v[186:187] op_sel:[1,0] op_sel_hi:[1,1]
    v_pk_mul_f32 v[118:119], v[94:95], v[154:155] op_sel:[1,0] op_sel_hi:[1,1]
    v_pk_mul_f32 v[120:121], v[102:103], v[250:251] op_sel:[1,0] op_sel_hi:[1,1]
    v_pk_mul_f32 v[122:123], v[102:103], v[218:219] op_sel:[1,0] op_sel_hi:[1,1]
    v_pk_fma_f32 v[154:155], v[94:95], v[154:155], v[116:117] op_sel:[0,0,0] op_sel_hi:[0,1,1] neg_lo:[0,0,1] neg_hi:[0,0,1]
    v_pk_fma_f32 v[186:187], v[94:95], v[186:187], v[118:119] op_sel:[0,0,0] op_sel_hi:[0,1,1]
    v_pk_fma_f32 v[218:219], v[102:103], v[218:219], v[120:121] op_sel:[0,0,0] op_sel_hi:[0,1,1] neg_lo:[0,0,1] neg_hi:[0,0,1]
    v_pk_fma_f32 v[250:251], v[102:103], v[250:251], v[122:123] op_sel:[0,0,0] op_sel_hi:[0,1,1]
    v_pk_mul_f32 v[116:117], v[94:95], v[188:189] op_sel:[1,0] op_sel_hi:[1,1]
    v_pk_mul_f32 v[118:119], v[94:95], v[156:157] op_sel:[1,0] op_sel_hi:[1,1]
    v_pk_mul_f32 v[120:121], v[102:103], v[252:253] op_sel:[1,0] op_sel_hi:[1,1]
    v_pk_mul_f32 v[122:123], v[102:103], v[220:221] op_sel:[1,0] op_sel_hi:[1,1]
    v_pk_fma_f32 v[156:157], v[94:95], v[156:157], v[116:117] op_sel:[0,0,0] op_sel_hi:[0,1,1] neg_lo:[0,0,1] neg_hi:[0,0,1]
    v_pk_fma_f32 v[188:189], v[94:95], v[188:189], v[118:119] op_sel:[0,0,0] op_sel_hi:[0,1,1]
    v_pk_fma_f32 v[220:221], v[102:103], v[220:221], v[120:121] op_sel:[0,0,0] op_sel_hi:[0,1,1] neg_lo:[0,0,1] neg_hi:[0,0,1]
    v_pk_fma_f32 v[252:253], v[102:103], v[252:253], v[122:123] op_sel:[0,0,0] op_sel_hi:[0,1,1]
    v_pk_mul_f32 v[116:117], v[94:95], v[190:191] op_sel:[1,0] op_sel_hi:[1,1]
    v_pk_mul_f32 v[118:119], v[94:95], v[158:159] op_sel:[1,0] op_sel_hi:[1,1]
    v_pk_mul_f32 v[120:121], v[102:103], v[254:255] op_sel:[1,0] op_sel_hi:[1,1]
    v_pk_mul_f32 v[122:123], v[102:103], v[222:223] op_sel:[1,0] op_sel_hi:[1,1]
    v_pk_fma_f32 v[158:159], v[94:95], v[158:159], v[116:117] op_sel:[0,0,0] op_sel_hi:[0,1,1] neg_lo:[0,0,1] neg_hi:[0,0,1]
    v_pk_fma_f32 v[190:191], v[94:95], v[190:191], v[118:119] op_sel:[0,0,0] op_sel_hi:[0,1,1]
    v_pk_fma_f32 v[222:223], v[102:103], v[222:223], v[120:121] op_sel:[0,0,0] op_sel_hi:[0,1,1] neg_lo:[0,0,1] neg_hi:[0,0,1]
    v_pk_fma_f32 v[254:255], v[102:103], v[254:255], v[122:123] op_sel:[0,0,0] op_sel_hi:[0,1,1]
    s_branch parallel_sum__ssm_conv_s5__glu_gated_bilinear__prompt_kernel_ssm_wait
parallel_sum__ssm_conv_s5__glu_gated_bilinear__prompt_kernel_ssm_w0:
    ds_read_b128 v[16:19], v111 offset:0
    ds_read_b128 v[32:35], v111 offset:4096
    ds_read_b128 v[20:23], v111 offset:16
    ds_read_b128 v[36:39], v111 offset:4112
    ds_read_b128 v[24:27], v111 offset:32
    ds_read_b128 v[40:43], v111 offset:4128
    ds_read_b128 v[28:31], v111 offset:48
    ds_read_b128 v[44:47], v111 offset:4144
    s_waitcnt lgkmcnt(0)
    v_fma_f32 v116, -v105, v32, v17
    v_fma_f32 v117, v105, v16, v33
    v_fma_f32 v8, v104, v16, v116
    v_fma_f32 v10, v104, v32, v117
    v_fma_f32 v116, -v105, v10, v18
    v_fma_f32 v117, v105, v8, v34
    v_fma_f32 v8, v104, v8, v116
    v_fma_f32 v10, v104, v10, v117
    v_fma_f32 v116, -v105, v10, v19
    v_fma_f32 v117, v105, v8, v35
    v_fma_f32 v8, v104, v8, v116
    v_fma_f32 v10, v104, v10, v117
    v_fma_f32 v116, -v105, v10, v20
    v_fma_f32 v117, v105, v8, v36
    v_fma_f32 v8, v104, v8, v116
    v_fma_f32 v10, v104, v10, v117
    v_fma_f32 v116, -v105, v10, v21
    v_fma_f32 v117, v105, v8, v37
    v_fma_f32 v8, v104, v8, v116
    v_fma_f32 v10, v104, v10, v117
    v_fma_f32 v116, -v105, v10, v22
    v_fma_f32 v117, v105, v8, v38
    v_fma_f32 v8, v104, v8, v116
    v_fma_f32 v10, v104, v10, v117
    v_fma_f32 v116, -v105, v10, v23
    v_fma_f32 v117, v105, v8, v39
    v_fma_f32 v8, v104, v8, v116
    v_fma_f32 v10, v104, v10, v117
    v_fma_f32 v116, -v105, v10, v24
    v_fma_f32 v117, v105, v8, v40
    v_fma_f32 v8, v104, v8, v116
    v_fma_f32 v10, v104, v10, v117
    v_fma_f32 v116, -v105, v10, v25
    v_fma_f32 v117, v105, v8, v41
    v_fma_f32 v8, v104, v8, v116
    v_fma_f32 v10, v104, v10, v117
    v_fma_f32 v116, -v105, v10, v26
    v_fma_f32 v117, v105, v8, v42
    v_fma_f32 v8, v104, v8, v116
    v_fma_f32 v10, v104, v10, v117
    v_fma_f32 v116, -v105, v10, v27
    v_fma_f32 v117, v105, v8, v43
    v_fma_f32 v8, v104, v8, v116
    v_fma_f32 v10, v104, v10, v117
    v_fma_f32 v116, -v105, v10, v28
    v_fma_f32 v117, v105, v8, v44
    v_fma_f32 v8, v104, v8, v116
    v_fma_f32 v10, v104, v10, v117
    v_fma_f32 v116, -v105, v10, v29
    v_fma_f32 v117, v105, v8, v45
    v_fma_f32 v8, v104, v8, v116
    v_fma_f32 v10, v104, v10, v117
    v_fma_f32 v116, -v105, v10, v30
    v_fma_f32 v117, v105, v8, v46
    v_fma_f32 v8, v104, v8, v116
    v_fma_f32 v10, v104, v10, v117
    v_fma_f32 v116, -v105, v10, v31
    v_fma_f32 v117, v105, v8, v47
    v_fma_f32 v8, v104, v8, v116
    v_fma_f32 v10, v104, v10, v117
    v_mov_b32 v9, s15
    v_mov_b32 v11, s15
    s_lshl_b32 s13, s7, 13
    s_add_u32 s13, s13, 0xc0000
    s_lshl_b32 s80, s6, 10
    s_add_u32 s80, s80, s13
    buffer_store_dwordx4 v[8:11], v114, s[64:67], s80 offen sc1
    v_pk_mul_f32 v[116:117], v[94:95], v[160:161] op_sel:[1,0] op_sel_hi:[1,1]
    v_pk_mul_f32 v[118:119], v[94:95], v[128:129] op_sel:[1,0] op_sel_hi:[1,1]
    v_pk_mul_f32 v[120:121], v[102:103], v[224:225] op_sel:[1,0] op_sel_hi:[1,1]
    v_pk_mul_f32 v[122:123], v[102:103], v[192:193] op_sel:[1,0] op_sel_hi:[1,1]
    v_pk_fma_f32 v[128:129], v[94:95], v[128:129], v[116:117] op_sel:[0,0,0] op_sel_hi:[0,1,1] neg_lo:[0,0,1] neg_hi:[0,0,1]
    v_pk_fma_f32 v[160:161], v[94:95], v[160:161], v[118:119] op_sel:[0,0,0] op_sel_hi:[0,1,1]
    v_pk_fma_f32 v[192:193], v[102:103], v[192:193], v[120:121] op_sel:[0,0,0] op_sel_hi:[0,1,1] neg_lo:[0,0,1] neg_hi:[0,0,1]
    v_pk_fma_f32 v[224:225], v[102:103], v[224:225], v[122:123] op_sel:[0,0,0] op_sel_hi:[0,1,1]
    v_pk_mul_f32 v[116:117], v[94:95], v[162:163] op_sel:[1,0] op_sel_hi:[1,1]
    v_pk_mul_f32 v[118:119], v[94:95], v[130:131] op_sel:[1,0] op_sel_hi:[1,1]
    v_pk_mul_f32 v[120:121], v[102:103], v[226:227] op_sel:[1,0] op_sel_hi:[1,1]
    v_pk_mul_f32 v[122:123], v[102:103], v[194:195] op_sel:[1,0] op_sel_hi:[1,1]
    v_pk_fma_f32 v[130:131], v[94:95], v[130:131], v[116:117] op_sel:[0,0,0] op_sel_hi:[0,1,1] neg_lo:[0,0,1] neg_hi:[0,0,1]
    v_pk_fma_f32 v[162:163], v[94:95], v[162:163], v[118:119] op_sel:[0,0,0] op_sel_hi:[0,1,1]
    v_pk_fma_f32 v[194:195], v[102:103], v[194:195], v[120:121] op_sel:[0,0,0] op_sel_hi:[0,1,1] neg_lo:[0,0,1] neg_hi:[0,0,1]
    v_pk_fma_f32 v[226:227], v[102:103], v[226:227], v[122:123] op_sel:[0,0,0] op_sel_hi:[0,1,1]
    v_pk_mul_f32 v[116:117], v[94:95], v[164:165] op_sel:[1,0] op_sel_hi:[1,1]
    v_pk_mul_f32 v[118:119], v[94:95], v[132:133] op_sel:[1,0] op_sel_hi:[1,1]
    v_pk_mul_f32 v[120:121], v[102:103], v[228:229] op_sel:[1,0] op_sel_hi:[1,1]
    v_pk_mul_f32 v[122:123], v[102:103], v[196:197] op_sel:[1,0] op_sel_hi:[1,1]
    v_pk_fma_f32 v[132:133], v[94:95], v[132:133], v[116:117] op_sel:[0,0,0] op_sel_hi:[0,1,1] neg_lo:[0,0,1] neg_hi:[0,0,1]
    v_pk_fma_f32 v[164:165], v[94:95], v[164:165], v[118:119] op_sel:[0,0,0] op_sel_hi:[0,1,1]
    v_pk_fma_f32 v[196:197], v[102:103], v[196:197], v[120:121] op_sel:[0,0,0] op_sel_hi:[0,1,1] neg_lo:[0,0,1] neg_hi:[0,0,1]
    v_pk_fma_f32 v[228:229], v[102:103], v[228:229], v[122:123] op_sel:[0,0,0] op_sel_hi:[0,1,1]
    v_pk_mul_f32 v[116:117], v[94:95], v[166:167] op_sel:[1,0] op_sel_hi:[1,1]
    v_pk_mul_f32 v[118:119], v[94:95], v[134:135] op_sel:[1,0] op_sel_hi:[1,1]
    v_pk_mul_f32 v[120:121], v[102:103], v[230:231] op_sel:[1,0] op_sel_hi:[1,1]
    v_pk_mul_f32 v[122:123], v[102:103], v[198:199] op_sel:[1,0] op_sel_hi:[1,1]
    v_pk_fma_f32 v[134:135], v[94:95], v[134:135], v[116:117] op_sel:[0,0,0] op_sel_hi:[0,1,1] neg_lo:[0,0,1] neg_hi:[0,0,1]
    v_pk_fma_f32 v[166:167], v[94:95], v[166:167], v[118:119] op_sel:[0,0,0] op_sel_hi:[0,1,1]
    v_pk_fma_f32 v[198:199], v[102:103], v[198:199], v[120:121] op_sel:[0,0,0] op_sel_hi:[0,1,1] neg_lo:[0,0,1] neg_hi:[0,0,1]
    v_pk_fma_f32 v[230:231], v[102:103], v[230:231], v[122:123] op_sel:[0,0,0] op_sel_hi:[0,1,1]
    v_pk_mul_f32 v[116:117], v[94:95], v[168:169] op_sel:[1,0] op_sel_hi:[1,1]
    v_pk_mul_f32 v[118:119], v[94:95], v[136:137] op_sel:[1,0] op_sel_hi:[1,1]
    v_pk_mul_f32 v[120:121], v[102:103], v[232:233] op_sel:[1,0] op_sel_hi:[1,1]
    v_pk_mul_f32 v[122:123], v[102:103], v[200:201] op_sel:[1,0] op_sel_hi:[1,1]
    v_pk_fma_f32 v[136:137], v[94:95], v[136:137], v[116:117] op_sel:[0,0,0] op_sel_hi:[0,1,1] neg_lo:[0,0,1] neg_hi:[0,0,1]
    v_pk_fma_f32 v[168:169], v[94:95], v[168:169], v[118:119] op_sel:[0,0,0] op_sel_hi:[0,1,1]
    v_pk_fma_f32 v[200:201], v[102:103], v[200:201], v[120:121] op_sel:[0,0,0] op_sel_hi:[0,1,1] neg_lo:[0,0,1] neg_hi:[0,0,1]
    v_pk_fma_f32 v[232:233], v[102:103], v[232:233], v[122:123] op_sel:[0,0,0] op_sel_hi:[0,1,1]
    v_pk_mul_f32 v[116:117], v[94:95], v[170:171] op_sel:[1,0] op_sel_hi:[1,1]
    v_pk_mul_f32 v[118:119], v[94:95], v[138:139] op_sel:[1,0] op_sel_hi:[1,1]
    v_pk_mul_f32 v[120:121], v[102:103], v[234:235] op_sel:[1,0] op_sel_hi:[1,1]
    v_pk_mul_f32 v[122:123], v[102:103], v[202:203] op_sel:[1,0] op_sel_hi:[1,1]
    v_pk_fma_f32 v[138:139], v[94:95], v[138:139], v[116:117] op_sel:[0,0,0] op_sel_hi:[0,1,1] neg_lo:[0,0,1] neg_hi:[0,0,1]
    v_pk_fma_f32 v[170:171], v[94:95], v[170:171], v[118:119] op_sel:[0,0,0] op_sel_hi:[0,1,1]
    v_pk_fma_f32 v[202:203], v[102:103], v[202:203], v[120:121] op_sel:[0,0,0] op_sel_hi:[0,1,1] neg_lo:[0,0,1] neg_hi:[0,0,1]
    v_pk_fma_f32 v[234:235], v[102:103], v[234:235], v[122:123] op_sel:[0,0,0] op_sel_hi:[0,1,1]
    v_pk_mul_f32 v[116:117], v[94:95], v[172:173] op_sel:[1,0] op_sel_hi:[1,1]
    v_pk_mul_f32 v[118:119], v[94:95], v[140:141] op_sel:[1,0] op_sel_hi:[1,1]
    v_pk_mul_f32 v[120:121], v[102:103], v[236:237] op_sel:[1,0] op_sel_hi:[1,1]
    v_pk_mul_f32 v[122:123], v[102:103], v[204:205] op_sel:[1,0] op_sel_hi:[1,1]
    v_pk_fma_f32 v[140:141], v[94:95], v[140:141], v[116:117] op_sel:[0,0,0] op_sel_hi:[0,1,1] neg_lo:[0,0,1] neg_hi:[0,0,1]
    v_pk_fma_f32 v[172:173], v[94:95], v[172:173], v[118:119] op_sel:[0,0,0] op_sel_hi:[0,1,1]
    v_pk_fma_f32 v[204:205], v[102:103], v[204:205], v[120:121] op_sel:[0,0,0] op_sel_hi:[0,1,1] neg_lo:[0,0,1] neg_hi:[0,0,1]
    v_pk_fma_f32 v[236:237], v[102:103], v[236:237], v[122:123] op_sel:[0,0,0] op_sel_hi:[0,1,1]
    v_pk_mul_f32 v[116:117], v[94:95], v[174:175] op_sel:[1,0] op_sel_hi:[1,1]
    v_pk_mul_f32 v[118:119], v[94:95], v[142:143] op_sel:[1,0] op_sel_hi:[1,1]
    v_pk_mul_f32 v[120:121], v[102:103], v[238:239] op_sel:[1,0] op_sel_hi:[1,1]
    v_pk_mul_f32 v[122:123], v[102:103], v[206:207] op_sel:[1,0] op_sel_hi:[1,1]
    v_pk_fma_f32 v[142:143], v[94:95], v[142:143], v[116:117] op_sel:[0,0,0] op_sel_hi:[0,1,1] neg_lo:[0,0,1] neg_hi:[0,0,1]
    v_pk_fma_f32 v[174:175], v[94:95], v[174:175], v[118:119] op_sel:[0,0,0] op_sel_hi:[0,1,1]
    v_pk_fma_f32 v[206:207], v[102:103], v[206:207], v[120:121] op_sel:[0,0,0] op_sel_hi:[0,1,1] neg_lo:[0,0,1] neg_hi:[0,0,1]
    v_pk_fma_f32 v[238:239], v[102:103], v[238:239], v[122:123] op_sel:[0,0,0] op_sel_hi:[0,1,1]
    v_pk_mul_f32 v[116:117], v[94:95], v[176:177] op_sel:[1,0] op_sel_hi:[1,1]
    v_pk_mul_f32 v[118:119], v[94:95], v[144:145] op_sel:[1,0] op_sel_hi:[1,1]
    v_pk_mul_f32 v[120:121], v[102:103], v[240:241] op_sel:[1,0] op_sel_hi:[1,1]
    v_pk_mul_f32 v[122:123], v[102:103], v[208:209] op_sel:[1,0] op_sel_hi:[1,1]
    v_pk_fma_f32 v[144:145], v[94:95], v[144:145], v[116:117] op_sel:[0,0,0] op_sel_hi:[0,1,1] neg_lo:[0,0,1] neg_hi:[0,0,1]
    v_pk_fma_f32 v[176:177], v[94:95], v[176:177], v[118:119] op_sel:[0,0,0] op_sel_hi:[0,1,1]
    v_pk_fma_f32 v[208:209], v[102:103], v[208:209], v[120:121] op_sel:[0,0,0] op_sel_hi:[0,1,1] neg_lo:[0,0,1] neg_hi:[0,0,1]
    v_pk_fma_f32 v[240:241], v[102:103], v[240:241], v[122:123] op_sel:[0,0,0] op_sel_hi:[0,1,1]
    v_pk_mul_f32 v[116:117], v[94:95], v[178:179] op_sel:[1,0] op_sel_hi:[1,1]
    v_pk_mul_f32 v[118:119], v[94:95], v[146:147] op_sel:[1,0] op_sel_hi:[1,1]
    v_pk_mul_f32 v[120:121], v[102:103], v[242:243] op_sel:[1,0] op_sel_hi:[1,1]
    v_pk_mul_f32 v[122:123], v[102:103], v[210:211] op_sel:[1,0] op_sel_hi:[1,1]
    v_pk_fma_f32 v[146:147], v[94:95], v[146:147], v[116:117] op_sel:[0,0,0] op_sel_hi:[0,1,1] neg_lo:[0,0,1] neg_hi:[0,0,1]
    v_pk_fma_f32 v[178:179], v[94:95], v[178:179], v[118:119] op_sel:[0,0,0] op_sel_hi:[0,1,1]
    v_pk_fma_f32 v[210:211], v[102:103], v[210:211], v[120:121] op_sel:[0,0,0] op_sel_hi:[0,1,1] neg_lo:[0,0,1] neg_hi:[0,0,1]
    v_pk_fma_f32 v[242:243], v[102:103], v[242:243], v[122:123] op_sel:[0,0,0] op_sel_hi:[0,1,1]
    v_pk_mul_f32 v[116:117], v[94:95], v[180:181] op_sel:[1,0] op_sel_hi:[1,1]
    v_pk_mul_f32 v[118:119], v[94:95], v[148:149] op_sel:[1,0] op_sel_hi:[1,1]
    v_pk_mul_f32 v[120:121], v[102:103], v[244:245] op_sel:[1,0] op_sel_hi:[1,1]
    v_pk_mul_f32 v[122:123], v[102:103], v[212:213] op_sel:[1,0] op_sel_hi:[1,1]
    v_pk_fma_f32 v[148:149], v[94:95], v[148:149], v[116:117] op_sel:[0,0,0] op_sel_hi:[0,1,1] neg_lo:[0,0,1] neg_hi:[0,0,1]
    v_pk_fma_f32 v[180:181], v[94:95], v[180:181], v[118:119] op_sel:[0,0,0] op_sel_hi:[0,1,1]
    v_pk_fma_f32 v[212:213], v[102:103], v[212:213], v[120:121] op_sel:[0,0,0] op_sel_hi:[0,1,1] neg_lo:[0,0,1] neg_hi:[0,0,1]
    v_pk_fma_f32 v[244:245], v[102:103], v[244:245], v[122:123] op_sel:[0,0,0] op_sel_hi:[0,1,1]
    v_pk_mul_f32 v[116:117], v[94:95], v[182:183] op_sel:[1,0] op_sel_hi:[1,1]
    v_pk_mul_f32 v[118:119], v[94:95], v[150:151] op_sel:[1,0] op_sel_hi:[1,1]
    v_pk_mul_f32 v[120:121], v[102:103], v[246:247] op_sel:[1,0] op_sel_hi:[1,1]
    v_pk_mul_f32 v[122:123], v[102:103], v[214:215] op_sel:[1,0] op_sel_hi:[1,1]
    v_pk_fma_f32 v[150:151], v[94:95], v[150:151], v[116:117] op_sel:[0,0,0] op_sel_hi:[0,1,1] neg_lo:[0,0,1] neg_hi:[0,0,1]
    v_pk_fma_f32 v[182:183], v[94:95], v[182:183], v[118:119] op_sel:[0,0,0] op_sel_hi:[0,1,1]
    v_pk_fma_f32 v[214:215], v[102:103], v[214:215], v[120:121] op_sel:[0,0,0] op_sel_hi:[0,1,1] neg_lo:[0,0,1] neg_hi:[0,0,1]
    v_pk_fma_f32 v[246:247], v[102:103], v[246:247], v[122:123] op_sel:[0,0,0] op_sel_hi:[0,1,1]
    v_pk_mul_f32 v[116:117], v[94:95], v[184:185] op_sel:[1,0] op_sel_hi:[1,1]
    v_pk_mul_f32 v[118:119], v[94:95], v[152:153] op_sel:[1,0] op_sel_hi:[1,1]
    v_pk_mul_f32 v[120:121], v[102:103], v[248:249] op_sel:[1,0] op_sel_hi:[1,1]
    v_pk_mul_f32 v[122:123], v[102:103], v[216:217] op_sel:[1,0] op_sel_hi:[1,1]
    v_pk_fma_f32 v[152:153], v[94:95], v[152:153], v[116:117] op_sel:[0,0,0] op_sel_hi:[0,1,1] neg_lo:[0,0,1] neg_hi:[0,0,1]
    v_pk_fma_f32 v[184:185], v[94:95], v[184:185], v[118:119] op_sel:[0,0,0] op_sel_hi:[0,1,1]
    v_pk_fma_f32 v[216:217], v[102:103], v[216:217], v[120:121] op_sel:[0,0,0] op_sel_hi:[0,1,1] neg_lo:[0,0,1] neg_hi:[0,0,1]
    v_pk_fma_f32 v[248:249], v[102:103], v[248:249], v[122:123] op_sel:[0,0,0] op_sel_hi:[0,1,1]
    v_pk_mul_f32 v[116:117], v[94:95], v[186:187] op_sel:[1,0] op_sel_hi:[1,1]
    v_pk_mul_f32 v[118:119], v[94:95], v[154:155] op_sel:[1,0] op_sel_hi:[1,1]
    v_pk_mul_f32 v[120:121], v[102:103], v[250:251] op_sel:[1,0] op_sel_hi:[1,1]
    v_pk_mul_f32 v[122:123], v[102:103], v[218:219] op_sel:[1,0] op_sel_hi:[1,1]
    v_pk_fma_f32 v[154:155], v[94:95], v[154:155], v[116:117] op_sel:[0,0,0] op_sel_hi:[0,1,1] neg_lo:[0,0,1] neg_hi:[0,0,1]
    v_pk_fma_f32 v[186:187], v[94:95], v[186:187], v[118:119] op_sel:[0,0,0] op_sel_hi:[0,1,1]
    v_pk_fma_f32 v[218:219], v[102:103], v[218:219], v[120:121] op_sel:[0,0,0] op_sel_hi:[0,1,1] neg_lo:[0,0,1] neg_hi:[0,0,1]
    v_pk_fma_f32 v[250:251], v[102:103], v[250:251], v[122:123] op_sel:[0,0,0] op_sel_hi:[0,1,1]
    v_pk_mul_f32 v[116:117], v[94:95], v[188:189] op_sel:[1,0] op_sel_hi:[1,1]
    v_pk_mul_f32 v[118:119], v[94:95], v[156:157] op_sel:[1,0] op_sel_hi:[1,1]
    v_pk_mul_f32 v[120:121], v[102:103], v[252:253] op_sel:[1,0] op_sel_hi:[1,1]
    v_pk_mul_f32 v[122:123], v[102:103], v[220:221] op_sel:[1,0] op_sel_hi:[1,1]
    v_pk_fma_f32 v[156:157], v[94:95], v[156:157], v[116:117] op_sel:[0,0,0] op_sel_hi:[0,1,1] neg_lo:[0,0,1] neg_hi:[0,0,1]
    v_pk_fma_f32 v[188:189], v[94:95], v[188:189], v[118:119] op_sel:[0,0,0] op_sel_hi:[0,1,1]
    v_pk_fma_f32 v[220:221], v[102:103], v[220:221], v[120:121] op_sel:[0,0,0] op_sel_hi:[0,1,1] neg_lo:[0,0,1] neg_hi:[0,0,1]
    v_pk_fma_f32 v[252:253], v[102:103], v[252:253], v[122:123] op_sel:[0,0,0] op_sel_hi:[0,1,1]
    v_pk_mul_f32 v[116:117], v[94:95], v[190:191] op_sel:[1,0] op_sel_hi:[1,1]
    v_pk_mul_f32 v[118:119], v[94:95], v[158:159] op_sel:[1,0] op_sel_hi:[1,1]
    v_pk_mul_f32 v[120:121], v[102:103], v[254:255] op_sel:[1,0] op_sel_hi:[1,1]
    v_pk_mul_f32 v[122:123], v[102:103], v[222:223] op_sel:[1,0] op_sel_hi:[1,1]
    v_pk_fma_f32 v[158:159], v[94:95], v[158:159], v[116:117] op_sel:[0,0,0] op_sel_hi:[0,1,1] neg_lo:[0,0,1] neg_hi:[0,0,1]
    v_pk_fma_f32 v[190:191], v[94:95], v[190:191], v[118:119] op_sel:[0,0,0] op_sel_hi:[0,1,1]
    v_pk_fma_f32 v[222:223], v[102:103], v[222:223], v[120:121] op_sel:[0,0,0] op_sel_hi:[0,1,1] neg_lo:[0,0,1] neg_hi:[0,0,1]
    v_pk_fma_f32 v[254:255], v[102:103], v[254:255], v[122:123] op_sel:[0,0,0] op_sel_hi:[0,1,1]
    v_mov_b32 v48, 0
    v_mov_b32 v64, 0
    s_cmp_eq_u32 s6, 0
    s_cbranch_scc1 parallel_sum__ssm_conv_s5__glu_gated_bilinear__prompt_kernel_lb_done
    s_mov_b32 s80, 0
    s_add_u32 s81, s13, 4096
parallel_sum__ssm_conv_s5__glu_gated_bilinear__prompt_kernel_poll:
    buffer_load_dwordx4 v[52:55], v114, s[64:67], s13 offen offset:0 sc1
    buffer_load_dwordx4 v[56:59], v114, s[64:67], s13 offen offset:1024 sc1
    buffer_load_dwordx4 v[60:63], v114, s[64:67], s13 offen offset:2048 sc1
    buffer_load_dwordx4 v[68:71], v114, s[64:67], s13 offen offset:3072 sc1
    buffer_load_dwordx4 v[72:75], v114, s[64:67], s81 offen offset:0 sc1
    buffer_load_dwordx4 v[76:79], v114, s[64:67], s81 offen offset:1024 sc1
    buffer_load_dwordx4 v[12:15], v114, s[64:67], s81 offen offset:2048 sc1
    s_waitcnt vmcnt(0)
    s_mov_b64 s[82:83], 0
    s_cmp_le_u32 s6, 0
    s_cbranch_scc1 parallel_sum__ssm_conv_s5__glu_gated_bilinear__prompt_kernel_chk_end
    v_cmp_ne_u32 vcc, s15, v53
    s_or_b64 s[82:83], s[82:83], vcc
    v_cmp_ne_u32 vcc, s15, v55
    s_or_b64 s[82:83], s[82:83], vcc
    s_cmp_le_u32 s6, 1
    s_cbranch_scc1 parallel_sum__ssm_conv_s5__glu_gated_bilinear__prompt_kernel_chk_end
    v_cmp_ne_u32 vcc, s15, v57
    s_or_b64 s[82:83], s[82:83], vcc
    v_cmp_ne_u32 vcc, s15, v59
    s_or_b64 s[82:83], s[82:83], vcc
    s_cmp_le_u32 s6, 2
    s_cbranch_scc1 parallel_sum__ssm_conv_s5__glu_gated_bilinear__prompt_kernel_chk_end
    v_cmp_ne_u32 vcc, s15, v61
    s_or_b64 s[82:83], s[82:83], vcc
    v_cmp_ne_u32 vcc, s15, v63
    s_or_b64 s[82:83], s[82:83], vcc
    s_cmp_le_u32 s6, 3
    s_cbranch_scc1 parallel_sum__ssm_conv_s5__glu_gated_bilinear__prompt_kernel_chk_end
    v_cmp_ne_u32 vcc, s15, v69
    s_or_b64 s[82:83], s[82:83], vcc
    v_cmp_ne_u32 vcc, s15, v71
    s_or_b64 s[82:83], s[82:83], vcc
    s_cmp_le_u32 s6, 4
    s_cbranch_scc1 parallel_sum__ssm_conv_s5__glu_gated_bilinear__prompt_kernel_chk_end
    v_cmp_ne_u32 vcc, s15, v73
    s_or_b64 s[82:83], s[82:83], vcc
    v_cmp_ne_u32 vcc, s15, v75
    s_or_b64 s[82:83], s[82:83], vcc
    s_cmp_le_u32 s6, 5
    s_cbranch_scc1 parallel_sum__ssm_conv_s5__glu_gated_bilinear__prompt_kernel_chk_end
    v_cmp_ne_u32 vcc, s15, v77
    s_or_b64 s[82:83], s[82:83], vcc
    v_cmp_ne_u32 vcc, s15, v79
    s_or_b64 s[82:83], s[82:83], vcc
    s_cmp_le_u32 s6, 6
    s_cbranch_scc1 parallel_sum__ssm_conv_s5__glu_gated_bilinear__prompt_kernel_chk_end
    v_cmp_ne_u32 vcc, s15, v13
    s_or_b64 s[82:83], s[82:83], vcc
    v_cmp_ne_u32 vcc, s15, v15
    s_or_b64 s[82:83], s[82:83], vcc
parallel_sum__ssm_conv_s5__glu_gated_bilinear__prompt_kernel_chk_end:
    s_cmp_eq_u64 s[82:83], 0
    s_cbranch_scc1 parallel_sum__ssm_conv_s5__glu_gated_bilinear__prompt_kernel_poll_ok
    s_add_u32 s80, s80, 1
    s_cmp_lt_u32 s80, 0x20000
    s_cbranch_scc0 parallel_sum__ssm_conv_s5__glu_gated_bilinear__prompt_kernel_poll_ok
    s_sleep 1
    s_branch parallel_sum__ssm_conv_s5__glu_gated_bilinear__prompt_kernel_poll
parallel_sum__ssm_conv_s5__glu_gated_bilinear__prompt_kernel_poll_ok:
    s_cmp_le_u32 s6, 0
    s_cbranch_scc1 parallel_sum__ssm_conv_s5__glu_gated_bilinear__prompt_kernel_lb_done
    v_fma_f32 v116, -v107, v64, v52
    v_fma_f32 v117, v107, v48, v54
    v_fma_f32 v48, v106, v48, v116
    v_fma_f32 v64, v106, v64, v117
    s_cmp_le_u32 s6, 1
    s_cbranch_scc1 parallel_sum__ssm_conv_s5__glu_gated_bilinear__prompt_kernel_lb_done
    v_fma_f32 v116, -v107, v64, v56
    v_fma_f32 v117, v107, v48, v58
    v_fma_f32 v48, v106, v48, v116
    v_fma_f32 v64, v106, v64, v117
    s_cmp_le_u32 s6, 2
    s_cbranch_scc1 parallel_sum__ssm_conv_s5__glu_gated_bilinear__prompt_kernel_lb_done
    v_fma_f32 v116, -v107, v64, v60
    v_fma_f32 v117, v107, v48, v62
    v_fma_f32 v48, v106, v48, v116
    v_fma_f32 v64, v106, v64, v117
    s_cmp_le_u32 s6, 3
    s_cbranch_scc1 parallel_sum__ssm_conv_s5__glu_gated_bilinear__prompt_kernel_lb_done
    v_fma_f32 v116, -v107, v64, v68
    v_fma_f32 v117, v107, v48, v70
    v_fma_f32 v48, v106, v48, v116
    v_fma_f32 v64, v106, v64, v117
    s_cmp_le_u32 s6, 4
    s_cbranch_scc1 parallel_sum__ssm_conv_s5__glu_gated_bilinear__prompt_kernel_lb_done
    v_fma_f32 v116, -v107, v64, v72
    v_fma_f32 v117, v107, v48, v74
    v_fma_f32 v48, v106, v48, v116
    v_fma_f32 v64, v106, v64, v117
    s_cmp_le_u32 s6, 5
    s_cbranch_scc1 parallel_sum__ssm_conv_s5__glu_gated_bilinear__prompt_kernel_lb_done
    v_fma_f32 v116, -v107, v64, v76
    v_fma_f32 v117, v107, v48, v78
    v_fma_f32 v48, v106, v48, v116
    v_fma_f32 v64, v106, v64, v117
    s_cmp_le_u32 s6, 6
    s_cbranch_scc1 parallel_sum__ssm_conv_s5__glu_gated_bilinear__prompt_kernel_lb_done
    v_fma_f32 v116, -v107, v64, v12
    v_fma_f32 v117, v107, v48, v14
    v_fma_f32 v48, v106, v48, v116
    v_fma_f32 v64, v106, v64, v117
parallel_sum__ssm_conv_s5__glu_gated_bilinear__prompt_kernel_lb_done:
    v_fma_f32 v116, -v105, v64, v16
    v_fma_f32 v117, v105, v48, v32
    v_fma_f32 v49, v104, v48, v116
    v_fma_f32 v65, v104, v64, v117
    v_fma_f32 v116, -v105, v65, v17
    v_fma_f32 v117, v105, v49, v33
    v_fma_f32 v50, v104, v49, v116
    v_fma_f32 v66, v104, v65, v117
    v_fma_f32 v116, -v105, v66, v18
    v_fma_f32 v117, v105, v50, v34
    v_fma_f32 v51, v104, v50, v116
    v_fma_f32 v67, v104, v66, v117
    v_fma_f32 v116, -v105, v67, v19
    v_fma_f32 v117, v105, v51, v35
    v_fma_f32 v52, v104, v51, v116
    v_fma_f32 v68, v104, v67, v117
    v_fma_f32 v116, -v105, v68, v20
    v_fma_f32 v117, v105, v52, v36
    v_fma_f32 v53, v104, v52, v116
    v_fma_f32 v69, v104, v68, v117
    v_fma_f32 v116, -v105, v69, v21
    v_fma_f32 v117, v105, v53, v37
    v_fma_f32 v54, v104, v53, v116
    v_fma_f32 v70, v104, v69, v117
    v_fma_f32 v116, -v105, v70, v22
    v_fma_f32 v117, v105, v54, v38
    v_fma_f32 v55, v104, v54, v116
    v_fma_f32 v71, v104, v70, v117
    v_fma_f32 v116, -v105, v71, v23
    v_fma_f32 v117, v105, v55, v39
    v_fma_f32 v56, v104, v55, v116
    v_fma_f32 v72, v104, v71, v117
    v_fma_f32 v116, -v105, v72, v24
    v_fma_f32 v117, v105, v56, v40
    v_fma_f32 v57, v104, v56, v116
    v_fma_f32 v73, v104, v72, v117
    v_fma_f32 v116, -v105, v73, v25
    v_fma_f32 v117, v105, v57, v41
    v_fma_f32 v58, v104, v57, v116
    v_fma_f32 v74, v104, v73, v117
    v_fma_f32 v116, -v105, v74, v26
    v_fma_f32 v117, v105, v58, v42
    v_fma_f32 v59, v104, v58, v116
    v_fma_f32 v75, v104, v74, v117
    v_fma_f32 v116, -v105, v75, v27
    v_fma_f32 v117, v105, v59, v43
    v_fma_f32 v60, v104, v59, v116
    v_fma_f32 v76, v104, v75, v117
    v_fma_f32 v116, -v105, v76, v28
    v_fma_f32 v117, v105, v60, v44
    v_fma_f32 v61, v104, v60, v116
    v_fma_f32 v77, v104, v76, v117
    v_fma_f32 v116, -v105, v77, v29
    v_fma_f32 v117, v105, v61, v45
    v_fma_f32 v62, v104, v61, v116
    v_fma_f32 v78, v104, v77, v117
    v_fma_f32 v116, -v105, v78, v30
    v_fma_f32 v117, v105, v62, v46
    v_fma_f32 v63, v104, v62, v116
    v_fma_f32 v79, v104, v78, v117
    ds_write_b128 v111, v[48:51] offset:8192
    ds_write_b128 v111, v[64:67] offset:12288
    ds_write_b128 v111, v[52:55] offset:8208
    ds_write_b128 v111, v[68:71] offset:12304
    ds_write_b128 v111, v[56:59] offset:8224
    ds_write_b128 v111, v[72:75] offset:12320
    ds_write_b128 v111, v[60:63] offset:8240
    ds_write_b128 v111, v[76:79] offset:12336
    s_waitcnt lgkmcnt(0)
parallel_sum__ssm_conv_s5__glu_gated_bilinear__prompt_kernel_ssm_wait:
    s_barrier
    ds_read_b64 v[8:9], v110 offset:8192
    ds_read_b64 v[10:11], v110 offset:12288
    ds_read_b64 v[12:13], v110 offset:10240
    ds_read_b64 v[14:15], v110 offset:14336
    s_waitcnt lgkmcnt(0)
    v_pk_mul_f32 v[116:117], v[94:95], v[10:11] op_sel:[1,0] op_sel_hi:[1,1]
    v_pk_mul_f32 v[118:119], v[94:95], v[8:9] op_sel:[1,0] op_sel_hi:[1,1]
    v_pk_mul_f32 v[120:121], v[102:103], v[14:15] op_sel:[1,0] op_sel_hi:[1,1]
    v_pk_mul_f32 v[122:123], v[102:103], v[12:13] op_sel:[1,0] op_sel_hi:[1,1]
    v_pk_fma_f32 v[8:9], v[94:95], v[8:9], v[116:117] op_sel:[0,0,0] op_sel_hi:[0,1,1] neg_lo:[0,0,1] neg_hi:[0,0,1]
    v_pk_fma_f32 v[10:11], v[94:95], v[10:11], v[118:119] op_sel:[0,0,0] op_sel_hi:[0,1,1]
    v_pk_fma_f32 v[12:13], v[102:103], v[12:13], v[120:121] op_sel:[0,0,0] op_sel_hi:[0,1,1] neg_lo:[0,0,1] neg_hi:[0,0,1]
    v_pk_fma_f32 v[14:15], v[102:103], v[14:15], v[122:123] op_sel:[0,0,0] op_sel_hi:[0,1,1]
    v_pk_fma_f32 v[116:117], v[88:89], v[10:11], v[128:129] op_sel:[1,0,0] op_sel_hi:[1,1,1] neg_lo:[1,0,0] neg_hi:[1,0,0]
    v_pk_fma_f32 v[118:119], v[88:89], v[8:9], v[160:161] op_sel:[1,0,0] op_sel_hi:[1,1,1]
    v_pk_fma_f32 v[120:121], v[96:97], v[14:15], v[192:193] op_sel:[1,0,0] op_sel_hi:[1,1,1] neg_lo:[1,0,0] neg_hi:[1,0,0]
    v_pk_fma_f32 v[122:123], v[96:97], v[12:13], v[224:225] op_sel:[1,0,0] op_sel_hi:[1,1,1]
    v_pk_fma_f32 v[128:129], v[88:89], v[8:9], v[116:117] op_sel:[0,0,0] op_sel_hi:[0,1,1]
    v_pk_fma_f32 v[160:161], v[88:89], v[10:11], v[118:119] op_sel:[0,0,0] op_sel_hi:[0,1,1]
    v_pk_fma_f32 v[192:193], v[96:97], v[12:13], v[120:121] op_sel:[0,0,0] op_sel_hi:[0,1,1]
    v_pk_fma_f32 v[224:225], v[96:97], v[14:15], v[122:123] op_sel:[0,0,0] op_sel_hi:[0,1,1]
    v_pk_fma_f32 v[116:117], v[88:89], v[160:161], v[130:131] op_sel:[1,0,0] op_sel_hi:[1,1,1] neg_lo:[1,0,0] neg_hi:[1,0,0]
    v_pk_fma_f32 v[118:119], v[88:89], v[128:129], v[162:163] op_sel:[1,0,0] op_sel_hi:[1,1,1]
    v_pk_fma_f32 v[120:121], v[96:97], v[224:225], v[194:195] op_sel:[1,0,0] op_sel_hi:[1,1,1] neg_lo:[1,0,0] neg_hi:[1,0,0]
    v_pk_fma_f32 v[122:123], v[96:97], v[192:193], v[226:227] op_sel:[1,0,0] op_sel_hi:[1,1,1]
    v_pk_fma_f32 v[130:131], v[88:89], v[128:129], v[116:117] op_sel:[0,0,0] op_sel_hi:[0,1,1]
    v_pk_fma_f32 v[162:163], v[88:89], v[160:161], v[118:119] op_sel:[0,0,0] op_sel_hi:[0,1,1]
    v_pk_fma_f32 v[194:195], v[96:97], v[192:193], v[120:121] op_sel:[0,0,0] op_sel_hi:[0,1,1]
    v_pk_fma_f32 v[226:227], v[96:97], v[224:225], v[122:123] op_sel:[0,0,0] op_sel_hi:[0,1,1]
    v_pk_fma_f32 v[116:117], v[88:89], v[162:163], v[132:133] op_sel:[1,0,0] op_sel_hi:[1,1,1] neg_lo:[1,0,0] neg_hi:[1,0,0]
    v_pk_fma_f32 v[118:119], v[88:89], v[130:131], v[164:165] op_sel:[1,0,0] op_sel_hi:[1,1,1]
    v_pk_fma_f32 v[120:121], v[96:97], v[226:227], v[196:197] op_sel:[1,0,0] op_sel_hi:[1,1,1] neg_lo:[1,0,0] neg_hi:[1,0,0]
    v_pk_fma_f32 v[122:123], v[96:97], v[194:195], v[228:229] op_sel:[1,0,0] op_sel_hi:[1,1,1]
    v_pk_fma_f32 v[132:133], v[88:89], v[130:131], v[116:117] op_sel:[0,0,0] op_sel_hi:[0,1,1]
    v_pk_fma_f32 v[164:165], v[88:89], v[162:163], v[118:119] op_sel:[0,0,0] op_sel_hi:[0,1,1]
    v_pk_fma_f32 v[196:197], v[96:97], v[194:195], v[120:121] op_sel:[0,0,0] op_sel_hi:[0,1,1]
    v_pk_fma_f32 v[228:229], v[96:97], v[226:227], v[122:123] op_sel:[0,0,0] op_sel_hi:[0,1,1]
    v_pk_fma_f32 v[116:117], v[88:89], v[164:165], v[134:135] op_sel:[1,0,0] op_sel_hi:[1,1,1] neg_lo:[1,0,0] neg_hi:[1,0,0]
    v_pk_fma_f32 v[118:119], v[88:89], v[132:133], v[166:167] op_sel:[1,0,0] op_sel_hi:[1,1,1]
    v_pk_fma_f32 v[120:121], v[96:97], v[228:229], v[198:199] op_sel:[1,0,0] op_sel_hi:[1,1,1] neg_lo:[1,0,0] neg_hi:[1,0,0]
    v_pk_fma_f32 v[122:123], v[96:97], v[196:197], v[230:231] op_sel:[1,0,0] op_sel_hi:[1,1,1]
    v_pk_fma_f32 v[134:135], v[88:89], v[132:133], v[116:117] op_sel:[0,0,0] op_sel_hi:[0,1,1]
    v_pk_fma_f32 v[166:167], v[88:89], v[164:165], v[118:119] op_sel:[0,0,0] op_sel_hi:[0,1,1]
    v_pk_fma_f32 v[198:199], v[96:97], v[196:197], v[120:121] op_sel:[0,0,0] op_sel_hi:[0,1,1]
    v_pk_fma_f32 v[230:231], v[96:97], v[228:229], v[122:123] op_sel:[0,0,0] op_sel_hi:[0,1,1]
    v_pk_fma_f32 v[116:117], v[88:89], v[166:167], v[136:137] op_sel:[1,0,0] op_sel_hi:[1,1,1] neg_lo:[1,0,0] neg_hi:[1,0,0]
    v_pk_fma_f32 v[118:119], v[88:89], v[134:135], v[168:169] op_sel:[1,0,0] op_sel_hi:[1,1,1]
    v_pk_fma_f32 v[120:121], v[96:97], v[230:231], v[200:201] op_sel:[1,0,0] op_sel_hi:[1,1,1] neg_lo:[1,0,0] neg_hi:[1,0,0]
    v_pk_fma_f32 v[122:123], v[96:97], v[198:199], v[232:233] op_sel:[1,0,0] op_sel_hi:[1,1,1]
    v_pk_fma_f32 v[136:137], v[88:89], v[134:135], v[116:117] op_sel:[0,0,0] op_sel_hi:[0,1,1]
    v_pk_fma_f32 v[168:169], v[88:89], v[166:167], v[118:119] op_sel:[0,0,0] op_sel_hi:[0,1,1]
    v_pk_fma_f32 v[200:201], v[96:97], v[198:199], v[120:121] op_sel:[0,0,0] op_sel_hi:[0,1,1]
    v_pk_fma_f32 v[232:233], v[96:97], v[230:231], v[122:123] op_sel:[0,0,0] op_sel_hi:[0,1,1]
    v_pk_fma_f32 v[116:117], v[88:89], v[168:169], v[138:139] op_sel:[1,0,0] op_sel_hi:[1,1,1] neg_lo:[1,0,0] neg_hi:[1,0,0]
    v_pk_fma_f32 v[118:119], v[88:89], v[136:137], v[170:171] op_sel:[1,0,0] op_sel_hi:[1,1,1]
    v_pk_fma_f32 v[120:121], v[96:97], v[232:233], v[202:203] op_sel:[1,0,0] op_sel_hi:[1,1,1] neg_lo:[1,0,0] neg_hi:[1,0,0]
    v_pk_fma_f32 v[122:123], v[96:97], v[200:201], v[234:235] op_sel:[1,0,0] op_sel_hi:[1,1,1]
    v_pk_fma_f32 v[138:139], v[88:89], v[136:137], v[116:117] op_sel:[0,0,0] op_sel_hi:[0,1,1]
    v_pk_fma_f32 v[170:171], v[88:89], v[168:169], v[118:119] op_sel:[0,0,0] op_sel_hi:[0,1,1]
    v_pk_fma_f32 v[202:203], v[96:97], v[200:201], v[120:121] op_sel:[0,0,0] op_sel_hi:[0,1,1]
    v_pk_fma_f32 v[234:235], v[96:97], v[232:233], v[122:123] op_sel:[0,0,0] op_sel_hi:[0,1,1]
    v_pk_fma_f32 v[116:117], v[88:89], v[170:171], v[140:141] op_sel:[1,0,0] op_sel_hi:[1,1,1] neg_lo:[1,0,0] neg_hi:[1,0,0]
    v_pk_fma_f32 v[118:119], v[88:89], v[138:139], v[172:173] op_sel:[1,0,0] op_sel_hi:[1,1,1]
    v_pk_fma_f32 v[120:121], v[96:97], v[234:235], v[204:205] op_sel:[1,0,0] op_sel_hi:[1,1,1] neg_lo:[1,0,0] neg_hi:[1,0,0]
    v_pk_fma_f32 v[122:123], v[96:97], v[202:203], v[236:237] op_sel:[1,0,0] op_sel_hi:[1,1,1]
    v_pk_fma_f32 v[140:141], v[88:89], v[138:139], v[116:117] op_sel:[0,0,0] op_sel_hi:[0,1,1]
    v_pk_fma_f32 v[172:173], v[88:89], v[170:171], v[118:119] op_sel:[0,0,0] op_sel_hi:[0,1,1]
    v_pk_fma_f32 v[204:205], v[96:97], v[202:203], v[120:121] op_sel:[0,0,0] op_sel_hi:[0,1,1]
    v_pk_fma_f32 v[236:237], v[96:97], v[234:235], v[122:123] op_sel:[0,0,0] op_sel_hi:[0,1,1]
    v_pk_fma_f32 v[116:117], v[88:89], v[172:173], v[142:143] op_sel:[1,0,0] op_sel_hi:[1,1,1] neg_lo:[1,0,0] neg_hi:[1,0,0]
    v_pk_fma_f32 v[118:119], v[88:89], v[140:141], v[174:175] op_sel:[1,0,0] op_sel_hi:[1,1,1]
    v_pk_fma_f32 v[120:121], v[96:97], v[236:237], v[206:207] op_sel:[1,0,0] op_sel_hi:[1,1,1] neg_lo:[1,0,0] neg_hi:[1,0,0]
    v_pk_fma_f32 v[122:123], v[96:97], v[204:205], v[238:239] op_sel:[1,0,0] op_sel_hi:[1,1,1]
    v_pk_fma_f32 v[142:143], v[88:89], v[140:141], v[116:117] op_sel:[0,0,0] op_sel_hi:[0,1,1]
    v_pk_fma_f32 v[174:175], v[88:89], v[172:173], v[118:119] op_sel:[0,0,0] op_sel_hi:[0,1,1]
    v_pk_fma_f32 v[206:207], v[96:97], v[204:205], v[120:121] op_sel:[0,0,0] op_sel_hi:[0,1,1]
    v_pk_fma_f32 v[238:239], v[96:97], v[236:237], v[122:123] op_sel:[0,0,0] op_sel_hi:[0,1,1]
    v_cvt_pk_bf16_f32 v16, v128, v130
    v_cvt_pk_bf16_f32 v17, v132, v134
    v_cvt_pk_bf16_f32 v18, v136, v138
    v_cvt_pk_bf16_f32 v19, v140, v142
    v_cvt_pk_bf16_f32 v20, v129, v131
    v_cvt_pk_bf16_f32 v21, v133, v135
    v_cvt_pk_bf16_f32 v22, v137, v139
    v_cvt_pk_bf16_f32 v23, v141, v143
    ds_write_b128 v112, v[16:19] offset:0
    ds_write_b128 v112, v[20:23] offset:32
    v_cvt_pk_bf16_f32 v32, v192, v194
    v_cvt_pk_bf16_f32 v33, v196, v198
    v_cvt_pk_bf16_f32 v34, v200, v202
    v_cvt_pk_bf16_f32 v35, v204, v206
    v_cvt_pk_bf16_f32 v36, v193, v195
    v_cvt_pk_bf16_f32 v37, v197, v199
    v_cvt_pk_bf16_f32 v38, v201, v203
    v_cvt_pk_bf16_f32 v39, v205, v207
    ds_write_b128 v112, v[32:35] offset:4608
    ds_write_b128 v112, v[36:39] offset:4640
    v_cvt_pk_bf16_f32 v24, -v160, -v162
    v_cvt_pk_bf16_f32 v25, -v164, -v166
    v_cvt_pk_bf16_f32 v26, -v168, -v170
    v_cvt_pk_bf16_f32 v27, -v172, -v174
    v_cvt_pk_bf16_f32 v28, -v161, -v163
    v_cvt_pk_bf16_f32 v29, -v165, -v167
    v_cvt_pk_bf16_f32 v30, -v169, -v171
    v_cvt_pk_bf16_f32 v31, -v173, -v175
    v_cvt_pk_bf16_f32 v40, -v224, -v226
    v_cvt_pk_bf16_f32 v41, -v228, -v230
    v_cvt_pk_bf16_f32 v42, -v232, -v234
    v_cvt_pk_bf16_f32 v43, -v236, -v238
    v_cvt_pk_bf16_f32 v44, -v225, -v227
    v_cvt_pk_bf16_f32 v45, -v229, -v231
    v_cvt_pk_bf16_f32 v46, -v233, -v235
    v_cvt_pk_bf16_f32 v47, -v237, -v239
    v_pk_fma_f32 v[116:117], v[88:89], v[174:175], v[144:145] op_sel:[1,0,0] op_sel_hi:[1,1,1] neg_lo:[1,0,0] neg_hi:[1,0,0]
    v_pk_fma_f32 v[118:119], v[88:89], v[142:143], v[176:177] op_sel:[1,0,0] op_sel_hi:[1,1,1]
    v_pk_fma_f32 v[120:121], v[96:97], v[238:239], v[208:209] op_sel:[1,0,0] op_sel_hi:[1,1,1] neg_lo:[1,0,0] neg_hi:[1,0,0]
    v_pk_fma_f32 v[122:123], v[96:97], v[206:207], v[240:241] op_sel:[1,0,0] op_sel_hi:[1,1,1]
    v_pk_fma_f32 v[144:145], v[88:89], v[142:143], v[116:117] op_sel:[0,0,0] op_sel_hi:[0,1,1]
    v_pk_fma_f32 v[176:177], v[88:89], v[174:175], v[118:119] op_sel:[0,0,0] op_sel_hi:[0,1,1]
    v_pk_fma_f32 v[208:209], v[96:97], v[206:207], v[120:121] op_sel:[0,0,0] op_sel_hi:[0,1,1]
    v_pk_fma_f32 v[240:241], v[96:97], v[238:239], v[122:123] op_sel:[0,0,0] op_sel_hi:[0,1,1]
    v_pk_fma_f32 v[116:117], v[88:89], v[176:177], v[146:147] op_sel:[1,0,0] op_sel_hi:[1,1,1] neg_lo:[1,0,0] neg_hi:[1,0,0]
    v_pk_fma_f32 v[118:119], v[88:89], v[144:145], v[178:179] op_sel:[1,0,0] op_sel_hi:[1,1,1]
    v_pk_fma_f32 v[120:121], v[96:97], v[240:241], v[210:211] op_sel:[1,0,0] op_sel_hi:[1,1,1] neg_lo:[1,0,0] neg_hi:[1,0,0]
    v_pk_fma_f32 v[122:123], v[96:97], v[208:209], v[242:243] op_sel:[1,0,0] op_sel_hi:[1,1,1]
    v_pk_fma_f32 v[146:147], v[88:89], v[144:145], v[116:117] op_sel:[0,0,0] op_sel_hi:[0,1,1]
    v_pk_fma_f32 v[178:179], v[88:89], v[176:177], v[118:119] op_sel:[0,0,0] op_sel_hi:[0,1,1]
    v_pk_fma_f32 v[210:211], v[96:97], v[208:209], v[120:121] op_sel:[0,0,0] op_sel_hi:[0,1,1]
    v_pk_fma_f32 v[242:243], v[96:97], v[240:241], v[122:123] op_sel:[0,0,0] op_sel_hi:[0,1,1]
    v_pk_fma_f32 v[116:117], v[88:89], v[178:179], v[148:149] op_sel:[1,0,0] op_sel_hi:[1,1,1] neg_lo:[1,0,0] neg_hi:[1,0,0]
    v_pk_fma_f32 v[118:119], v[88:89], v[146:147], v[180:181] op_sel:[1,0,0] op_sel_hi:[1,1,1]
    v_pk_fma_f32 v[120:121], v[96:97], v[242:243], v[212:213] op_sel:[1,0,0] op_sel_hi:[1,1,1] neg_lo:[1,0,0] neg_hi:[1,0,0]
    v_pk_fma_f32 v[122:123], v[96:97], v[210:211], v[244:245] op_sel:[1,0,0] op_sel_hi:[1,1,1]
    v_pk_fma_f32 v[148:149], v[88:89], v[146:147], v[116:117] op_sel:[0,0,0] op_sel_hi:[0,1,1]
    v_pk_fma_f32 v[180:181], v[88:89], v[178:179], v[118:119] op_sel:[0,0,0] op_sel_hi:[0,1,1]
    v_pk_fma_f32 v[212:213], v[96:97], v[210:211], v[120:121] op_sel:[0,0,0] op_sel_hi:[0,1,1]
    v_pk_fma_f32 v[244:245], v[96:97], v[242:243], v[122:123] op_sel:[0,0,0] op_sel_hi:[0,1,1]
    v_pk_fma_f32 v[116:117], v[88:89], v[180:181], v[150:151] op_sel:[1,0,0] op_sel_hi:[1,1,1] neg_lo:[1,0,0] neg_hi:[1,0,0]
    v_pk_fma_f32 v[118:119], v[88:89], v[148:149], v[182:183] op_sel:[1,0,0] op_sel_hi:[1,1,1]
    v_pk_fma_f32 v[120:121], v[96:97], v[244:245], v[214:215] op_sel:[1,0,0] op_sel_hi:[1,1,1] neg_lo:[1,0,0] neg_hi:[1,0,0]
    v_pk_fma_f32 v[122:123], v[96:97], v[212:213], v[246:247] op_sel:[1,0,0] op_sel_hi:[1,1,1]
    v_pk_fma_f32 v[150:151], v[88:89], v[148:149], v[116:117] op_sel:[0,0,0] op_sel_hi:[0,1,1]
    v_pk_fma_f32 v[182:183], v[88:89], v[180:181], v[118:119] op_sel:[0,0,0] op_sel_hi:[0,1,1]
    v_pk_fma_f32 v[214:215], v[96:97], v[212:213], v[120:121] op_sel:[0,0,0] op_sel_hi:[0,1,1]
    v_pk_fma_f32 v[246:247], v[96:97], v[244:245], v[122:123] op_sel:[0,0,0] op_sel_hi:[0,1,1]
    v_pk_fma_f32 v[116:117], v[88:89], v[182:183], v[152:153] op_sel:[1,0,0] op_sel_hi:[1,1,1] neg_lo:[1,0,0] neg_hi:[1,0,0]
    v_pk_fma_f32 v[118:119], v[88:89], v[150:151], v[184:185] op_sel:[1,0,0] op_sel_hi:[1,1,1]
    v_pk_fma_f32 v[120:121], v[96:97], v[246:247], v[216:217] op_sel:[1,0,0] op_sel_hi:[1,1,1] neg_lo:[1,0,0] neg_hi:[1,0,0]
    v_pk_fma_f32 v[122:123], v[96:97], v[214:215], v[248:249] op_sel:[1,0,0] op_sel_hi:[1,1,1]
    v_pk_fma_f32 v[152:153], v[88:89], v[150:151], v[116:117] op_sel:[0,0,0] op_sel_hi:[0,1,1]
    v_pk_fma_f32 v[184:185], v[88:89], v[182:183], v[118:119] op_sel:[0,0,0] op_sel_hi:[0,1,1]
    v_pk_fma_f32 v[216:217], v[96:97], v[214:215], v[120:121] op_sel:[0,0,0] op_sel_hi:[0,1,1]
    v_pk_fma_f32 v[248:249], v[96:97], v[246:247], v[122:123] op_sel:[0,0,0] op_sel_hi:[0,1,1]
    v_pk_fma_f32 v[116:117], v[88:89], v[184:185], v[154:155] op_sel:[1,0,0] op_sel_hi:[1,1,1] neg_lo:[1,0,0] neg_hi:[1,0,0]
    v_pk_fma_f32 v[118:119], v[88:89], v[152:153], v[186:187] op_sel:[1,0,0] op_sel_hi:[1,1,1]
    v_pk_fma_f32 v[120:121], v[96:97], v[248:249], v[218:219] op_sel:[1,0,0] op_sel_hi:[1,1,1] neg_lo:[1,0,0] neg_hi:[1,0,0]
    v_pk_fma_f32 v[122:123], v[96:97], v[216:217], v[250:251] op_sel:[1,0,0] op_sel_hi:[1,1,1]
    v_pk_fma_f32 v[154:155], v[88:89], v[152:153], v[116:117] op_sel:[0,0,0] op_sel_hi:[0,1,1]
    v_pk_fma_f32 v[186:187], v[88:89], v[184:185], v[118:119] op_sel:[0,0,0] op_sel_hi:[0,1,1]
    v_pk_fma_f32 v[218:219], v[96:97], v[216:217], v[120:121] op_sel:[0,0,0] op_sel_hi:[0,1,1]
    v_pk_fma_f32 v[250:251], v[96:97], v[248:249], v[122:123] op_sel:[0,0,0] op_sel_hi:[0,1,1]
    v_pk_fma_f32 v[116:117], v[88:89], v[186:187], v[156:157] op_sel:[1,0,0] op_sel_hi:[1,1,1] neg_lo:[1,0,0] neg_hi:[1,0,0]
    v_pk_fma_f32 v[118:119], v[88:89], v[154:155], v[188:189] op_sel:[1,0,0] op_sel_hi:[1,1,1]
    v_pk_fma_f32 v[120:121], v[96:97], v[250:251], v[220:221] op_sel:[1,0,0] op_sel_hi:[1,1,1] neg_lo:[1,0,0] neg_hi:[1,0,0]
    v_pk_fma_f32 v[122:123], v[96:97], v[218:219], v[252:253] op_sel:[1,0,0] op_sel_hi:[1,1,1]
    v_pk_fma_f32 v[156:157], v[88:89], v[154:155], v[116:117] op_sel:[0,0,0] op_sel_hi:[0,1,1]
    v_pk_fma_f32 v[188:189], v[88:89], v[186:187], v[118:119] op_sel:[0,0,0] op_sel_hi:[0,1,1]
    v_pk_fma_f32 v[220:221], v[96:97], v[218:219], v[120:121] op_sel:[0,0,0] op_sel_hi:[0,1,1]
    v_pk_fma_f32 v[252:253], v[96:97], v[250:251], v[122:123] op_sel:[0,0,0] op_sel_hi:[0,1,1]
    v_pk_fma_f32 v[116:117], v[88:89], v[188:189], v[158:159] op_sel:[1,0,0] op_sel_hi:[1,1,1] neg_lo:[1,0,0] neg_hi:[1,0,0]
    v_pk_fma_f32 v[118:119], v[88:89], v[156:157], v[190:191] op_sel:[1,0,0] op_sel_hi:[1,1,1]
    v_pk_fma_f32 v[120:121], v[96:97], v[252:253], v[222:223] op_sel:[1,0,0] op_sel_hi:[1,1,1] neg_lo:[1,0,0] neg_hi:[1,0,0]
    v_pk_fma_f32 v[122:123], v[96:97], v[220:221], v[254:255] op_sel:[1,0,0] op_sel_hi:[1,1,1]
    v_pk_fma_f32 v[158:159], v[88:89], v[156:157], v[116:117] op_sel:[0,0,0] op_sel_hi:[0,1,1]
    v_pk_fma_f32 v[190:191], v[88:89], v[188:189], v[118:119] op_sel:[0,0,0] op_sel_hi:[0,1,1]
    v_pk_fma_f32 v[222:223], v[96:97], v[220:221], v[120:121] op_sel:[0,0,0] op_sel_hi:[0,1,1]
    v_pk_fma_f32 v[254:255], v[96:97], v[252:253], v[122:123] op_sel:[0,0,0] op_sel_hi:[0,1,1]
    v_cvt_pk_bf16_f32 v48, v144, v146
    v_cvt_pk_bf16_f32 v49, v148, v150
    v_cvt_pk_bf16_f32 v50, v152, v154
    v_cvt_pk_bf16_f32 v51, v156, v158
    v_cvt_pk_bf16_f32 v52, v145, v147
    v_cvt_pk_bf16_f32 v53, v149, v151
    v_cvt_pk_bf16_f32 v54, v153, v155
    v_cvt_pk_bf16_f32 v55, v157, v159
    ds_write_b128 v112, v[48:51] offset:16
    ds_write_b128 v112, v[52:55] offset:48
    v_cvt_pk_bf16_f32 v64, v208, v210
    v_cvt_pk_bf16_f32 v65, v212, v214
    v_cvt_pk_bf16_f32 v66, v216, v218
    v_cvt_pk_bf16_f32 v67, v220, v222
    v_cvt_pk_bf16_f32 v68, v209, v211
    v_cvt_pk_bf16_f32 v69, v213, v215
    v_cvt_pk_bf16_f32 v70, v217, v219
    v_cvt_pk_bf16_f32 v71, v221, v223
    ds_write_b128 v112, v[64:67] offset:4624
    ds_write_b128 v112, v[68:71] offset:4656
    v_cvt_pk_bf16_f32 v56, -v176, -v178
    v_cvt_pk_bf16_f32 v57, -v180, -v182
    v_cvt_pk_bf16_f32 v58, -v184, -v186
    v_cvt_pk_bf16_f32 v59, -v188, -v190
    v_cvt_pk_bf16_f32 v60, -v177, -v179
    v_cvt_pk_bf16_f32 v61, -v181, -v183
    v_cvt_pk_bf16_f32 v62, -v185, -v187
    v_cvt_pk_bf16_f32 v63, -v189, -v191
    v_cvt_pk_bf16_f32 v72, -v240, -v242
    v_cvt_pk_bf16_f32 v73, -v244, -v246
    v_cvt_pk_bf16_f32 v74, -v248, -v250
    v_cvt_pk_bf16_f32 v75, -v252, -v254
    v_cvt_pk_bf16_f32 v76, -v241, -v243
    v_cvt_pk_bf16_f32 v77, -v245, -v247
    v_cvt_pk_bf16_f32 v78, -v249, -v251
    v_cvt_pk_bf16_f32 v79, -v253, -v255
    s_add_u32 s80, s12, 0
    s_add_u32 s81, s12, 96256
    s_add_u32 s82, s12, 192512
    s_add_u32 s83, s12, 288768
    v_add_u32 v115, 20480, v114
    ds_read_b64_tr_b16 v[128:129], v113 offset:0
    ds_read_b64_tr_b16 v[130:131], v113 offset:576
    ds_read_b64_tr_b16 v[132:133], v113 offset:32
    ds_read_b64_tr_b16 v[134:135], v113 offset:608
    ds_read_b64_tr_b16 v[136:137], v113 offset:64
    ds_read_b64_tr_b16 v[138:139], v113 offset:640
    ds_read_b64_tr_b16 v[140:141], v113 offset:96
    ds_read_b64_tr_b16 v[142:143], v113 offset:672
    ds_read_b64_tr_b16 v[144:145], v113 offset:4608
    ds_read_b64_tr_b16 v[146:147], v113 offset:5184
    s_waitcnt lgkmcnt(8)
    buffer_store_dwordx4 v[128:131], v114, s[56:59], s80 offen offset:0 sc1
    ds_read_b64_tr_b16 v[148:149], v113 offset:4640
    ds_read_b64_tr_b16 v[150:151], v113 offset:5216
    s_waitcnt lgkmcnt(8)
    buffer_store_dwordx4 v[132:135], v114, s[56:59], s81 offen offset:0 sc1
    ds_read_b64_tr_b16 v[152:153], v113 offset:4672
    ds_read_b64_tr_b16 v[154:155], v113 offset:5248
    s_waitcnt lgkmcnt(8)
    buffer_store_dwordx4 v[136:139], v114, s[56:59], s82 offen offset:0 sc1
    ds_read_b64_tr_b16 v[156:157], v113 offset:4704
    ds_read_b64_tr_b16 v[158:159], v113 offset:5280
    s_waitcnt lgkmcnt(8)
    buffer_store_dwordx4 v[140:143], v114, s[56:59], s83 offen offset:0 sc1
    ds_write_b128 v112, v[24:27] offset:0
    ds_write_b128 v112, v[28:31] offset:32
    ds_write_b128 v112, v[56:59] offset:16
    ds_write_b128 v112, v[60:63] offset:48
    ds_read_b64_tr_b16 v[160:161], v113 offset:0
    ds_read_b64_tr_b16 v[162:163], v113 offset:576
    s_waitcnt lgkmcnt(12)
    buffer_store_dwordx4 v[144:147], v114, s[56:59], s80 offen offset:1024 sc1
    ds_read_b64_tr_b16 v[164:165], v113 offset:32
    ds_read_b64_tr_b16 v[166:167], v113 offset:608
    s_waitcnt lgkmcnt(12)
    buffer_store_dwordx4 v[148:151], v114, s[56:59], s81 offen offset:1024 sc1
    ds_read_b64_tr_b16 v[168:169], v113 offset:64
    ds_read_b64_tr_b16 v[170:171], v113 offset:640
    s_waitcnt lgkmcnt(12)
    buffer_store_dwordx4 v[152:155], v114, s[56:59], s82 offen offset:1024 sc1
    ds_read_b64_tr_b16 v[172:173], v113 offset:96
    ds_read_b64_tr_b16 v[174:175], v113 offset:672
    s_waitcnt lgkmcnt(12)
    buffer_store_dwordx4 v[156:159], v114, s[56:59], s83 offen offset:1024 sc1
    ds_write_b128 v112, v[40:43] offset:4608
    ds_write_b128 v112, v[44:47] offset:4640
    ds_write_b128 v112, v[72:75] offset:4624
    ds_write_b128 v112, v[76:79] offset:4656
    ds_read_b64_tr_b16 v[176:177], v113 offset:4608
    ds_read_b64_tr_b16 v[178:179], v113 offset:5184
    s_waitcnt lgkmcnt(12)
    buffer_store_dwordx4 v[160:163], v115, s[56:59], s80 offen offset:0 sc1
    ds_read_b64_tr_b16 v[180:181], v113 offset:4640
    ds_read_b64_tr_b16 v[182:183], v113 offset:5216
    s_waitcnt lgkmcnt(12)
    buffer_store_dwordx4 v[164:167], v115, s[56:59], s81 offen offset:0 sc1
    ds_read_b64_tr_b16 v[184:185], v113 offset:4672
    ds_read_b64_tr_b16 v[186:187], v113 offset:5248
    s_waitcnt lgkmcnt(12)
    buffer_store_dwordx4 v[168:171], v115, s[56:59], s82 offen offset:0 sc1
    ds_read_b64_tr_b16 v[188:189], v113 offset:4704
    ds_read_b64_tr_b16 v[190:191], v113 offset:5280
    s_waitcnt lgkmcnt(12)
    buffer_store_dwordx4 v[172:175], v115, s[56:59], s83 offen offset:0 sc1
    s_waitcnt lgkmcnt(6)
    buffer_store_dwordx4 v[176:179], v115, s[56:59], s80 offen offset:1024 sc1
    s_waitcnt lgkmcnt(4)
    buffer_store_dwordx4 v[180:183], v115, s[56:59], s81 offen offset:1024 sc1
    s_waitcnt lgkmcnt(2)
    buffer_store_dwordx4 v[184:187], v115, s[56:59], s82 offen offset:1024 sc1
    s_waitcnt lgkmcnt(0)
    buffer_store_dwordx4 v[188:191], v115, s[56:59], s83 offen offset:1024 sc1
    s_mov_b32 s101, 0
parallel_sum__ssm_conv_s5__glu_gated_bilinear__prompt_kernel_p2c:
    s_setprio 0
    s_mov_b32 s52, s42
    s_mov_b32 s53, s43
    s_mov_b32 s54, 0x500000
    s_mov_b32 s55, 0x00020000
    v_lshlrev_b32 v4, 4, v1
    v_lshlrev_b32 v5, 4, v1
    v_lshlrev_b32 v6, 4, v1
    v_lshlrev_b32 v7, 4, v1
    v_add_u32 v8, 4096, v4
    s_mul_i32 s10, s6, 276480
    s_mul_i32 s11, s14, 5120
    s_add_u32 s10, s10, s11
    s_add_u32 s10, s10, 0x200000
    s_lshl_b32 s80, s6, 2
    s_add_u32 s80, s80, s5
    s_lshl_b32 s80, s80, 6
    s_add_u32 s80, s80, s7
    s_lshl_b32 s80, s80, 2
    s_add_u32 s80, s80, s101
    s_add_u32 s100, s80, 0xe0000
    s_lshl_b32 s80, s7, 2
    s_mul_i32 s80, s80, 96256
    s_lshl_b32 s81, s5, 10
    s_add_u32 s80, s80, s81
    s_add_u32 s80, s80, 40960
    s_add_u32 s81, s5, 0
    s_and_b32 s81, s81, 3
    s_mul_i32 s81, s81, 96256
    s_add_u32 s8, s80, s81
    s_add_u32 s81, s5, 1
    s_and_b32 s81, s81, 3
    s_mul_i32 s81, s81, 96256
    s_add_u32 s9, s80, s81
    s_add_u32 s81, s5, 2
    s_and_b32 s81, s81, 3
    s_mul_i32 s81, s81, 96256
    s_add_u32 s12, s80, s81
    s_add_u32 s81, s5, 3
    s_and_b32 s81, s81, 3
    s_mul_i32 s81, s81, 96256
    s_add_u32 s13, s80, s81
    v_lshlrev_b32 v0, 4, v1
    v_lshrrev_b32 v2, 5, v1
    v_lshlrev_b32 v2, 4, v2
    v_bfe_u32 v3, v1, 4, 1
    v_lshl_add_u32 v2, v3, 2, v2
    v_bfe_u32 v3, v1, 2, 2
    v_add_u32 v2, v2, v3
    v_mul_u32_u24 v2, 160, v2
    v_and_b32 v3, 3, v1
    v_lshl_add_u32 v2, v3, 3, v2
    v_add_u32 v2, s11, v2
    v_add_u32 v3, 0x14000, v2
    v_mov_b32 v10, s15
    v_mov_b32 v11, 0
    s_barrier
    ds_read_b64_tr_b16 v[12:13], v2 offset:61440
    ds_read_b64_tr_b16 v[14:15], v2 offset:62720
    ds_read_b64_tr_b16 v[16:17], v2 offset:61472
    ds_read_b64_tr_b16 v[18:19], v2 offset:62752
    ds_read_b64_tr_b16 v[20:21], v2 offset:61504
    ds_read_b64_tr_b16 v[22:23], v2 offset:62784
    ds_read_b64_tr_b16 v[24:25], v2 offset:61536
    ds_read_b64_tr_b16 v[26:27], v2 offset:62816
    ds_read_b64_tr_b16 v[28:29], v2 offset:61568
    ds_read_b64_tr_b16 v[30:31], v2 offset:62848
    ds_read_b64_tr_b16 v[32:33], v3 offset:0
    ds_read_b64_tr_b16 v[34:35], v3 offset:1280
    ds_read_b64_tr_b16 v[36:37], v3 offset:32
    ds_read_b64_tr_b16 v[38:39], v3 offset:1312
    ds_read_b64_tr_b16 v[40:41], v3 offset:64
    ds_read_b64_tr_b16 v[42:43], v3 offset:1344
    ds_read_b64_tr_b16 v[44:45], v3 offset:96
    ds_read_b64_tr_b16 v[46:47], v3 offset:1376
    ds_read_b64_tr_b16 v[48:49], v3 offset:128
    ds_read_b64_tr_b16 v[50:51], v3 offset:1408
    ds_read_b64_tr_b16 v[52:53], v3 offset:20480
    ds_read_b64_tr_b16 v[54:55], v3 offset:21760
    ds_read_b64_tr_b16 v[56:57], v3 offset:20512
    ds_read_b64_tr_b16 v[58:59], v3 offset:21792
    ds_read_b64_tr_b16 v[60:61], v3 offset:20544
    ds_read_b64_tr_b16 v[62:63], v3 offset:21824
    ds_read_b64_tr_b16 v[64:65], v3 offset:20576
    ds_read_b64_tr_b16 v[66:67], v3 offset:21856
    ds_read_b64_tr_b16 v[68:69], v3 offset:20608
    ds_read_b64_tr_b16 v[70:71], v3 offset:21888
    ds_read_b64_tr_b16 v[72:73], v3 offset:40960
    ds_read_b64_tr_b16 v[74:75], v3 offset:42240
    ds_read_b64_tr_b16 v[76:77], v3 offset:40992
    ds_read_b64_tr_b16 v[78:79], v3 offset:42272
    ds_read_b64_tr_b16 v[80:81], v3 offset:41024
    ds_read_b64_tr_b16 v[82:83], v3 offset:42304
    ds_read_b64_tr_b16 v[84:85], v3 offset:41056
    ds_read_b64_tr_b16 v[86:87], v3 offset:42336
    ds_read_b64_tr_b16 v[88:89], v3 offset:41088
    ds_read_b64_tr_b16 v[90:91], v3 offset:42368
    ds_read_b64_tr_b16 v[92:93], v3 offset:61440
    ds_read_b64_tr_b16 v[94:95], v3 offset:62720
    ds_read_b64_tr_b16 v[96:97], v3 offset:61472
    ds_read_b64_tr_b16 v[98:99], v3 offset:62752
    ds_read_b64_tr_b16 v[100:101], v3 offset:61504
    ds_read_b64_tr_b16 v[102:103], v3 offset:62784
    ds_read_b64_tr_b16 v[104:105], v3 offset:61536
    ds_read_b64_tr_b16 v[106:107], v3 offset:62816
    ds_read_b64_tr_b16 v[108:109], v3 offset:61568
    ds_read_b64_tr_b16 v[110:111], v3 offset:62848
    s_waitcnt lgkmcnt(0)
    s_barrier
    s_waitcnt vmcnt(0)
    s_mov_b64 exec, 1
    buffer_store_dword v10, v11, s[64:67], s100 offen sc1
    s_mov_b64 exec, -1
    s_cmp_lt_u32 s5, 2
    s_cselect_b32 s0, 13, 12
    s_cselect_b64 s[34:35], -1, 0
    s_lshl_b32 s0, s0, 12
    s_add_u32 s1, s10, 266240
    s_lshr_b32 s80, s2, 5
    s_bfe_u32 s81, s2, 0x20003
    s_mul_i32 s80, s80, 3
    s_lshr_b32 s4, s80, 1
    s_sub_u32 s80, s4, 13
    s_cmp_ge_u32 s4, 13
    s_cselect_b32 s4, s80, s4
    s_lshl_b32 s4, s4, 12
    v_min_u32 v10, 37, v1
    v_lshlrev_b32 v10, 7, v10
    s_cmp_eq_u32 s101, 0
    s_cbranch_scc1 parallel_sum__ssm_conv_s5__glu_gated_bilinear__prompt_kernel_e3skip
    s_barrier
parallel_sum__ssm_conv_s5__glu_gated_bilinear__prompt_kernel_e3skip:
    s_add_u32 s80, s8, s4
    buffer_load_dwordx4 v[112:115], v0, s[56:59], s80 offen sc1
    s_add_u32 s80, s9, s4
    buffer_load_dwordx4 v[116:119], v0, s[56:59], s80 offen sc1
    s_add_u32 s80, s12, s4
    buffer_load_dwordx4 v[120:123], v0, s[56:59], s80 offen sc1
    s_add_u32 s80, s13, s4
    s_add_u32 s4, s4, 4096
    s_cmp_eq_u32 s4, 53248
    s_cselect_b32 s4, 0, s4
    buffer_load_dwordx4 v[124:127], v0, s[56:59], s80 offen sc1
    s_add_u32 s80, s8, s4
    buffer_load_dwordx4 v[128:131], v0, s[56:59], s80 offen sc1
    s_add_u32 s80, s9, s4
    buffer_load_dwordx4 v[132:135], v0, s[56:59], s80 offen sc1
    s_add_u32 s80, s12, s4
    buffer_load_dwordx4 v[136:139], v0, s[56:59], s80 offen sc1
    s_add_u32 s80, s13, s4
    s_add_u32 s4, s4, 4096
    s_cmp_eq_u32 s4, 53248
    s_cselect_b32 s4, 0, s4
    buffer_load_dwordx4 v[140:143], v0, s[56:59], s80 offen sc1
    s_add_u32 s80, s8, s4
    buffer_load_dwordx4 v[144:147], v0, s[56:59], s80 offen sc1
    s_add_u32 s80, s9, s4
    buffer_load_dwordx4 v[148:151], v0, s[56:59], s80 offen sc1
    s_add_u32 s80, s12, s4
    buffer_load_dwordx4 v[152:155], v0, s[56:59], s80 offen sc1
    s_add_u32 s80, s13, s4
    s_add_u32 s4, s4, 4096
    s_cmp_eq_u32 s4, 53248
    s_cselect_b32 s4, 0, s4
    buffer_load_dwordx4 v[156:159], v0, s[56:59], s80 offen sc1
    s_add_u32 s80, s8, s4
    buffer_load_dwordx4 v[160:163], v0, s[56:59], s80 offen sc1
    s_add_u32 s80, s9, s4
    buffer_load_dwordx4 v[164:167], v0, s[56:59], s80 offen sc1
    s_add_u32 s80, s12, s4
    buffer_load_dwordx4 v[168:171], v0, s[56:59], s80 offen sc1
    s_add_u32 s80, s13, s4
    s_add_u32 s4, s4, 4096
    s_cmp_eq_u32 s4, 53248
    s_cselect_b32 s4, 0, s4
    buffer_load_dwordx4 v[172:175], v0, s[56:59], s80 offen sc1
    s_waitcnt vmcnt(15)
    v_mfma_f32_16x16x32_bf16 v[176:179], v[12:15], v[112:115], 0
    v_mfma_f32_16x16x32_bf16 v[180:183], v[16:19], v[112:115], 0
    v_mfma_f32_16x16x32_bf16 v[184:187], v[20:23], v[112:115], 0
    v_mfma_f32_16x16x32_bf16 v[188:191], v[24:27], v[112:115], 0
    v_mfma_f32_16x16x32_bf16 v[192:195], v[28:31], v[112:115], 0
    s_add_u32 s80, s8, s4
    buffer_load_dwordx4 v[112:115], v0, s[56:59], s80 offen sc1
    s_waitcnt vmcnt(15)
    v_mfma_f32_16x16x32_bf16 v[196:199], v[12:15], v[116:119], 0
    v_mfma_f32_16x16x32_bf16 v[200:203], v[16:19], v[116:119], 0
    v_mfma_f32_16x16x32_bf16 v[204:207], v[20:23], v[116:119], 0
    v_mfma_f32_16x16x32_bf16 v[208:211], v[24:27], v[116:119], 0
    v_mfma_f32_16x16x32_bf16 v[212:215], v[28:31], v[116:119], 0
    s_add_u32 s80, s9, s4
    buffer_load_dwordx4 v[116:119], v0, s[56:59], s80 offen sc1
    s_waitcnt vmcnt(15)
    v_mfma_f32_16x16x32_bf16 v[216:219], v[12:15], v[120:123], 0
    v_mfma_f32_16x16x32_bf16 v[220:223], v[16:19], v[120:123], 0
    v_mfma_f32_16x16x32_bf16 v[224:227], v[20:23], v[120:123], 0
    v_mfma_f32_16x16x32_bf16 v[228:231], v[24:27], v[120:123], 0
    v_mfma_f32_16x16x32_bf16 v[232:235], v[28:31], v[120:123], 0
    s_add_u32 s80, s12, s4
    buffer_load_dwordx4 v[120:123], v0, s[56:59], s80 offen sc1
    s_waitcnt vmcnt(15)
    v_mfma_f32_16x16x32_bf16 v[236:239], v[12:15], v[124:127], 0
    v_mfma_f32_16x16x32_bf16 v[240:243], v[16:19], v[124:127], 0
    v_mfma_f32_16x16x32_bf16 v[244:247], v[20:23], v[124:127], 0
    v_mfma_f32_16x16x32_bf16 v[248:251], v[24:27], v[124:127], 0
    v_mfma_f32_16x16x32_bf16 v[252:255], v[28:31], v[124:127], 0
    s_add_u32 s80, s13, s4
    s_add_u32 s4, s4, 4096
    s_cmp_eq_u32 s4, 53248
    s_cselect_b32 s4, 0, s4
    buffer_load_dwordx4 v[124:127], v0, s[56:59], s80 offen sc1
    s_cmp_lg_u32 s101, 0
    s_cbranch_scc1 g_3
    s_barrier
g_3:
    s_waitcnt vmcnt(15)
    v_mfma_f32_16x16x32_bf16 v[176:179], v[32:35], v[128:131], v[176:179]
    v_mfma_f32_16x16x32_bf16 v[180:183], v[36:39], v[128:131], v[180:183]
    v_mfma_f32_16x16x32_bf16 v[184:187], v[40:43], v[128:131], v[184:187]
    v_mfma_f32_16x16x32_bf16 v[188:191], v[44:47], v[128:131], v[188:191]
    v_mfma_f32_16x16x32_bf16 v[192:195], v[48:51], v[128:131], v[192:195]
    s_add_u32 s80, s8, s4
    buffer_load_dwordx4 v[128:131], v0, s[56:59], s80 offen sc1
    s_waitcnt vmcnt(15)
    v_mfma_f32_16x16x32_bf16 v[196:199], v[32:35], v[132:135], v[196:199]
    v_mfma_f32_16x16x32_bf16 v[200:203], v[36:39], v[132:135], v[200:203]
    v_mfma_f32_16x16x32_bf16 v[204:207], v[40:43], v[132:135], v[204:207]
    v_mfma_f32_16x16x32_bf16 v[208:211], v[44:47], v[132:135], v[208:211]
    v_mfma_f32_16x16x32_bf16 v[212:215], v[48:51], v[132:135], v[212:215]
    s_add_u32 s80, s9, s4
    buffer_load_dwordx4 v[132:135], v0, s[56:59], s80 offen sc1
    s_waitcnt vmcnt(15)
    v_mfma_f32_16x16x32_bf16 v[216:219], v[32:35], v[136:139], v[216:219]
    v_mfma_f32_16x16x32_bf16 v[220:223], v[36:39], v[136:139], v[220:223]
    v_mfma_f32_16x16x32_bf16 v[224:227], v[40:43], v[136:139], v[224:227]
    v_mfma_f32_16x16x32_bf16 v[228:231], v[44:47], v[136:139], v[228:231]
    v_mfma_f32_16x16x32_bf16 v[232:235], v[48:51], v[136:139], v[232:235]
    s_add_u32 s80, s12, s4
    buffer_load_dwordx4 v[136:139], v0, s[56:59], s80 offen sc1
    s_waitcnt vmcnt(15)
    v_mfma_f32_16x16x32_bf16 v[236:239], v[32:35], v[140:143], v[236:239]
    v_mfma_f32_16x16x32_bf16 v[240:243], v[36:39], v[140:143], v[240:243]
    v_mfma_f32_16x16x32_bf16 v[244:247], v[40:43], v[140:143], v[244:247]
    v_mfma_f32_16x16x32_bf16 v[248:251], v[44:47], v[140:143], v[248:251]
    v_mfma_f32_16x16x32_bf16 v[252:255], v[48:51], v[140:143], v[252:255]
    s_add_u32 s80, s13, s4
    s_add_u32 s4, s4, 4096
    s_cmp_eq_u32 s4, 53248
    s_cselect_b32 s4, 0, s4
    buffer_load_dwordx4 v[140:143], v0, s[56:59], s80 offen sc1
    s_waitcnt vmcnt(15)
    v_mfma_f32_16x16x32_bf16 v[176:179], v[52:55], v[144:147], v[176:179]
    v_mfma_f32_16x16x32_bf16 v[180:183], v[56:59], v[144:147], v[180:183]
    v_mfma_f32_16x16x32_bf16 v[184:187], v[60:63], v[144:147], v[184:187]
    v_mfma_f32_16x16x32_bf16 v[188:191], v[64:67], v[144:147], v[188:191]
    v_mfma_f32_16x16x32_bf16 v[192:195], v[68:71], v[144:147], v[192:195]
    s_add_u32 s80, s8, s4
    buffer_load_dwordx4 v[144:147], v0, s[56:59], s80 offen sc1
    s_waitcnt vmcnt(15)
    v_mfma_f32_16x16x32_bf16 v[196:199], v[52:55], v[148:151], v[196:199]
    v_mfma_f32_16x16x32_bf16 v[200:203], v[56:59], v[148:151], v[200:203]
    v_mfma_f32_16x16x32_bf16 v[204:207], v[60:63], v[148:151], v[204:207]
    v_mfma_f32_16x16x32_bf16 v[208:211], v[64:67], v[148:151], v[208:211]
    v_mfma_f32_16x16x32_bf16 v[212:215], v[68:71], v[148:151], v[212:215]
    s_add_u32 s80, s9, s4
    buffer_load_dwordx4 v[148:151], v0, s[56:59], s80 offen sc1
    s_waitcnt vmcnt(15)
    v_mfma_f32_16x16x32_bf16 v[216:219], v[52:55], v[152:155], v[216:219]
    v_mfma_f32_16x16x32_bf16 v[220:223], v[56:59], v[152:155], v[220:223]
    v_mfma_f32_16x16x32_bf16 v[224:227], v[60:63], v[152:155], v[224:227]
    v_mfma_f32_16x16x32_bf16 v[228:231], v[64:67], v[152:155], v[228:231]
    v_mfma_f32_16x16x32_bf16 v[232:235], v[68:71], v[152:155], v[232:235]
    s_add_u32 s80, s12, s4
    buffer_load_dwordx4 v[152:155], v0, s[56:59], s80 offen sc1
    s_waitcnt vmcnt(15)
    v_mfma_f32_16x16x32_bf16 v[236:239], v[52:55], v[156:159], v[236:239]
    v_mfma_f32_16x16x32_bf16 v[240:243], v[56:59], v[156:159], v[240:243]
    v_mfma_f32_16x16x32_bf16 v[244:247], v[60:63], v[156:159], v[244:247]
    v_mfma_f32_16x16x32_bf16 v[248:251], v[64:67], v[156:159], v[248:251]
    v_mfma_f32_16x16x32_bf16 v[252:255], v[68:71], v[156:159], v[252:255]
    s_add_u32 s80, s13, s4
    s_add_u32 s4, s4, 4096
    s_cmp_eq_u32 s4, 53248
    s_cselect_b32 s4, 0, s4
    buffer_load_dwordx4 v[156:159], v0, s[56:59], s80 offen sc1
    s_waitcnt vmcnt(15)
    v_mfma_f32_16x16x32_bf16 v[176:179], v[72:75], v[160:163], v[176:179]
    v_mfma_f32_16x16x32_bf16 v[180:183], v[76:79], v[160:163], v[180:183]
    v_mfma_f32_16x16x32_bf16 v[184:187], v[80:83], v[160:163], v[184:187]
    v_mfma_f32_16x16x32_bf16 v[188:191], v[84:87], v[160:163], v[188:191]
    v_mfma_f32_16x16x32_bf16 v[192:195], v[88:91], v[160:163], v[192:195]
    s_add_u32 s80, s8, s4
    buffer_load_dwordx4 v[160:163], v0, s[56:59], s80 offen sc1
    s_waitcnt vmcnt(15)
    v_mfma_f32_16x16x32_bf16 v[196:199], v[72:75], v[164:167], v[196:199]
    v_mfma_f32_16x16x32_bf16 v[200:203], v[76:79], v[164:167], v[200:203]
    v_mfma_f32_16x16x32_bf16 v[204:207], v[80:83], v[164:167], v[204:207]
    v_mfma_f32_16x16x32_bf16 v[208:211], v[84:87], v[164:167], v[208:211]
    v_mfma_f32_16x16x32_bf16 v[212:215], v[88:91], v[164:167], v[212:215]
    s_add_u32 s80, s9, s4
    buffer_load_dwordx4 v[164:167], v0, s[56:59], s80 offen sc1
    s_waitcnt vmcnt(15)
    v_mfma_f32_16x16x32_bf16 v[216:219], v[72:75], v[168:171], v[216:219]
    v_mfma_f32_16x16x32_bf16 v[220:223], v[76:79], v[168:171], v[220:223]
    v_mfma_f32_16x16x32_bf16 v[224:227], v[80:83], v[168:171], v[224:227]
    v_mfma_f32_16x16x32_bf16 v[228:231], v[84:87], v[168:171], v[228:231]
    v_mfma_f32_16x16x32_bf16 v[232:235], v[88:91], v[168:171], v[232:235]
    s_add_u32 s80, s12, s4
    buffer_load_dwordx4 v[168:171], v0, s[56:59], s80 offen sc1
    s_waitcnt vmcnt(15)
    v_mfma_f32_16x16x32_bf16 v[236:239], v[72:75], v[172:175], v[236:239]
    v_mfma_f32_16x16x32_bf16 v[240:243], v[76:79], v[172:175], v[240:243]
    v_mfma_f32_16x16x32_bf16 v[244:247], v[80:83], v[172:175], v[244:247]
    v_mfma_f32_16x16x32_bf16 v[248:251], v[84:87], v[172:175], v[248:251]
    v_mfma_f32_16x16x32_bf16 v[252:255], v[88:91], v[172:175], v[252:255]
    s_add_u32 s80, s13, s4
    s_add_u32 s4, s4, 4096
    s_cmp_eq_u32 s4, 53248
    s_cselect_b32 s4, 0, s4
    buffer_load_dwordx4 v[172:175], v0, s[56:59], s80 offen sc1
    s_waitcnt vmcnt(15)
    v_mfma_f32_16x16x32_bf16 v[176:179], v[92:95], v[112:115], v[176:179]
    v_mfma_f32_16x16x32_bf16 v[180:183], v[96:99], v[112:115], v[180:183]
    v_mfma_f32_16x16x32_bf16 v[184:187], v[100:103], v[112:115], v[184:187]
    v_mfma_f32_16x16x32_bf16 v[188:191], v[104:107], v[112:115], v[188:191]
    v_mfma_f32_16x16x32_bf16 v[192:195], v[108:111], v[112:115], v[192:195]
    s_add_u32 s80, s8, s4
    buffer_load_dwordx4 v[112:115], v0, s[56:59], s80 offen sc1
    s_waitcnt vmcnt(15)
    v_mfma_f32_16x16x32_bf16 v[196:199], v[92:95], v[116:119], v[196:199]
    ds_read_b64_tr_b16 v[12:13], v2 offset:0
    v_mfma_f32_16x16x32_bf16 v[200:203], v[96:99], v[116:119], v[200:203]
    ds_read_b64_tr_b16 v[14:15], v2 offset:1280
    v_mfma_f32_16x16x32_bf16 v[204:207], v[100:103], v[116:119], v[204:207]
    ds_read_b64_tr_b16 v[16:17], v2 offset:32
    v_mfma_f32_16x16x32_bf16 v[208:211], v[104:107], v[116:119], v[208:211]
    ds_read_b64_tr_b16 v[18:19], v2 offset:1312
    v_mfma_f32_16x16x32_bf16 v[212:215], v[108:111], v[116:119], v[212:215]
    ds_read_b64_tr_b16 v[20:21], v2 offset:64
    s_add_u32 s80, s9, s4
    buffer_load_dwordx4 v[116:119], v0, s[56:59], s80 offen sc1
    s_waitcnt vmcnt(15)
    v_mfma_f32_16x16x32_bf16 v[216:219], v[92:95], v[120:123], v[216:219]
    ds_read_b64_tr_b16 v[22:23], v2 offset:1344
    v_mfma_f32_16x16x32_bf16 v[220:223], v[96:99], v[120:123], v[220:223]
    ds_read_b64_tr_b16 v[24:25], v2 offset:96
    v_mfma_f32_16x16x32_bf16 v[224:227], v[100:103], v[120:123], v[224:227]
    ds_read_b64_tr_b16 v[26:27], v2 offset:1376
    v_mfma_f32_16x16x32_bf16 v[228:231], v[104:107], v[120:123], v[228:231]
    ds_read_b64_tr_b16 v[28:29], v2 offset:128
    v_mfma_f32_16x16x32_bf16 v[232:235], v[108:111], v[120:123], v[232:235]
    ds_read_b64_tr_b16 v[30:31], v2 offset:1408
    s_add_u32 s80, s12, s4
    buffer_load_dwordx4 v[120:123], v0, s[56:59], s80 offen sc1
    s_waitcnt vmcnt(15)
    v_mfma_f32_16x16x32_bf16 v[236:239], v[92:95], v[124:127], v[236:239]
    v_mfma_f32_16x16x32_bf16 v[240:243], v[96:99], v[124:127], v[240:243]
    v_mfma_f32_16x16x32_bf16 v[244:247], v[100:103], v[124:127], v[244:247]
    v_mfma_f32_16x16x32_bf16 v[248:251], v[104:107], v[124:127], v[248:251]
    v_mfma_f32_16x16x32_bf16 v[252:255], v[108:111], v[124:127], v[252:255]
    s_add_u32 s80, s13, s4
    s_add_u32 s4, s4, 4096
    s_cmp_eq_u32 s4, 53248
    s_cselect_b32 s4, 0, s4
    buffer_load_dwordx4 v[124:127], v0, s[56:59], s80 offen sc1
    s_waitcnt vmcnt(15)
    s_waitcnt lgkmcnt(8)
    v_mfma_f32_16x16x32_bf16 v[176:179], v[12:15], v[128:131], v[176:179]
    s_waitcnt lgkmcnt(6)
    v_mfma_f32_16x16x32_bf16 v[180:183], v[16:19], v[128:131], v[180:183]
    s_waitcnt lgkmcnt(4)
    v_mfma_f32_16x16x32_bf16 v[184:187], v[20:23], v[128:131], v[184:187]
    s_waitcnt lgkmcnt(2)
    v_mfma_f32_16x16x32_bf16 v[188:191], v[24:27], v[128:131], v[188:191]
    s_waitcnt lgkmcnt(0)
    v_mfma_f32_16x16x32_bf16 v[192:195], v[28:31], v[128:131], v[192:195]
    s_add_u32 s80, s8, s4
    buffer_load_dwordx4 v[128:131], v0, s[56:59], s80 offen sc1
    s_waitcnt vmcnt(15)
    v_mfma_f32_16x16x32_bf16 v[196:199], v[12:15], v[132:135], v[196:199]
    ds_read_b64_tr_b16 v[32:33], v2 offset:20480
    v_mfma_f32_16x16x32_bf16 v[200:203], v[16:19], v[132:135], v[200:203]
    ds_read_b64_tr_b16 v[34:35], v2 offset:21760
    v_mfma_f32_16x16x32_bf16 v[204:207], v[20:23], v[132:135], v[204:207]
    ds_read_b64_tr_b16 v[36:37], v2 offset:20512
    v_mfma_f32_16x16x32_bf16 v[208:211], v[24:27], v[132:135], v[208:211]
    ds_read_b64_tr_b16 v[38:39], v2 offset:21792
    v_mfma_f32_16x16x32_bf16 v[212:215], v[28:31], v[132:135], v[212:215]
    ds_read_b64_tr_b16 v[40:41], v2 offset:20544
    s_add_u32 s80, s9, s4
    buffer_load_dwordx4 v[132:135], v0, s[56:59], s80 offen sc1
    s_waitcnt vmcnt(15)
    v_mfma_f32_16x16x32_bf16 v[216:219], v[12:15], v[136:139], v[216:219]
    ds_read_b64_tr_b16 v[42:43], v2 offset:21824
    v_mfma_f32_16x16x32_bf16 v[220:223], v[16:19], v[136:139], v[220:223]
    ds_read_b64_tr_b16 v[44:45], v2 offset:20576
    v_mfma_f32_16x16x32_bf16 v[224:227], v[20:23], v[136:139], v[224:227]
    ds_read_b64_tr_b16 v[46:47], v2 offset:21856
    v_mfma_f32_16x16x32_bf16 v[228:231], v[24:27], v[136:139], v[228:231]
    ds_read_b64_tr_b16 v[48:49], v2 offset:20608
    v_mfma_f32_16x16x32_bf16 v[232:235], v[28:31], v[136:139], v[232:235]
    ds_read_b64_tr_b16 v[50:51], v2 offset:21888
    s_add_u32 s80, s12, s4
    buffer_load_dwordx4 v[136:139], v0, s[56:59], s80 offen sc1
    s_waitcnt vmcnt(15)
    v_mfma_f32_16x16x32_bf16 v[236:239], v[12:15], v[140:143], v[236:239]
    v_mfma_f32_16x16x32_bf16 v[240:243], v[16:19], v[140:143], v[240:243]
    v_mfma_f32_16x16x32_bf16 v[244:247], v[20:23], v[140:143], v[244:247]
    v_mfma_f32_16x16x32_bf16 v[248:251], v[24:27], v[140:143], v[248:251]
    v_mfma_f32_16x16x32_bf16 v[252:255], v[28:31], v[140:143], v[252:255]
    s_add_u32 s80, s13, s4
    s_add_u32 s4, s4, 4096
    s_cmp_eq_u32 s4, 53248
    s_cselect_b32 s4, 0, s4
    buffer_load_dwordx4 v[140:143], v0, s[56:59], s80 offen sc1
    s_waitcnt vmcnt(15)
    s_waitcnt lgkmcnt(8)
    v_mfma_f32_16x16x32_bf16 v[176:179], v[32:35], v[144:147], v[176:179]
    s_waitcnt lgkmcnt(6)
    v_mfma_f32_16x16x32_bf16 v[180:183], v[36:39], v[144:147], v[180:183]
    s_waitcnt lgkmcnt(4)
    v_mfma_f32_16x16x32_bf16 v[184:187], v[40:43], v[144:147], v[184:187]
    s_waitcnt lgkmcnt(2)
    v_mfma_f32_16x16x32_bf16 v[188:191], v[44:47], v[144:147], v[188:191]
    s_waitcnt lgkmcnt(0)
    v_mfma_f32_16x16x32_bf16 v[192:195], v[48:51], v[144:147], v[192:195]
    s_add_u32 s80, s8, s4
    buffer_load_dwordx4 v[144:147], v0, s[56:59], s80 offen sc1
    s_waitcnt vmcnt(15)
    v_mfma_f32_16x16x32_bf16 v[196:199], v[32:35], v[148:151], v[196:199]
    ds_read_b64_tr_b16 v[12:13], v2 offset:40960
    v_mfma_f32_16x16x32_bf16 v[200:203], v[36:39], v[148:151], v[200:203]
    ds_read_b64_tr_b16 v[14:15], v2 offset:42240
    v_mfma_f32_16x16x32_bf16 v[204:207], v[40:43], v[148:151], v[204:207]
    ds_read_b64_tr_b16 v[16:17], v2 offset:40992
    v_mfma_f32_16x16x32_bf16 v[208:211], v[44:47], v[148:151], v[208:211]
    ds_read_b64_tr_b16 v[18:19], v2 offset:42272
    v_mfma_f32_16x16x32_bf16 v[212:215], v[48:51], v[148:151], v[212:215]
    ds_read_b64_tr_b16 v[20:21], v2 offset:41024
    s_add_u32 s80, s9, s4
    buffer_load_dwordx4 v[148:151], v0, s[56:59], s80 offen sc1
    s_waitcnt vmcnt(15)
    v_mfma_f32_16x16x32_bf16 v[216:219], v[32:35], v[152:155], v[216:219]
    ds_read_b64_tr_b16 v[22:23], v2 offset:42304
    v_mfma_f32_16x16x32_bf16 v[220:223], v[36:39], v[152:155], v[220:223]
    ds_read_b64_tr_b16 v[24:25], v2 offset:41056
    v_mfma_f32_16x16x32_bf16 v[224:227], v[40:43], v[152:155], v[224:227]
    ds_read_b64_tr_b16 v[26:27], v2 offset:42336
    v_mfma_f32_16x16x32_bf16 v[228:231], v[44:47], v[152:155], v[228:231]
    ds_read_b64_tr_b16 v[28:29], v2 offset:41088
    v_mfma_f32_16x16x32_bf16 v[232:235], v[48:51], v[152:155], v[232:235]
    ds_read_b64_tr_b16 v[30:31], v2 offset:42368
    s_add_u32 s80, s12, s4
    buffer_load_dwordx4 v[152:155], v0, s[56:59], s80 offen sc1
    s_waitcnt vmcnt(15)
    v_mfma_f32_16x16x32_bf16 v[236:239], v[32:35], v[156:159], v[236:239]
    v_mfma_f32_16x16x32_bf16 v[240:243], v[36:39], v[156:159], v[240:243]
    v_mfma_f32_16x16x32_bf16 v[244:247], v[40:43], v[156:159], v[244:247]
    v_mfma_f32_16x16x32_bf16 v[248:251], v[44:47], v[156:159], v[248:251]
    v_mfma_f32_16x16x32_bf16 v[252:255], v[48:51], v[156:159], v[252:255]
    s_add_u32 s80, s13, s4
    s_add_u32 s4, s4, 4096
    s_cmp_eq_u32 s4, 53248
    s_cselect_b32 s4, 0, s4
    buffer_load_dwordx4 v[156:159], v0, s[56:59], s80 offen sc1
    s_mov_b64 exec, s[34:35]
    s_add_u32 m0, s11, 0
    s_nop 0
    buffer_load_dwordx4 v4, s[60:63], s1 offen offset:0 sc1 lds
    buffer_load_dwordx4 v5, s[60:63], s1 offen offset:1024 sc1 lds
    buffer_load_dwordx4 v6, s[60:63], s1 offen offset:2048 sc1 lds
    buffer_load_dwordx4 v7, s[60:63], s1 offen offset:3072 sc1 lds
    s_add_u32 m0, s11, 4096
    s_nop 0
    buffer_load_dwordx4 v8, s[60:63], s1 offen offset:0 sc1 lds
    s_mov_b64 exec, -1
    s_waitcnt vmcnt(20)
    s_waitcnt lgkmcnt(8)
    v_mfma_f32_16x16x32_bf16 v[176:179], v[12:15], v[160:163], v[176:179]
    s_waitcnt lgkmcnt(6)
    v_mfma_f32_16x16x32_bf16 v[180:183], v[16:19], v[160:163], v[180:183]
    s_waitcnt lgkmcnt(4)
    v_mfma_f32_16x16x32_bf16 v[184:187], v[20:23], v[160:163], v[184:187]
    s_waitcnt lgkmcnt(2)
    v_mfma_f32_16x16x32_bf16 v[188:191], v[24:27], v[160:163], v[188:191]
    s_waitcnt lgkmcnt(0)
    v_mfma_f32_16x16x32_bf16 v[192:195], v[28:31], v[160:163], v[192:195]
    s_add_u32 s80, s8, s4
    buffer_load_dwordx4 v[160:163], v0, s[56:59], s80 offen sc1
    s_waitcnt vmcnt(20)
    v_mfma_f32_16x16x32_bf16 v[196:199], v[12:15], v[164:167], v[196:199]
    ds_read_b64_tr_b16 v[32:33], v2 offset:61440
    v_mfma_f32_16x16x32_bf16 v[200:203], v[16:19], v[164:167], v[200:203]
    ds_read_b64_tr_b16 v[34:35], v2 offset:62720
    v_mfma_f32_16x16x32_bf16 v[204:207], v[20:23], v[164:167], v[204:207]
    ds_read_b64_tr_b16 v[36:37], v2 offset:61472
    v_mfma_f32_16x16x32_bf16 v[208:211], v[24:27], v[164:167], v[208:211]
    ds_read_b64_tr_b16 v[38:39], v2 offset:62752
    v_mfma_f32_16x16x32_bf16 v[212:215], v[28:31], v[164:167], v[212:215]
    ds_read_b64_tr_b16 v[40:41], v2 offset:61504
    s_add_u32 s80, s9, s4
    buffer_load_dwordx4 v[164:167], v0, s[56:59], s80 offen sc1
    s_waitcnt vmcnt(20)
    v_mfma_f32_16x16x32_bf16 v[216:219], v[12:15], v[168:171], v[216:219]
    ds_read_b64_tr_b16 v[42:43], v2 offset:62784
    v_mfma_f32_16x16x32_bf16 v[220:223], v[16:19], v[168:171], v[220:223]
    ds_read_b64_tr_b16 v[44:45], v2 offset:61536
    v_mfma_f32_16x16x32_bf16 v[224:227], v[20:23], v[168:171], v[224:227]
    ds_read_b64_tr_b16 v[46:47], v2 offset:62816
    v_mfma_f32_16x16x32_bf16 v[228:231], v[24:27], v[168:171], v[228:231]
    ds_read_b64_tr_b16 v[48:49], v2 offset:61568
    v_mfma_f32_16x16x32_bf16 v[232:235], v[28:31], v[168:171], v[232:235]
    ds_read_b64_tr_b16 v[50:51], v2 offset:62848
    s_add_u32 s80, s12, s4
    buffer_load_dwordx4 v[168:171], v0, s[56:59], s80 offen sc1
    s_waitcnt vmcnt(20)
    v_mfma_f32_16x16x32_bf16 v[236:239], v[12:15], v[172:175], v[236:239]
    v_mfma_f32_16x16x32_bf16 v[240:243], v[16:19], v[172:175], v[240:243]
    v_mfma_f32_16x16x32_bf16 v[244:247], v[20:23], v[172:175], v[244:247]
    v_mfma_f32_16x16x32_bf16 v[248:251], v[24:27], v[172:175], v[248:251]
    v_mfma_f32_16x16x32_bf16 v[252:255], v[28:31], v[172:175], v[252:255]
    s_add_u32 s80, s13, s4
    s_add_u32 s4, s4, 4096
    s_cmp_eq_u32 s4, 53248
    s_cselect_b32 s4, 0, s4
    buffer_load_dwordx4 v[172:175], v0, s[56:59], s80 offen sc1
    v_add_u32 v10, s11, v0
    s_sub_u32 s81, s5, 1
    s_and_b32 s81, s81, 3
    s_mul_i32 s81, s81, 5120
    v_add_u32 v5, s81, v0
    s_sub_u32 s81, s5, 2
    s_and_b32 s81, s81, 3
    s_mul_i32 s81, s81, 5120
    v_add_u32 v6, s81, v0
    s_sub_u32 s81, s5, 3
    s_and_b32 s81, s81, 3
    s_mul_i32 s81, s81, 5120
    v_add_u32 v7, s81, v0
    s_mul_i32 s81, s5, 20480
    s_add_u32 s81, s81, 0x14000
    v_add_u32 v11, s81, v0
    s_waitcnt vmcnt(20)
    s_waitcnt lgkmcnt(8)
    v_mfma_f32_16x16x32_bf16 v[176:179], v[32:35], v[112:115], v[176:179]
    s_waitcnt lgkmcnt(6)
    v_mfma_f32_16x16x32_bf16 v[180:183], v[36:39], v[112:115], v[180:183]
    s_waitcnt lgkmcnt(4)
    v_mfma_f32_16x16x32_bf16 v[184:187], v[40:43], v[112:115], v[184:187]
    s_waitcnt lgkmcnt(2)
    v_mfma_f32_16x16x32_bf16 v[188:191], v[44:47], v[112:115], v[188:191]
    s_waitcnt lgkmcnt(0)
    v_mfma_f32_16x16x32_bf16 v[192:195], v[48:51], v[112:115], v[192:195]
    s_add_u32 s80, s8, s4
    buffer_load_dwordx4 v[112:115], v0, s[56:59], s80 offen sc1
    s_waitcnt vmcnt(20)
    v_mfma_f32_16x16x32_bf16 v[196:199], v[32:35], v[116:119], v[196:199]
    ds_read_b64_tr_b16 v[12:13], v3 offset:0
    v_mfma_f32_16x16x32_bf16 v[200:203], v[36:39], v[116:119], v[200:203]
    ds_read_b64_tr_b16 v[14:15], v3 offset:1280
    v_mfma_f32_16x16x32_bf16 v[204:207], v[40:43], v[116:119], v[204:207]
    ds_read_b64_tr_b16 v[16:17], v3 offset:32
    v_mfma_f32_16x16x32_bf16 v[208:211], v[44:47], v[116:119], v[208:211]
    ds_read_b64_tr_b16 v[18:19], v3 offset:1312
    v_mfma_f32_16x16x32_bf16 v[212:215], v[48:51], v[116:119], v[212:215]
    ds_read_b64_tr_b16 v[20:21], v3 offset:64
    s_add_u32 s80, s9, s4
    buffer_load_dwordx4 v[116:119], v0, s[56:59], s80 offen sc1
    s_waitcnt vmcnt(20)
    v_mfma_f32_16x16x32_bf16 v[216:219], v[32:35], v[120:123], v[216:219]
    ds_read_b64_tr_b16 v[22:23], v3 offset:1344
    v_mfma_f32_16x16x32_bf16 v[220:223], v[36:39], v[120:123], v[220:223]
    ds_read_b64_tr_b16 v[24:25], v3 offset:96
    v_mfma_f32_16x16x32_bf16 v[224:227], v[40:43], v[120:123], v[224:227]
    ds_read_b64_tr_b16 v[26:27], v3 offset:1376
    v_mfma_f32_16x16x32_bf16 v[228:231], v[44:47], v[120:123], v[228:231]
    ds_read_b64_tr_b16 v[28:29], v3 offset:128
    v_mfma_f32_16x16x32_bf16 v[232:235], v[48:51], v[120:123], v[232:235]
    ds_read_b64_tr_b16 v[30:31], v3 offset:1408
    s_add_u32 s80, s12, s4
    buffer_load_dwordx4 v[120:123], v0, s[56:59], s80 offen sc1
    s_waitcnt vmcnt(20)
    v_mfma_f32_16x16x32_bf16 v[236:239], v[32:35], v[124:127], v[236:239]
    v_mfma_f32_16x16x32_bf16 v[240:243], v[36:39], v[124:127], v[240:243]
    v_mfma_f32_16x16x32_bf16 v[244:247], v[40:43], v[124:127], v[244:247]
    v_mfma_f32_16x16x32_bf16 v[248:251], v[44:47], v[124:127], v[248:251]
    v_mfma_f32_16x16x32_bf16 v[252:255], v[48:51], v[124:127], v[252:255]
    s_add_u32 s80, s13, s4
    s_add_u32 s4, s4, 4096
    s_cmp_eq_u32 s4, 53248
    s_cselect_b32 s4, 0, s4
    buffer_load_dwordx4 v[124:127], v0, s[56:59], s80 offen sc1
    s_lshl_b32 s81, s7, 2
    s_add_u32 s81, s81, s5
    s_lshl_b32 s81, s81, 4
    v_and_b32 v8, 15, v1
    v_add_u32 v8, s81, v8
    v_mul_u32_u24 v8, 640, v8
    v_lshrrev_b32 v9, 4, v1
    v_lshl_add_u32 v8, v9, 2, v8
    s_mul_i32 s81, s6, 80
    v_add_u32 v8, s81, v8
    v_lshlrev_b32 v9, 2, v8
    s_add_u32 s81, s11, 0xf000
    v_lshl_add_u32 v8, v1, 2, s81
    s_waitcnt vmcnt(20)
    s_waitcnt lgkmcnt(8)
    v_mfma_f32_16x16x32_bf16 v[176:179], v[12:15], v[128:131], v[176:179]
    s_waitcnt lgkmcnt(6)
    v_mfma_f32_16x16x32_bf16 v[180:183], v[16:19], v[128:131], v[180:183]
    s_waitcnt lgkmcnt(4)
    v_mfma_f32_16x16x32_bf16 v[184:187], v[20:23], v[128:131], v[184:187]
    s_waitcnt lgkmcnt(2)
    v_mfma_f32_16x16x32_bf16 v[188:191], v[24:27], v[128:131], v[188:191]
    s_waitcnt lgkmcnt(0)
    v_mfma_f32_16x16x32_bf16 v[192:195], v[28:31], v[128:131], v[192:195]
    s_add_u32 s80, s8, s0
    s_mov_b64 exec, s[34:35]
    buffer_load_dwordx4 v[128:131], v0, s[56:59], s80 offen sc1
    s_mov_b64 exec, -1
    s_waitcnt vmcnt(20)
    v_mfma_f32_16x16x32_bf16 v[196:199], v[12:15], v[132:135], v[196:199]
    ds_read_b64_tr_b16 v[32:33], v3 offset:20480
    v_mfma_f32_16x16x32_bf16 v[200:203], v[16:19], v[132:135], v[200:203]
    ds_read_b64_tr_b16 v[34:35], v3 offset:21760
    v_mfma_f32_16x16x32_bf16 v[204:207], v[20:23], v[132:135], v[204:207]
    ds_read_b64_tr_b16 v[36:37], v3 offset:20512
    v_mfma_f32_16x16x32_bf16 v[208:211], v[24:27], v[132:135], v[208:211]
    ds_read_b64_tr_b16 v[38:39], v3 offset:21792
    v_mfma_f32_16x16x32_bf16 v[212:215], v[28:31], v[132:135], v[212:215]
    ds_read_b64_tr_b16 v[40:41], v3 offset:20544
    s_add_u32 s80, s9, s0
    s_mov_b64 exec, s[34:35]
    buffer_load_dwordx4 v[132:135], v0, s[56:59], s80 offen sc1
    s_mov_b64 exec, -1
    s_waitcnt vmcnt(20)
    v_mfma_f32_16x16x32_bf16 v[216:219], v[12:15], v[136:139], v[216:219]
    ds_read_b64_tr_b16 v[42:43], v3 offset:21824
    v_mfma_f32_16x16x32_bf16 v[220:223], v[16:19], v[136:139], v[220:223]
    ds_read_b64_tr_b16 v[44:45], v3 offset:20576
    v_mfma_f32_16x16x32_bf16 v[224:227], v[20:23], v[136:139], v[224:227]
    ds_read_b64_tr_b16 v[46:47], v3 offset:21856
    v_mfma_f32_16x16x32_bf16 v[228:231], v[24:27], v[136:139], v[228:231]
    ds_read_b64_tr_b16 v[48:49], v3 offset:20608
    v_mfma_f32_16x16x32_bf16 v[232:235], v[28:31], v[136:139], v[232:235]
    ds_read_b64_tr_b16 v[50:51], v3 offset:21888
    s_add_u32 s80, s12, s0
    s_mov_b64 exec, s[34:35]
    buffer_load_dwordx4 v[136:139], v0, s[56:59], s80 offen sc1
    s_mov_b64 exec, -1
    s_waitcnt vmcnt(20)
    v_mfma_f32_16x16x32_bf16 v[236:239], v[12:15], v[140:143], v[236:239]
    v_mfma_f32_16x16x32_bf16 v[240:243], v[16:19], v[140:143], v[240:243]
    v_mfma_f32_16x16x32_bf16 v[244:247], v[20:23], v[140:143], v[244:247]
    v_mfma_f32_16x16x32_bf16 v[248:251], v[24:27], v[140:143], v[248:251]
    v_mfma_f32_16x16x32_bf16 v[252:255], v[28:31], v[140:143], v[252:255]
    s_add_u32 s80, s13, s0
    s_mov_b64 exec, s[34:35]
    buffer_load_dwordx4 v[140:143], v0, s[56:59], s80 offen sc1
    s_mov_b64 exec, -1
    s_waitcnt vmcnt(20)
    s_waitcnt lgkmcnt(8)
    v_mfma_f32_16x16x32_bf16 v[176:179], v[32:35], v[144:147], v[176:179]
    s_waitcnt lgkmcnt(6)
    v_mfma_f32_16x16x32_bf16 v[180:183], v[36:39], v[144:147], v[180:183]
    s_waitcnt lgkmcnt(4)
    v_mfma_f32_16x16x32_bf16 v[184:187], v[40:43], v[144:147], v[184:187]
    s_waitcnt lgkmcnt(2)
    v_mfma_f32_16x16x32_bf16 v[188:191], v[44:47], v[144:147], v[188:191]
    s_waitcnt lgkmcnt(0)
    v_mfma_f32_16x16x32_bf16 v[192:195], v[48:51], v[144:147], v[192:195]
    s_waitcnt vmcnt(19)
    v_mfma_f32_16x16x32_bf16 v[196:199], v[32:35], v[148:151], v[196:199]
    ds_read_b64_tr_b16 v[12:13], v3 offset:40960
    v_mfma_f32_16x16x32_bf16 v[200:203], v[36:39], v[148:151], v[200:203]
    ds_read_b64_tr_b16 v[14:15], v3 offset:42240
    v_mfma_f32_16x16x32_bf16 v[204:207], v[40:43], v[148:151], v[204:207]
    ds_read_b64_tr_b16 v[16:17], v3 offset:40992
    v_mfma_f32_16x16x32_bf16 v[208:211], v[44:47], v[148:151], v[208:211]
    ds_read_b64_tr_b16 v[18:19], v3 offset:42272
    v_mfma_f32_16x16x32_bf16 v[212:215], v[48:51], v[148:151], v[212:215]
    ds_read_b64_tr_b16 v[20:21], v3 offset:41024
    s_waitcnt vmcnt(18)
    v_mfma_f32_16x16x32_bf16 v[216:219], v[32:35], v[152:155], v[216:219]
    ds_read_b64_tr_b16 v[22:23], v3 offset:42304
    v_mfma_f32_16x16x32_bf16 v[220:223], v[36:39], v[152:155], v[220:223]
    ds_read_b64_tr_b16 v[24:25], v3 offset:41056
    v_mfma_f32_16x16x32_bf16 v[224:227], v[40:43], v[152:155], v[224:227]
    ds_read_b64_tr_b16 v[26:27], v3 offset:42336
    v_mfma_f32_16x16x32_bf16 v[228:231], v[44:47], v[152:155], v[228:231]
    ds_read_b64_tr_b16 v[28:29], v3 offset:41088
    v_mfma_f32_16x16x32_bf16 v[232:235], v[48:51], v[152:155], v[232:235]
    ds_read_b64_tr_b16 v[30:31], v3 offset:42368
    s_waitcnt vmcnt(17)
    v_mfma_f32_16x16x32_bf16 v[236:239], v[32:35], v[156:159], v[236:239]
    v_mfma_f32_16x16x32_bf16 v[240:243], v[36:39], v[156:159], v[240:243]
    v_mfma_f32_16x16x32_bf16 v[244:247], v[40:43], v[156:159], v[244:247]
    v_mfma_f32_16x16x32_bf16 v[248:251], v[44:47], v[156:159], v[248:251]
    v_mfma_f32_16x16x32_bf16 v[252:255], v[48:51], v[156:159], v[252:255]
    s_waitcnt vmcnt(11)
    s_waitcnt lgkmcnt(8)
    v_mfma_f32_16x16x32_bf16 v[176:179], v[12:15], v[160:163], v[176:179]
    s_waitcnt lgkmcnt(6)
    v_mfma_f32_16x16x32_bf16 v[180:183], v[16:19], v[160:163], v[180:183]
    s_waitcnt lgkmcnt(4)
    v_mfma_f32_16x16x32_bf16 v[184:187], v[20:23], v[160:163], v[184:187]
    s_waitcnt lgkmcnt(2)
    v_mfma_f32_16x16x32_bf16 v[188:191], v[24:27], v[160:163], v[188:191]
    s_waitcnt lgkmcnt(0)
    v_mfma_f32_16x16x32_bf16 v[192:195], v[28:31], v[160:163], v[192:195]
    s_waitcnt vmcnt(10)
    v_mfma_f32_16x16x32_bf16 v[196:199], v[12:15], v[164:167], v[196:199]
    ds_read_b64_tr_b16 v[32:33], v3 offset:61440
    v_mfma_f32_16x16x32_bf16 v[200:203], v[16:19], v[164:167], v[200:203]
    ds_read_b64_tr_b16 v[34:35], v3 offset:62720
    v_mfma_f32_16x16x32_bf16 v[204:207], v[20:23], v[164:167], v[204:207]
    ds_read_b64_tr_b16 v[36:37], v3 offset:61472
    v_mfma_f32_16x16x32_bf16 v[208:211], v[24:27], v[164:167], v[208:211]
    ds_read_b64_tr_b16 v[38:39], v3 offset:62752
    v_mfma_f32_16x16x32_bf16 v[212:215], v[28:31], v[164:167], v[212:215]
    ds_read_b64_tr_b16 v[40:41], v3 offset:61504
    s_waitcnt vmcnt(9)
    v_mfma_f32_16x16x32_bf16 v[216:219], v[12:15], v[168:171], v[216:219]
    ds_read_b64_tr_b16 v[42:43], v3 offset:62784
    v_mfma_f32_16x16x32_bf16 v[220:223], v[16:19], v[168:171], v[220:223]
    ds_read_b64_tr_b16 v[44:45], v3 offset:61536
    v_mfma_f32_16x16x32_bf16 v[224:227], v[20:23], v[168:171], v[224:227]
    ds_read_b64_tr_b16 v[46:47], v3 offset:62816
    v_mfma_f32_16x16x32_bf16 v[228:231], v[24:27], v[168:171], v[228:231]
    ds_read_b64_tr_b16 v[48:49], v3 offset:61568
    v_mfma_f32_16x16x32_bf16 v[232:235], v[28:31], v[168:171], v[232:235]
    ds_read_b64_tr_b16 v[50:51], v3 offset:62848
    s_waitcnt vmcnt(8)
    v_mfma_f32_16x16x32_bf16 v[236:239], v[12:15], v[172:175], v[236:239]
    v_mfma_f32_16x16x32_bf16 v[240:243], v[16:19], v[172:175], v[240:243]
    v_mfma_f32_16x16x32_bf16 v[244:247], v[20:23], v[172:175], v[244:247]
    v_mfma_f32_16x16x32_bf16 v[248:251], v[24:27], v[172:175], v[248:251]
    v_mfma_f32_16x16x32_bf16 v[252:255], v[28:31], v[172:175], v[252:255]
    s_waitcnt vmcnt(7)
    s_waitcnt lgkmcnt(8)
    v_mfma_f32_16x16x32_bf16 v[176:179], v[32:35], v[112:115], v[176:179]
    s_waitcnt lgkmcnt(6)
    v_mfma_f32_16x16x32_bf16 v[180:183], v[36:39], v[112:115], v[180:183]
    s_waitcnt lgkmcnt(4)
    v_mfma_f32_16x16x32_bf16 v[184:187], v[40:43], v[112:115], v[184:187]
    s_waitcnt lgkmcnt(2)
    v_mfma_f32_16x16x32_bf16 v[188:191], v[44:47], v[112:115], v[188:191]
    s_waitcnt lgkmcnt(0)
    v_mfma_f32_16x16x32_bf16 v[192:195], v[48:51], v[112:115], v[192:195]
    s_waitcnt vmcnt(6)
    v_mfma_f32_16x16x32_bf16 v[196:199], v[32:35], v[116:119], v[196:199]
    ds_read_b64_tr_b16 v[12:13], v2 offset:0
    v_mfma_f32_16x16x32_bf16 v[200:203], v[36:39], v[116:119], v[200:203]
    ds_read_b64_tr_b16 v[14:15], v2 offset:1280
    v_mfma_f32_16x16x32_bf16 v[204:207], v[40:43], v[116:119], v[204:207]
    ds_read_b64_tr_b16 v[16:17], v2 offset:32
    v_mfma_f32_16x16x32_bf16 v[208:211], v[44:47], v[116:119], v[208:211]
    ds_read_b64_tr_b16 v[18:19], v2 offset:1312
    v_mfma_f32_16x16x32_bf16 v[212:215], v[48:51], v[116:119], v[212:215]
    ds_read_b64_tr_b16 v[20:21], v2 offset:64
    s_waitcnt vmcnt(5)
    v_mfma_f32_16x16x32_bf16 v[216:219], v[32:35], v[120:123], v[216:219]
    ds_read_b64_tr_b16 v[22:23], v2 offset:1344
    v_mfma_f32_16x16x32_bf16 v[220:223], v[36:39], v[120:123], v[220:223]
    ds_read_b64_tr_b16 v[24:25], v2 offset:96
    v_mfma_f32_16x16x32_bf16 v[224:227], v[40:43], v[120:123], v[224:227]
    ds_read_b64_tr_b16 v[26:27], v2 offset:1376
    v_mfma_f32_16x16x32_bf16 v[228:231], v[44:47], v[120:123], v[228:231]
    ds_read_b64_tr_b16 v[28:29], v2 offset:128
    v_mfma_f32_16x16x32_bf16 v[232:235], v[48:51], v[120:123], v[232:235]
    ds_read_b64_tr_b16 v[30:31], v2 offset:1408
    s_waitcnt vmcnt(4)
    v_mfma_f32_16x16x32_bf16 v[236:239], v[32:35], v[124:127], v[236:239]
    v_mfma_f32_16x16x32_bf16 v[240:243], v[36:39], v[124:127], v[240:243]
    v_mfma_f32_16x16x32_bf16 v[244:247], v[40:43], v[124:127], v[244:247]
    v_mfma_f32_16x16x32_bf16 v[248:251], v[44:47], v[124:127], v[248:251]
    v_mfma_f32_16x16x32_bf16 v[252:255], v[48:51], v[124:127], v[252:255]
    s_cmp_ge_u32 s5, 2
    s_cbranch_scc1 parallel_sum__ssm_conv_s5__glu_gated_bilinear__prompt_kernel_g_end
    s_waitcnt vmcnt(3)
    s_waitcnt lgkmcnt(8)
    v_mfma_f32_16x16x32_bf16 v[176:179], v[12:15], v[128:131], v[176:179]
    s_waitcnt lgkmcnt(6)
    v_mfma_f32_16x16x32_bf16 v[180:183], v[16:19], v[128:131], v[180:183]
    s_waitcnt lgkmcnt(4)
    v_mfma_f32_16x16x32_bf16 v[184:187], v[20:23], v[128:131], v[184:187]
    s_waitcnt lgkmcnt(2)
    v_mfma_f32_16x16x32_bf16 v[188:191], v[24:27], v[128:131], v[188:191]
    s_waitcnt lgkmcnt(0)
    v_mfma_f32_16x16x32_bf16 v[192:195], v[28:31], v[128:131], v[192:195]
    s_waitcnt vmcnt(2)
    v_mfma_f32_16x16x32_bf16 v[196:199], v[12:15], v[132:135], v[196:199]
    v_mfma_f32_16x16x32_bf16 v[200:203], v[16:19], v[132:135], v[200:203]
    v_mfma_f32_16x16x32_bf16 v[204:207], v[20:23], v[132:135], v[204:207]
    v_mfma_f32_16x16x32_bf16 v[208:211], v[24:27], v[132:135], v[208:211]
    v_mfma_f32_16x16x32_bf16 v[212:215], v[28:31], v[132:135], v[212:215]
    s_waitcnt vmcnt(1)
    v_mfma_f32_16x16x32_bf16 v[216:219], v[12:15], v[136:139], v[216:219]
    v_mfma_f32_16x16x32_bf16 v[220:223], v[16:19], v[136:139], v[220:223]
    v_mfma_f32_16x16x32_bf16 v[224:227], v[20:23], v[136:139], v[224:227]
    v_mfma_f32_16x16x32_bf16 v[228:231], v[24:27], v[136:139], v[228:231]
    v_mfma_f32_16x16x32_bf16 v[232:235], v[28:31], v[136:139], v[232:235]
    s_waitcnt vmcnt(0)
    v_mfma_f32_16x16x32_bf16 v[236:239], v[12:15], v[140:143], v[236:239]
    v_mfma_f32_16x16x32_bf16 v[240:243], v[16:19], v[140:143], v[240:243]
    v_mfma_f32_16x16x32_bf16 v[244:247], v[20:23], v[140:143], v[244:247]
    v_mfma_f32_16x16x32_bf16 v[248:251], v[24:27], v[140:143], v[248:251]
    v_mfma_f32_16x16x32_bf16 v[252:255], v[28:31], v[140:143], v[252:255]
parallel_sum__ssm_conv_s5__glu_gated_bilinear__prompt_kernel_g_end:
    s_nop 7
    ds_write_b128 v10, v[196:199] offset:0
    ds_write_b128 v10, v[200:203] offset:1024
    ds_write_b128 v10, v[204:207] offset:2048
    ds_write_b128 v10, v[208:211] offset:3072
    ds_write_b128 v10, v[212:215] offset:4096
    ds_write_b128 v10, v[216:219] offset:20480
    ds_write_b128 v10, v[220:223] offset:21504
    ds_write_b128 v10, v[224:227] offset:22528
    ds_write_b128 v10, v[228:231] offset:23552
    ds_write_b128 v10, v[232:235] offset:24576
    ds_write_b128 v10, v[236:239] offset:40960
    ds_write_b128 v10, v[240:243] offset:41984
    ds_write_b128 v10, v[244:247] offset:43008
    ds_write_b128 v10, v[248:251] offset:44032
    ds_write_b128 v10, v[252:255] offset:45056
    s_waitcnt vmcnt(0) lgkmcnt(0)
    s_barrier
    ds_read_b128 v[112:115], v5 offset:0
    ds_read_b128 v[116:119], v5 offset:1024
    ds_read_b128 v[120:123], v5 offset:2048
    ds_read_b128 v[124:127], v5 offset:3072
    ds_read_b128 v[128:131], v5 offset:4096
    ds_read_b128 v[132:135], v6 offset:20480
    ds_read_b128 v[136:139], v6 offset:21504
    ds_read_b128 v[140:143], v6 offset:22528
    ds_read_b128 v[144:147], v6 offset:23552
    ds_read_b128 v[148:151], v6 offset:24576
    ds_read_b128 v[152:155], v7 offset:40960
    ds_read_b128 v[156:159], v7 offset:41984
    ds_read_b128 v[160:163], v7 offset:43008
    ds_read_b128 v[164:167], v7 offset:44032
    ds_read_b128 v[168:171], v7 offset:45056
    s_waitcnt lgkmcnt(14)
    v_pk_add_f32 v[176:177], v[176:177], v[112:113]
    v_pk_add_f32 v[178:179], v[178:179], v[114:115]
    s_waitcnt lgkmcnt(13)
    v_pk_add_f32 v[180:181], v[180:181], v[116:117]
    v_pk_add_f32 v[182:183], v[182:183], v[118:119]
    s_waitcnt lgkmcnt(12)
    v_pk_add_f32 v[184:185], v[184:185], v[120:121]
    v_pk_add_f32 v[186:187], v[186:187], v[122:123]
    s_waitcnt lgkmcnt(11)
    v_pk_add_f32 v[188:189], v[188:189], v[124:125]
    v_pk_add_f32 v[190:191], v[190:191], v[126:127]
    s_waitcnt lgkmcnt(10)
    v_pk_add_f32 v[192:193], v[192:193], v[128:129]
    v_pk_add_f32 v[194:195], v[194:195], v[130:131]
    s_waitcnt lgkmcnt(9)
    v_pk_add_f32 v[176:177], v[176:177], v[132:133]
    v_pk_add_f32 v[178:179], v[178:179], v[134:135]
    s_waitcnt lgkmcnt(8)
    v_pk_add_f32 v[180:181], v[180:181], v[136:137]
    v_pk_add_f32 v[182:183], v[182:183], v[138:139]
    s_waitcnt lgkmcnt(7)
    v_pk_add_f32 v[184:185], v[184:185], v[140:141]
    v_pk_add_f32 v[186:187], v[186:187], v[142:143]
    s_waitcnt lgkmcnt(6)
    v_pk_add_f32 v[188:189], v[188:189], v[144:145]
    v_pk_add_f32 v[190:191], v[190:191], v[146:147]
    s_waitcnt lgkmcnt(5)
    v_pk_add_f32 v[192:193], v[192:193], v[148:149]
    v_pk_add_f32 v[194:195], v[194:195], v[150:151]
    s_waitcnt lgkmcnt(4)
    v_pk_add_f32 v[176:177], v[176:177], v[152:153]
    v_pk_add_f32 v[178:179], v[178:179], v[154:155]
    s_waitcnt lgkmcnt(3)
    v_pk_add_f32 v[180:181], v[180:181], v[156:157]
    v_pk_add_f32 v[182:183], v[182:183], v[158:159]
    s_waitcnt lgkmcnt(2)
    v_pk_add_f32 v[184:185], v[184:185], v[160:161]
    v_pk_add_f32 v[186:187], v[186:187], v[162:163]
    s_waitcnt lgkmcnt(1)
    v_pk_add_f32 v[188:189], v[188:189], v[164:165]
    v_pk_add_f32 v[190:191], v[190:191], v[166:167]
    s_waitcnt lgkmcnt(0)
    v_pk_add_f32 v[192:193], v[192:193], v[168:169]
    v_pk_add_f32 v[194:195], v[194:195], v[170:171]
    v_lshrrev_b32 v130, 4, v1
    v_bfe_u32 v131, v1, 1, 2
    v_add_u32 v130, v130, v131
    v_lshlrev_b32 v130, 4, v130
    v_and_b32 v131, 15, v1
    v_mul_u32_u24 v131, 320, v131
    v_add_u32 v130, v130, v131
    v_lshrrev_b32 v131, 4, v1
    v_bfe_u32 v132, v1, 1, 2
    v_add_u32 v131, v131, v132
    v_cmp_lt_u32 vcc, 3, v131
    v_mov_b32 v131, 0xffffffc0
    v_mov_b32 v132, 0x100
    v_cndmask_b32 v132, v132, v131, vcc
    s_sub_u32 s81, s5, 1
    s_and_b32 s81, s81, 3
    s_mul_i32 s81, s81, 5120
    v_add_u32 v130, s81, v130
    v_add_u32 v132, v132, v130
    ds_write_b128 v130, v[176:179] offset:0
    ds_write_b128 v130, v[180:183] offset:64
    ds_write_b128 v130, v[184:187] offset:128
    ds_write_b128 v130, v[188:191] offset:192
    ds_write_b128 v132, v[192:195] offset:0
    s_mov_b32 s82, 0xcccccccd
    s_lshl_b32 s81, s7, 2
    s_add_u32 s81, s81, s5
    s_mul_i32 s81, s81, 40960
    s_mul_i32 s80, s6, 320
    s_add_u32 s81, s81, s80
    s_add_u32 s80, s11, 0xf000
    v_add_u32 v133, 0, v1
    v_mul_hi_u32 v134, v133, s82
    v_lshrrev_b32 v134, 4, v134
    v_mul_u32_u24 v135, 20, v134
    v_sub_u32 v133, v133, v135
    v_bfe_u32 v135, v134, 1, 2
    v_sub_u32 v133, v133, v135
    v_add_u32 v135, 20, v133
    v_min_u32 v133, v133, v135
    v_lshl_add_u32 v120, v134, 2, s80
    v_mul_u32_u24 v134, 2560, v134
    v_lshl_add_u32 v134, v133, 4, v134
    v_add_u32 v125, s81, v134
    v_add_u32 v133, 64, v1
    v_mul_hi_u32 v134, v133, s82
    v_lshrrev_b32 v134, 4, v134
    v_mul_u32_u24 v135, 20, v134
    v_sub_u32 v133, v133, v135
    v_bfe_u32 v135, v134, 1, 2
    v_sub_u32 v133, v133, v135
    v_add_u32 v135, 20, v133
    v_min_u32 v133, v133, v135
    v_lshl_add_u32 v121, v134, 2, s80
    v_mul_u32_u24 v134, 2560, v134
    v_lshl_add_u32 v134, v133, 4, v134
    v_add_u32 v126, s81, v134
    v_add_u32 v133, 128, v1
    v_mul_hi_u32 v134, v133, s82
    v_lshrrev_b32 v134, 4, v134
    v_mul_u32_u24 v135, 20, v134
    v_sub_u32 v133, v133, v135
    v_bfe_u32 v135, v134, 1, 2
    v_sub_u32 v133, v133, v135
    v_add_u32 v135, 20, v133
    v_min_u32 v133, v133, v135
    v_lshl_add_u32 v122, v134, 2, s80
    v_mul_u32_u24 v134, 2560, v134
    v_lshl_add_u32 v134, v133, 4, v134
    v_add_u32 v127, s81, v134
    v_add_u32 v133, 192, v1
    v_mul_hi_u32 v134, v133, s82
    v_lshrrev_b32 v134, 4, v134
    v_mul_u32_u24 v135, 20, v134
    v_sub_u32 v133, v133, v135
    v_bfe_u32 v135, v134, 1, 2
    v_sub_u32 v133, v133, v135
    v_add_u32 v135, 20, v133
    v_min_u32 v133, v133, v135
    v_lshl_add_u32 v123, v134, 2, s80
    v_mul_u32_u24 v134, 2560, v134
    v_lshl_add_u32 v134, v133, 4, v134
    v_add_u32 v128, s81, v134
    v_add_u32 v133, 256, v1
    v_mul_hi_u32 v134, v133, s82
    v_lshrrev_b32 v134, 4, v134
    v_mul_u32_u24 v135, 20, v134
    v_sub_u32 v133, v133, v135
    v_bfe_u32 v135, v134, 1, 2
    v_sub_u32 v133, v133, v135
    v_add_u32 v135, 20, v133
    v_min_u32 v133, v133, v135
    v_lshl_add_u32 v124, v134, 2, s80
    v_mul_u32_u24 v134, 2560, v134
    v_lshl_add_u32 v134, v133, 4, v134
    v_add_u32 v129, s81, v134
    s_barrier
    ds_read_b32 v112, v120
    ds_read_b128 v[12:15], v5 offset:0
    ds_read_b128 v[16:19], v11 offset:0
    ds_read_b128 v[20:23], v11 offset:5120
    ds_read_b128 v[24:27], v11 offset:10240
    ds_read_b128 v[28:31], v11 offset:15360
    ds_read_b32 v114, v121
    ds_read_b128 v[32:35], v5 offset:1024
    ds_read_b128 v[36:39], v11 offset:1024
    ds_read_b128 v[40:43], v11 offset:6144
    ds_read_b128 v[44:47], v11 offset:11264
    ds_read_b128 v[48:51], v11 offset:16384
    ds_read_b32 v116, v122
    ds_read_b128 v[52:55], v5 offset:2048
    ds_read_b128 v[56:59], v11 offset:2048
    ds_read_b128 v[60:63], v11 offset:7168
    s_waitcnt lgkmcnt(13)
    v_pk_fma_f32 v[12:13], v[12:13], v[112:113], v[16:17] op_sel:[0,0,0] op_sel_hi:[1,0,1]
    v_pk_fma_f32 v[14:15], v[14:15], v[112:113], v[18:19] op_sel:[0,0,0] op_sel_hi:[1,0,1]
    ds_read_b128 v[64:67], v11 offset:12288
    s_waitcnt lgkmcnt(13)
    v_pk_add_f32 v[12:13], v[12:13], v[20:21]
    v_pk_add_f32 v[14:15], v[14:15], v[22:23]
    ds_read_b128 v[68:71], v11 offset:17408
    s_waitcnt lgkmcnt(13)
    v_pk_add_f32 v[12:13], v[12:13], v[24:25]
    v_pk_add_f32 v[14:15], v[14:15], v[26:27]
    ds_read_b32 v118, v123
    s_waitcnt lgkmcnt(13)
    v_pk_add_f32 v[12:13], v[12:13], v[28:29]
    v_pk_add_f32 v[14:15], v[14:15], v[30:31]
    buffer_store_dwordx4 v[12:15], v125, s[52:55], 0 offen sc1
    ds_read_b128 v[72:75], v5 offset:3072
    ds_read_b128 v[76:79], v11 offset:3072
    ds_read_b128 v[80:83], v11 offset:8192
    s_waitcnt lgkmcnt(13)
    v_pk_fma_f32 v[32:33], v[32:33], v[114:115], v[36:37] op_sel:[0,0,0] op_sel_hi:[1,0,1]
    v_pk_fma_f32 v[34:35], v[34:35], v[114:115], v[38:39] op_sel:[0,0,0] op_sel_hi:[1,0,1]
    ds_read_b128 v[84:87], v11 offset:13312
    s_waitcnt lgkmcnt(13)
    v_pk_add_f32 v[32:33], v[32:33], v[40:41]
    v_pk_add_f32 v[34:35], v[34:35], v[42:43]
    ds_read_b128 v[88:91], v11 offset:18432
    s_waitcnt lgkmcnt(13)
    v_pk_add_f32 v[32:33], v[32:33], v[44:45]
    v_pk_add_f32 v[34:35], v[34:35], v[46:47]
    ds_read_b32 v120, v124
    s_waitcnt lgkmcnt(13)
    v_pk_add_f32 v[32:33], v[32:33], v[48:49]
    v_pk_add_f32 v[34:35], v[34:35], v[50:51]
    buffer_store_dwordx4 v[32:35], v126, s[52:55], 0 offen sc1
    ds_read_b128 v[92:95], v5 offset:4096
    ds_read_b128 v[96:99], v11 offset:4096
    ds_read_b128 v[100:103], v11 offset:9216
    s_waitcnt lgkmcnt(13)
    v_pk_fma_f32 v[52:53], v[52:53], v[116:117], v[56:57] op_sel:[0,0,0] op_sel_hi:[1,0,1]
    v_pk_fma_f32 v[54:55], v[54:55], v[116:117], v[58:59] op_sel:[0,0,0] op_sel_hi:[1,0,1]
    ds_read_b128 v[104:107], v11 offset:14336
    s_waitcnt lgkmcnt(13)
    v_pk_add_f32 v[52:53], v[52:53], v[60:61]
    v_pk_add_f32 v[54:55], v[54:55], v[62:63]
    ds_read_b128 v[108:111], v11 offset:19456
    s_waitcnt lgkmcnt(13)
    v_pk_add_f32 v[52:53], v[52:53], v[64:65]
    v_pk_add_f32 v[54:55], v[54:55], v[66:67]
    s_waitcnt lgkmcnt(12)
    v_pk_add_f32 v[52:53], v[52:53], v[68:69]
    v_pk_add_f32 v[54:55], v[54:55], v[70:71]
    buffer_store_dwordx4 v[52:55], v127, s[52:55], 0 offen sc1
    s_waitcnt lgkmcnt(9)
    v_pk_fma_f32 v[72:73], v[72:73], v[118:119], v[76:77] op_sel:[0,0,0] op_sel_hi:[1,0,1]
    v_pk_fma_f32 v[74:75], v[74:75], v[118:119], v[78:79] op_sel:[0,0,0] op_sel_hi:[1,0,1]
    s_waitcnt lgkmcnt(8)
    v_pk_add_f32 v[72:73], v[72:73], v[80:81]
    v_pk_add_f32 v[74:75], v[74:75], v[82:83]
    s_waitcnt lgkmcnt(7)
    v_pk_add_f32 v[72:73], v[72:73], v[84:85]
    v_pk_add_f32 v[74:75], v[74:75], v[86:87]
    s_waitcnt lgkmcnt(6)
    v_pk_add_f32 v[72:73], v[72:73], v[88:89]
    v_pk_add_f32 v[74:75], v[74:75], v[90:91]
    buffer_store_dwordx4 v[72:75], v128, s[52:55], 0 offen sc1
    s_waitcnt lgkmcnt(3)
    v_pk_fma_f32 v[92:93], v[92:93], v[120:121], v[96:97] op_sel:[0,0,0] op_sel_hi:[1,0,1]
    v_pk_fma_f32 v[94:95], v[94:95], v[120:121], v[98:99] op_sel:[0,0,0] op_sel_hi:[1,0,1]
    s_waitcnt lgkmcnt(2)
    v_pk_add_f32 v[92:93], v[92:93], v[100:101]
    v_pk_add_f32 v[94:95], v[94:95], v[102:103]
    s_waitcnt lgkmcnt(1)
    v_pk_add_f32 v[92:93], v[92:93], v[104:105]
    v_pk_add_f32 v[94:95], v[94:95], v[106:107]
    s_waitcnt lgkmcnt(0)
    v_pk_add_f32 v[92:93], v[92:93], v[108:109]
    v_pk_add_f32 v[94:95], v[94:95], v[110:111]
    buffer_store_dwordx4 v[92:95], v129, s[52:55], 0 offen sc1
    s_endpgm
parallel_sum__ssm_conv_s5__glu_gated_bilinear__prompt_kernel_hglu:
    v_lshlrev_b32 v0, 4, v1
    s_mov_b32 s68, s40
    s_mov_b32 s69, s41
    s_mov_b32 s70, 0x21c000
    s_mov_b32 s71, 0x00020000
    s_add_u32 s1, s12, 128
    s_add_u32 m0, s13, 53376
    s_nop 0
    buffer_load_dwordx4 v232, s[48:51], s1 offen offset:0 lds
    buffer_load_dwordx4 v233, s[48:51], s1 offen offset:1024 lds
    buffer_load_dwordx4 v234, s[48:51], s1 offen offset:2048 lds
    buffer_load_dwordx4 v235, s[48:51], s1 offen offset:3072 lds
    s_add_u32 m0, s13, 57472
    s_nop 0
    buffer_load_dwordx4 v236, s[48:51], s1 offen offset:0 lds
    buffer_load_dwordx4 v237, s[48:51], s1 offen offset:1024 lds
    buffer_load_dwordx4 v238, s[48:51], s1 offen offset:2048 lds
    buffer_load_dwordx4 v239, s[48:51], s1 offen offset:3072 lds
    s_add_u32 s1, s101, 221184
    s_add_u32 m0, s100, 53376
    s_nop 0
    buffer_load_dwordx4 v240, s[52:55], s1 offen offset:0 lds
    buffer_load_dwordx4 v241, s[52:55], s1 offen offset:1024 lds
    buffer_load_dwordx4 v242, s[52:55], s1 offen offset:2048 lds
    buffer_load_dwordx4 v243, s[52:55], s1 offen offset:3072 lds
    s_add_u32 m0, s100, 57472
    s_nop 0
    buffer_load_dwordx4 v244, s[52:55], s1 offen offset:0 lds
    v_bfe_u32 v2, v1, 2, 2
    v_lshrrev_b32 v3, 4, v1
    v_lshl_add_u32 v2, v3, 2, v2
    v_mul_u32_u24 v2, 160, v2
    v_and_b32 v3, 3, v1
    v_lshl_add_u32 v2, v3, 3, v2
    s_and_b32 s80, s14, 1
    s_mul_i32 s80, s80, 10368
    s_lshr_b32 s81, s14, 1
    s_lshl_b32 s81, s81, 5
    s_add_u32 s80, s80, s81
    s_add_u32 s80, s80, 32768
    v_add_u32 v150, s80, v2
    v_add_u32 v151, 0xd080, v150
    v_add_u32 v152, 0x1a100, v150
    v_mov_b32 v153, 0x3f803f80
    v_mov_b32 v196, 0x3f803f80
    v_mov_b32 v197, 0x3f803f80
    v_mov_b32 v198, 0x3f803f80
    v_mov_b32 v199, 0x3f803f80
    v_mov_b32 v156, 0
    v_mov_b32 v157, 0
    v_mov_b32 v158, 0
    v_mov_b32 v159, 0
    v_mov_b32 v160, 0
    v_mov_b32 v161, 0
    v_mov_b32 v162, 0
    v_mov_b32 v163, 0
    v_mov_b32 v164, 0
    v_mov_b32 v165, 0
    v_mov_b32 v166, 0
    v_mov_b32 v167, 0
    s_mov_b32 s76, s44
    s_mov_b32 s77, s45
    s_mov_b32 s78, 0x100
    s_mov_b32 s79, 0x00020000
    v_mov_b32 v101, 0
    s_waitcnt vmcnt(13)
    s_barrier
    s_lshl_b32 s80, s2, 2
    s_add_u32 s80, s80, s14
    s_cmp_lg_u32 s80, 0
    s_cbranch_scc1 parallel_sum__ssm_conv_s5__glu_gated_bilinear__prompt_kernel_hg_nn
    s_memrealtime s[82:83]
    s_waitcnt lgkmcnt(0)
    s_or_b32 s82, s82, 1
    v_mov_b32 v2, s82
    s_mov_b64 exec, 1
    buffer_store_dword v2, v101, s[76:79], 0 offen sc1
    s_mov_b64 exec, -1
parallel_sum__ssm_conv_s5__glu_gated_bilinear__prompt_kernel_hg_nn:
    s_add_u32 s1, s12, 256
    s_add_u32 m0, s13, 106752
    s_nop 0
    buffer_load_dwordx4 v232, s[48:51], s1 offen offset:0 lds
    buffer_load_dwordx4 v233, s[48:51], s1 offen offset:1024 lds
    buffer_load_dwordx4 v234, s[48:51], s1 offen offset:2048 lds
    buffer_load_dwordx4 v235, s[48:51], s1 offen offset:3072 lds
    s_add_u32 m0, s13, 110848
    s_nop 0
    buffer_load_dwordx4 v236, s[48:51], s1 offen offset:0 lds
    buffer_load_dwordx4 v237, s[48:51], s1 offen offset:1024 lds
    buffer_load_dwordx4 v238, s[48:51], s1 offen offset:2048 lds
    buffer_load_dwordx4 v239, s[48:51], s1 offen offset:3072 lds
    s_add_u32 s1, s101, 442368
    s_add_u32 m0, s100, 106752
    s_nop 0
    buffer_load_dwordx4 v240, s[52:55], s1 offen offset:0 lds
    buffer_load_dwordx4 v241, s[52:55], s1 offen offset:1024 lds
    buffer_load_dwordx4 v242, s[52:55], s1 offen offset:2048 lds
    buffer_load_dwordx4 v243, s[52:55], s1 offen offset:3072 lds
    s_add_u32 m0, s100, 110848
    s_nop 0
    buffer_load_dwordx4 v244, s[52:55], s1 offen offset:0 lds
    s_cmp_lg_u32 s6, 0
    s_cbranch_scc1 cs_4
    ds_read_b64_tr_b16 v[172:173], v150 offset:0
    ds_read_b64_tr_b16 v[174:175], v150 offset:2560
    ds_read_b64_tr_b16 v[176:177], v150 offset:5120
    ds_read_b64_tr_b16 v[178:179], v150 offset:7680
    ds_read_b64_tr_b16 v[180:181], v150 offset:64
    ds_read_b64_tr_b16 v[182:183], v150 offset:2624
    ds_read_b64_tr_b16 v[184:185], v150 offset:5184
    ds_read_b64_tr_b16 v[186:187], v150 offset:7744
    ds_read_b64_tr_b16 v[188:189], v150 offset:128
    ds_read_b64_tr_b16 v[190:191], v150 offset:2688
    ds_read_b64_tr_b16 v[192:193], v150 offset:5248
    ds_read_b64_tr_b16 v[194:195], v150 offset:7808
    s_waitcnt lgkmcnt(0)
    v_mfma_f32_16x16x32_bf16 v[156:159], v[196:199], v[172:175], v[156:159]
    v_mfma_f32_16x16x32_bf16 v[160:163], v[196:199], v[180:183], v[160:163]
    v_mfma_f32_16x16x32_bf16 v[164:167], v[196:199], v[188:191], v[164:167]
    v_mfma_f32_16x16x32_bf16 v[156:159], v[196:199], v[176:179], v[156:159]
    v_mfma_f32_16x16x32_bf16 v[160:163], v[196:199], v[184:187], v[160:163]
    v_mfma_f32_16x16x32_bf16 v[164:167], v[196:199], v[192:195], v[164:167]
cs_4:
    v_lshlrev_b32 v248, 4, v1
    v_lshlrev_b32 v249, 4, v1
    v_lshlrev_b32 v250, 4, v1
    v_lshlrev_b32 v251, 4, v1
    v_add_u32 v252, 4096, v248
    s_mul_i32 s10, s6, 276480
    s_mul_i32 s11, s14, 5120
    s_add_u32 s10, s10, s11
    s_add_u32 s10, s10, 0x200000
    s_waitcnt vmcnt(13)
    s_barrier
    s_add_u32 s1, s12, 384
    s_add_u32 m0, s13, 0
    s_nop 0
    buffer_load_dwordx4 v232, s[48:51], s1 offen offset:0 lds
    buffer_load_dwordx4 v233, s[48:51], s1 offen offset:1024 lds
    buffer_load_dwordx4 v234, s[48:51], s1 offen offset:2048 lds
    buffer_load_dwordx4 v235, s[48:51], s1 offen offset:3072 lds
    s_add_u32 m0, s13, 4096
    s_nop 0
    buffer_load_dwordx4 v236, s[48:51], s1 offen offset:0 lds
    buffer_load_dwordx4 v237, s[48:51], s1 offen offset:1024 lds
    buffer_load_dwordx4 v238, s[48:51], s1 offen offset:2048 lds
    buffer_load_dwordx4 v239, s[48:51], s1 offen offset:3072 lds
    s_add_u32 s1, s101, 663552
    s_add_u32 m0, s100, 0
    s_nop 0
    buffer_load_dwordx4 v240, s[52:55], s1 offen offset:0 lds
    buffer_load_dwordx4 v241, s[52:55], s1 offen offset:1024 lds
    buffer_load_dwordx4 v242, s[52:55], s1 offen offset:2048 lds
    buffer_load_dwordx4 v243, s[52:55], s1 offen offset:3072 lds
    s_add_u32 m0, s100, 4096
    s_nop 0
    buffer_load_dwordx4 v244, s[52:55], s1 offen offset:0 lds
    s_cmp_lg_u32 s6, 1
    s_cbranch_scc1 cs_5
    ds_read_b64_tr_b16 v[172:173], v151 offset:0
    ds_read_b64_tr_b16 v[174:175], v151 offset:2560
    ds_read_b64_tr_b16 v[176:177], v151 offset:5120
    ds_read_b64_tr_b16 v[178:179], v151 offset:7680
    ds_read_b64_tr_b16 v[180:181], v151 offset:64
    ds_read_b64_tr_b16 v[182:183], v151 offset:2624
    ds_read_b64_tr_b16 v[184:185], v151 offset:5184
    ds_read_b64_tr_b16 v[186:187], v151 offset:7744
    ds_read_b64_tr_b16 v[188:189], v151 offset:128
    ds_read_b64_tr_b16 v[190:191], v151 offset:2688
    ds_read_b64_tr_b16 v[192:193], v151 offset:5248
    ds_read_b64_tr_b16 v[194:195], v151 offset:7808
    s_waitcnt lgkmcnt(0)
    v_mfma_f32_16x16x32_bf16 v[156:159], v[196:199], v[172:175], v[156:159]
    v_mfma_f32_16x16x32_bf16 v[160:163], v[196:199], v[180:183], v[160:163]
    v_mfma_f32_16x16x32_bf16 v[164:167], v[196:199], v[188:191], v[164:167]
    v_mfma_f32_16x16x32_bf16 v[156:159], v[196:199], v[176:179], v[156:159]
    v_mfma_f32_16x16x32_bf16 v[160:163], v[196:199], v[184:187], v[160:163]
    v_mfma_f32_16x16x32_bf16 v[164:167], v[196:199], v[192:195], v[164:167]
cs_5:
    s_lshl_b32 s80, s6, 8
    s_lshl_b32 s81, s7, 3
    s_add_u32 s80, s80, s81
    s_lshl_b32 s81, s14, 1
    s_add_u32 s80, s80, s81
    v_lshrrev_b32 v2, 5, v1
    v_add_u32 v100, s80, v2
    v_mul_u32_u24 v2, 1280, v100
    v_and_b32 v3, 31, v1
    v_lshl_add_u32 v104, v3, 3, v2
    buffer_load_dwordx2 v[136:137], v104, s[48:51], 0 offen offset:0
    buffer_load_dwordx2 v[138:139], v104, s[48:51], 0 offen offset:256
    buffer_load_dwordx2 v[140:141], v104, s[48:51], 0 offen offset:512
    buffer_load_dwordx2 v[142:143], v104, s[48:51], 0 offen offset:768
    buffer_load_dwordx2 v[144:145], v104, s[48:51], 0 offen offset:1024
    s_cmp_lt_u32 s7, 16
    s_cselect_b32 s72, s26, s28
    s_cselect_b32 s73, s27, s29
    s_mov_b32 s74, 0xc8000
    s_mov_b32 s75, 0x00020000
    v_and_b32 v7, 15, v1
    v_mul_u32_u24 v7, 1280, v7
    v_lshrrev_b32 v2, 4, v1
    v_lshl_add_u32 v7, v2, 4, v7
    s_and_b32 s80, s7, 7
    s_lshl_b32 s80, s80, 2
    s_add_u32 s80, s80, s14
    s_mul_i32 s8, s6, 102400
    s_bfe_u32 s81, s7, 0x10003
    s_lshl_b32 s81, s81, 7
    s_add_u32 s8, s8, s81
    s_lshl_b32 s0, s6, 2
    s_lshr_b32 s81, s7, 3
    s_add_u32 s0, s0, s81
    s_mul_i32 s0, s0, 50
    s_mul_i32 s81, s80, 0x3334
    s_lshr_b32 s81, s81, 16
    s_mul_i32 s82, s81, 5
    s_sub_u32 s82, s80, s82
    s_mul_i32 s82, s82, 20480
    s_add_u32 s82, s82, s8
    s_lshr_b32 s83, s81, 1
    s_lshl_b32 s83, s83, 8
    s_add_u32 s82, s82, s83
    s_and_b32 s83, s81, 1
    s_lshl_b32 s83, s83, 6
    s_add_u32 s82, s82, s83
    buffer_load_dwordx4 v[200:203], v7, s[72:75], s82 offen
    s_add_u32 s3, s0, s80
    s_lshl_b32 s3, s3, 10
    s_add_u32 s80, s80, 32
    s_cmp_lt_u32 s80, 50
    s_cselect_b64 s[34:35], -1, 0
    s_mov_b64 exec, s[34:35]
    s_mul_i32 s81, s80, 0x3334
    s_lshr_b32 s81, s81, 16
    s_mul_i32 s82, s81, 5
    s_sub_u32 s82, s80, s82
    s_mul_i32 s82, s82, 20480
    s_add_u32 s82, s82, s8
    s_lshr_b32 s83, s81, 1
    s_lshl_b32 s83, s83, 8
    s_add_u32 s82, s82, s83
    s_and_b32 s83, s81, 1
    s_lshl_b32 s83, s83, 6
    s_add_u32 s82, s82, s83
    buffer_load_dwordx4 v[204:207], v7, s[72:75], s82 offen
    s_add_u32 s4, s0, s80
    s_lshl_b32 s4, s4, 10
    s_mov_b64 exec, -1
    v_lshlrev_b32 v0, 4, v1
    s_and_b32 s80, s7, 7
    s_lshl_b32 s80, s80, 2
    s_add_u32 s80, s80, s14
    s_lshr_b32 s19, s7, 3
    s_mov_b32 s22, 0xcccccccd
    s_mul_i32 s23, s6, 276480
    s_add_u32 s23, s23, 0x200000
    s_mul_i32 s24, s6, 160
    s_mul_i32 s82, s80, 0x3334
    s_lshr_b32 s82, s82, 16
    s_mul_i32 s83, s82, 5
    s_sub_u32 s83, s80, s83
    s_lshl_b32 s82, s82, 2
    s_add_u32 s82, s82, s19
    s_lshl_b32 s81, s83, 6
    v_add_u32 v2, s81, v1
    v_mul_hi_u32 v3, v2, s22
    v_lshrrev_b32 v3, 3, v3
    v_mul_u32_u24 v4, 10, v3
    v_sub_u32 v2, v2, v4
    v_mul_u32_u24 v3, 1280, v3
    v_lshl_add_u32 v20, v2, 4, v3
    s_mul_i32 s16, s82, 5120
    s_add_u32 s16, s16, s23
    s_lshl_b32 s83, s83, 10
    s_add_u32 s16, s16, s83
    s_mul_i32 s82, s82, 40960
    s_add_u32 s82, s82, s24
    buffer_load_dwordx4 v[8:11], v20, s[68:71], s82 offen
    s_add_u32 s80, s80, 32
    s_mul_i32 s82, s80, 0x3334
    s_lshr_b32 s82, s82, 16
    s_mul_i32 s83, s82, 5
    s_sub_u32 s83, s80, s83
    s_lshl_b32 s82, s82, 2
    s_add_u32 s82, s82, s19
    s_lshl_b32 s81, s83, 6
    v_add_u32 v2, s81, v1
    v_mul_hi_u32 v3, v2, s22
    v_lshrrev_b32 v3, 3, v3
    v_mul_u32_u24 v4, 10, v3
    v_sub_u32 v2, v2, v4
    v_mul_u32_u24 v3, 1280, v3
    v_lshl_add_u32 v21, v2, 4, v3
    s_mul_i32 s17, s82, 5120
    s_add_u32 s17, s17, s23
    s_lshl_b32 s83, s83, 10
    s_add_u32 s17, s17, s83
    s_mul_i32 s82, s82, 40960
    s_add_u32 s82, s82, s24
    buffer_load_dwordx4 v[12:15], v21, s[68:71], s82 offen
    s_add_u32 s80, s80, 32
    s_mul_i32 s82, s80, 0x3334
    s_lshr_b32 s82, s82, 16
    s_mul_i32 s83, s82, 5
    s_sub_u32 s83, s80, s83
    s_lshl_b32 s82, s82, 2
    s_add_u32 s82, s82, s19
    s_lshl_b32 s81, s83, 6
    v_add_u32 v2, s81, v1
    v_mul_hi_u32 v3, v2, s22
    v_lshrrev_b32 v3, 3, v3
    v_mul_u32_u24 v4, 10, v3
    v_sub_u32 v2, v2, v4
    v_mul_u32_u24 v3, 1280, v3
    v_lshl_add_u32 v22, v2, 4, v3
    s_mul_i32 s18, s82, 5120
    s_add_u32 s18, s18, s23
    s_lshl_b32 s83, s83, 10
    s_add_u32 s18, s18, s83
    s_mul_i32 s82, s82, 40960
    s_add_u32 s82, s82, s24
    s_cmp_lt_u32 s19, 2
    s_cselect_b32 s81, 6, 1
    s_add_u32 s81, s81, 64
    s_cmp_lt_u32 s80, s81
    s_cselect_b64 s[20:21], -1, 0
    s_mov_b64 exec, s[20:21]
    buffer_load_dwordx4 v[16:19], v22, s[68:71], s82 offen
    s_mov_b64 exec, -1
    s_waitcnt vmcnt(23)
    s_barrier
    s_add_u32 s1, s12, 512
    s_add_u32 m0, s13, 53376
    s_nop 0
    buffer_load_dwordx4 v232, s[48:51], s1 offen offset:0 lds
    buffer_load_dwordx4 v233, s[48:51], s1 offen offset:1024 lds
    buffer_load_dwordx4 v234, s[48:51], s1 offen offset:2048 lds
    buffer_load_dwordx4 v235, s[48:51], s1 offen offset:3072 lds
    s_add_u32 m0, s13, 57472
    s_nop 0
    buffer_load_dwordx4 v236, s[48:51], s1 offen offset:0 lds
    buffer_load_dwordx4 v237, s[48:51], s1 offen offset:1024 lds
    buffer_load_dwordx4 v238, s[48:51], s1 offen offset:2048 lds
    buffer_load_dwordx4 v239, s[48:51], s1 offen offset:3072 lds
    s_add_u32 s1, s101, 884736
    s_add_u32 m0, s100, 53376
    s_nop 0
    buffer_load_dwordx4 v240, s[52:55], s1 offen offset:0 lds
    buffer_load_dwordx4 v241, s[52:55], s1 offen offset:1024 lds
    buffer_load_dwordx4 v242, s[52:55], s1 offen offset:2048 lds
    buffer_load_dwordx4 v243, s[52:55], s1 offen offset:3072 lds
    s_add_u32 m0, s100, 57472
    s_nop 0
    buffer_load_dwordx4 v244, s[52:55], s1 offen offset:0 lds
    s_cmp_lg_u32 s6, 2
    s_cbranch_scc1 cs_6
    ds_read_b64_tr_b16 v[172:173], v152 offset:0
    ds_read_b64_tr_b16 v[174:175], v152 offset:2560
    ds_read_b64_tr_b16 v[176:177], v152 offset:5120
    ds_read_b64_tr_b16 v[178:179], v152 offset:7680
    ds_read_b64_tr_b16 v[180:181], v152 offset:64
    ds_read_b64_tr_b16 v[182:183], v152 offset:2624
    ds_read_b64_tr_b16 v[184:185], v152 offset:5184
    ds_read_b64_tr_b16 v[186:187], v152 offset:7744
    ds_read_b64_tr_b16 v[188:189], v152 offset:128
    ds_read_b64_tr_b16 v[190:191], v152 offset:2688
    ds_read_b64_tr_b16 v[192:193], v152 offset:5248
    ds_read_b64_tr_b16 v[194:195], v152 offset:7808
    s_waitcnt lgkmcnt(0)
    v_mfma_f32_16x16x32_bf16 v[156:159], v[196:199], v[172:175], v[156:159]
    v_mfma_f32_16x16x32_bf16 v[160:163], v[196:199], v[180:183], v[160:163]
    v_mfma_f32_16x16x32_bf16 v[164:167], v[196:199], v[188:191], v[164:167]
    v_mfma_f32_16x16x32_bf16 v[156:159], v[196:199], v[176:179], v[156:159]
    v_mfma_f32_16x16x32_bf16 v[160:163], v[196:199], v[184:187], v[160:163]
    v_mfma_f32_16x16x32_bf16 v[164:167], v[196:199], v[192:195], v[164:167]
cs_6:
    s_waitcnt vmcnt(23)
    s_barrier
    s_waitcnt vmcnt(13)
    buffer_store_dwordx4 v[8:11], v0, s[60:63], s16 offen sc1
    buffer_store_dwordx4 v[12:15], v0, s[60:63], s17 offen sc1
    s_mov_b64 exec, s[20:21]
    buffer_store_dwordx4 v[16:19], v0, s[60:63], s18 offen sc1
    s_mov_b64 exec, -1
    s_add_u32 s1, s12, 640
    s_add_u32 m0, s13, 106752
    s_nop 0
    buffer_load_dwordx4 v232, s[48:51], s1 offen offset:0 lds
    v_lshlrev_b32 v108, 16, v136
    v_and_b32 v109, 0xffff0000, v136
    v_lshlrev_b32 v110, 16, v137
    v_and_b32 v111, 0xffff0000, v137
    v_lshlrev_b32 v112, 16, v138
    v_and_b32 v113, 0xffff0000, v138
    v_lshlrev_b32 v114, 16, v139
    v_and_b32 v115, 0xffff0000, v139
    v_lshlrev_b32 v116, 16, v140
    v_and_b32 v117, 0xffff0000, v140
    buffer_load_dwordx4 v233, s[48:51], s1 offen offset:1024 lds
    v_lshlrev_b32 v118, 16, v141
    v_and_b32 v119, 0xffff0000, v141
    v_lshlrev_b32 v120, 16, v142
    v_and_b32 v121, 0xffff0000, v142
    v_lshlrev_b32 v122, 16, v143
    v_and_b32 v123, 0xffff0000, v143
    v_lshlrev_b32 v124, 16, v144
    v_and_b32 v125, 0xffff0000, v144
    v_lshlrev_b32 v126, 16, v145
    v_and_b32 v127, 0xffff0000, v145
    buffer_load_dwordx4 v234, s[48:51], s1 offen offset:2048 lds
    v_add_f32 v2, v108, v109
    v_add_f32 v3, v110, v111
    v_add_f32 v2, v2, v112
    v_add_f32 v3, v3, v113
    v_add_f32 v2, v2, v114
    v_add_f32 v3, v3, v115
    v_add_f32 v2, v2, v116
    v_add_f32 v3, v3, v117
    v_add_f32 v2, v2, v118
    v_add_f32 v3, v3, v119
    buffer_load_dwordx4 v235, s[48:51], s1 offen offset:3072 lds
    v_add_f32 v2, v2, v120
    v_add_f32 v3, v3, v121
    v_add_f32 v2, v2, v122
    v_add_f32 v3, v3, v123
    v_add_f32 v2, v2, v124
    v_add_f32 v3, v3, v125
    v_add_f32 v2, v2, v126
    v_add_f32 v3, v3, v127
    v_add_f32 v2, v2, v3
    s_nop 1
    s_add_u32 m0, s13, 110848
    s_nop 0
    buffer_load_dwordx4 v236, s[48:51], s1 offen offset:0 lds
    v_add_f32 v2, v2, v2 row_ror:8 row_mask:0xf bank_mask:0xf
    s_nop 1
    v_add_f32 v2, v2, v2 row_ror:4 row_mask:0xf bank_mask:0xf
    s_nop 1
    v_add_f32 v2, v2, v2 row_ror:2 row_mask:0xf bank_mask:0xf
    s_nop 1
    v_add_f32 v2, v2, v2 row_ror:1 row_mask:0xf bank_mask:0xf
    v_mov_b32 v4, v2
    s_nop 1
    v_permlane16_swap_b32 v2, v4
    buffer_load_dwordx4 v237, s[48:51], s1 offen offset:1024 lds
    s_nop 1
    v_add_f32 v2, v2, v4
    v_mul_f32 v2, 0x3acccccd, v2
    v_sub_f32 v108, v108, v2
    v_sub_f32 v109, v109, v2
    v_sub_f32 v110, v110, v2
    v_sub_f32 v111, v111, v2
    v_sub_f32 v112, v112, v2
    v_sub_f32 v113, v113, v2
    v_sub_f32 v114, v114, v2
    buffer_load_dwordx4 v238, s[48:51], s1 offen offset:2048 lds
    v_sub_f32 v115, v115, v2
    v_sub_f32 v116, v116, v2
    v_sub_f32 v117, v117, v2
    v_sub_f32 v118, v118, v2
    v_sub_f32 v119, v119, v2
    v_sub_f32 v120, v120, v2
    v_sub_f32 v121, v121, v2
    v_sub_f32 v122, v122, v2
    v_sub_f32 v123, v123, v2
    v_sub_f32 v124, v124, v2
    buffer_load_dwordx4 v239, s[48:51], s1 offen offset:3072 lds
    v_sub_f32 v125, v125, v2
    v_sub_f32 v126, v126, v2
    v_sub_f32 v127, v127, v2
    v_mul_f32 v3, v108, v108
    v_mul_f32 v4, v109, v109
    v_fmac_f32 v3, v110, v110
    v_fmac_f32 v4, v111, v111
    v_fmac_f32 v3, v112, v112
    v_fmac_f32 v4, v113, v113
    v_fmac_f32 v3, v114, v114
    s_add_u32 s1, s101, 1105920
    s_add_u32 m0, s100, 106752
    s_nop 0
    buffer_load_dwordx4 v240, s[52:55], s1 offen offset:0 lds
    v_fmac_f32 v4, v115, v115
    v_fmac_f32 v3, v116, v116
    v_fmac_f32 v4, v117, v117
    v_fmac_f32 v3, v118, v118
    v_fmac_f32 v4, v119, v119
    v_fmac_f32 v3, v120, v120
    v_fmac_f32 v4, v121, v121
    v_fmac_f32 v3, v122, v122
    v_fmac_f32 v4, v123, v123
    v_fmac_f32 v3, v124, v124
    buffer_load_dwordx4 v241, s[52:55], s1 offen offset:1024 lds
    v_fmac_f32 v4, v125, v125
    v_fmac_f32 v3, v126, v126
    v_fmac_f32 v4, v127, v127
    v_add_f32 v3, v3, v4
    s_nop 1
    v_add_f32 v3, v3, v3 row_ror:8 row_mask:0xf bank_mask:0xf
    s_nop 1
    v_add_f32 v3, v3, v3 row_ror:4 row_mask:0xf bank_mask:0xf
    s_nop 1
    v_add_f32 v3, v3, v3 row_ror:2 row_mask:0xf bank_mask:0xf
    buffer_load_dwordx4 v242, s[52:55], s1 offen offset:2048 lds
    s_nop 1
    v_add_f32 v3, v3, v3 row_ror:1 row_mask:0xf bank_mask:0xf
    v_mov_b32 v4, v3
    s_nop 1
    v_permlane16_swap_b32 v3, v4
    s_nop 1
    v_add_f32 v3, v3, v4
    v_mul_f32 v3, 0x3acccccd, v3
    v_cvt_pk_bf16_f32 v96, v2, v2
    v_lshlrev_b32 v96, 16, v96
    buffer_load_dwordx4 v243, s[52:55], s1 offen offset:3072 lds
    v_cvt_pk_bf16_f32 v3, v3, v3
    v_lshlrev_b32 v3, 16, v3
    v_add_f32 v3, 0x3727c5ac, v3
    v_cvt_pk_bf16_f32 v3, v3, v3
    v_lshlrev_b32 v3, 16, v3
    v_sqrt_f32 v3, v3
    s_nop 0
    v_cvt_pk_bf16_f32 v3, v3, v3
    v_lshlrev_b32 v3, 16, v3
    v_rcp_f32 v98, v3
    s_add_u32 m0, s100, 110848
    s_nop 0
    buffer_load_dwordx4 v244, s[52:55], s1 offen offset:0 lds
    s_cmp_lg_u32 s6, 3
    s_cbranch_scc1 cs_7
    ds_read_b64_tr_b16 v[172:173], v150 offset:0
    ds_read_b64_tr_b16 v[174:175], v150 offset:2560
    ds_read_b64_tr_b16 v[176:177], v150 offset:5120
    ds_read_b64_tr_b16 v[178:179], v150 offset:7680
    ds_read_b64_tr_b16 v[180:181], v150 offset:64
    ds_read_b64_tr_b16 v[182:183], v150 offset:2624
    ds_read_b64_tr_b16 v[184:185], v150 offset:5184
    ds_read_b64_tr_b16 v[186:187], v150 offset:7744
    ds_read_b64_tr_b16 v[188:189], v150 offset:128
    ds_read_b64_tr_b16 v[190:191], v150 offset:2688
    ds_read_b64_tr_b16 v[192:193], v150 offset:5248
    ds_read_b64_tr_b16 v[194:195], v150 offset:7808
    s_waitcnt lgkmcnt(0)
    v_mfma_f32_16x16x32_bf16 v[156:159], v[196:199], v[172:175], v[156:159]
    v_mfma_f32_16x16x32_bf16 v[160:163], v[196:199], v[180:183], v[160:163]
    v_mfma_f32_16x16x32_bf16 v[164:167], v[196:199], v[188:191], v[164:167]
    v_mfma_f32_16x16x32_bf16 v[156:159], v[196:199], v[176:179], v[156:159]
    v_mfma_f32_16x16x32_bf16 v[160:163], v[196:199], v[184:187], v[160:163]
    v_mfma_f32_16x16x32_bf16 v[164:167], v[196:199], v[192:195], v[164:167]
cs_7:
    buffer_load_dword v97, v101, s[76:79], 0 offen sc1
    s_waitcnt lgkmcnt(0)
    s_waitcnt vmcnt(17)
    s_barrier
    buffer_store_dwordx4 v[200:203], v0, s[60:63], s3 offen sc1
    s_mov_b64 exec, s[34:35]
    buffer_store_dwordx4 v[204:207], v0, s[60:63], s4 offen sc1
    s_mov_b64 exec, -1
    s_add_u32 s1, s12, 768
    s_add_u32 m0, s13, 0
    s_nop 0
    buffer_load_dwordx4 v232, s[48:51], s1 offen offset:0 lds
    buffer_load_dwordx4 v233, s[48:51], s1 offen offset:1024 lds
    buffer_load_dwordx4 v234, s[48:51], s1 offen offset:2048 lds
    buffer_load_dwordx4 v235, s[48:51], s1 offen offset:3072 lds
    s_add_u32 m0, s13, 4096
    s_nop 0
    buffer_load_dwordx4 v236, s[48:51], s1 offen offset:0 lds
    buffer_load_dwordx4 v237, s[48:51], s1 offen offset:1024 lds
    buffer_load_dwordx4 v238, s[48:51], s1 offen offset:2048 lds
    buffer_load_dwordx4 v239, s[48:51], s1 offen offset:3072 lds
    s_add_u32 s1, s101, 1327104
    s_add_u32 m0, s100, 0
    s_nop 0
    buffer_load_dwordx4 v240, s[52:55], s1 offen offset:0 lds
    buffer_load_dwordx4 v241, s[52:55], s1 offen offset:1024 lds
    buffer_load_dwordx4 v242, s[52:55], s1 offen offset:2048 lds
    buffer_load_dwordx4 v243, s[52:55], s1 offen offset:3072 lds
    s_add_u32 m0, s100, 4096
    s_nop 0
    buffer_load_dwordx4 v244, s[52:55], s1 offen offset:0 lds
    s_cmp_lg_u32 s6, 4
    s_cbranch_scc1 cs_8
    ds_read_b64_tr_b16 v[172:173], v151 offset:0
    ds_read_b64_tr_b16 v[174:175], v151 offset:2560
    ds_read_b64_tr_b16 v[176:177], v151 offset:5120
    ds_read_b64_tr_b16 v[178:179], v151 offset:7680
    ds_read_b64_tr_b16 v[180:181], v151 offset:64
    ds_read_b64_tr_b16 v[182:183], v151 offset:2624
    ds_read_b64_tr_b16 v[184:185], v151 offset:5184
    ds_read_b64_tr_b16 v[186:187], v151 offset:7744
    ds_read_b64_tr_b16 v[188:189], v151 offset:128
    ds_read_b64_tr_b16 v[190:191], v151 offset:2688
    ds_read_b64_tr_b16 v[192:193], v151 offset:5248
    ds_read_b64_tr_b16 v[194:195], v151 offset:7808
    s_waitcnt lgkmcnt(0)
    v_mfma_f32_16x16x32_bf16 v[156:159], v[196:199], v[172:175], v[156:159]
    v_mfma_f32_16x16x32_bf16 v[160:163], v[196:199], v[180:183], v[160:163]
    v_mfma_f32_16x16x32_bf16 v[164:167], v[196:199], v[188:191], v[164:167]
    v_mfma_f32_16x16x32_bf16 v[156:159], v[196:199], v[176:179], v[156:159]
    v_mfma_f32_16x16x32_bf16 v[160:163], v[196:199], v[184:187], v[160:163]
    v_mfma_f32_16x16x32_bf16 v[164:167], v[196:199], v[192:195], v[164:167]
cs_8:
    s_mov_b32 s72, s32
    s_mov_b32 s73, s33
    s_mov_b32 s74, 0x500
    s_mov_b32 s75, 0x00020000
    s_lshl_b32 s81, s7, 2
    s_add_u32 s81, s81, s14
    s_lshl_b32 s81, s81, 4
    v_and_b32 v7, 15, v1
    v_add_u32 v7, s81, v7
    v_lshrrev_b32 v246, 4, v1
    v_lshlrev_b32 v246, 2, v246
    s_mul_i32 s81, s6, 80
    v_add_u32 v246, s81, v246
    v_mul_u32_u24 v247, 640, v7
    v_add_u32 v247, v247, v246
    v_lshlrev_b32 v247, 1, v247
    v_lshlrev_b32 v246, 1, v246
    v_lshlrev_b32 v7, 4, v7
    s_waitcnt vmcnt(16)
    s_barrier
    s_waitcnt vmcnt(15)
    s_mov_b32 s80, 0
parallel_sum__ssm_conv_s5__glu_gated_bilinear__prompt_kernel_hg_np:
    v_readfirstlane_b32 s15, v97
    s_nop 3
    s_cmp_lg_u32 s15, 0
    s_cbranch_scc1 parallel_sum__ssm_conv_s5__glu_gated_bilinear__prompt_kernel_hg_np_ok
    s_add_u32 s80, s80, 1
    s_cmp_lt_u32 s80, 0x20000
    s_cbranch_scc0 parallel_sum__ssm_conv_s5__glu_gated_bilinear__prompt_kernel_hg_np_ok
    buffer_load_dword v97, v101, s[76:79], 0 offen sc1
    s_waitcnt vmcnt(0)
    s_branch parallel_sum__ssm_conv_s5__glu_gated_bilinear__prompt_kernel_hg_np
parallel_sum__ssm_conv_s5__glu_gated_bilinear__prompt_kernel_hg_np_ok:
    v_mov_b32 v2, 0x27fc0
    ds_write_b32 v2, v97
    s_waitcnt vmcnt(13)
    v_mov_b32 v99, v97
    v_lshlrev_b32 v3, 4, v100
    s_mov_b32 exec_lo, 1
    s_mov_b32 exec_hi, 1
    buffer_store_dwordx4 v[96:99], v3, s[64:67], 0 offen sc1
    s_mov_b64 exec, -1
    s_add_u32 s1, s12, 896
    s_add_u32 m0, s13, 53376
    s_nop 0
    buffer_load_dwordx4 v232, s[48:51], s1 offen offset:0 lds
    buffer_load_dwordx4 v233, s[48:51], s1 offen offset:1024 lds
    buffer_load_dwordx4 v234, s[48:51], s1 offen offset:2048 lds
    buffer_load_dwordx4 v235, s[48:51], s1 offen offset:3072 lds
    s_add_u32 m0, s13, 57472
    s_nop 0
    buffer_load_dwordx4 v236, s[48:51], s1 offen offset:0 lds
    buffer_load_dwordx4 v237, s[48:51], s1 offen offset:1024 lds
    buffer_load_dwordx4 v238, s[48:51], s1 offen offset:2048 lds
    buffer_load_dwordx4 v239, s[48:51], s1 offen offset:3072 lds
    s_add_u32 s1, s101, 1548288
    s_add_u32 m0, s100, 53376
    s_nop 0
    buffer_load_dwordx4 v240, s[52:55], s1 offen offset:0 lds
    buffer_load_dwordx4 v241, s[52:55], s1 offen offset:1024 lds
    buffer_load_dwordx4 v242, s[52:55], s1 offen offset:2048 lds
    buffer_load_dwordx4 v243, s[52:55], s1 offen offset:3072 lds
    s_add_u32 m0, s100, 57472
    s_nop 0
    buffer_load_dwordx4 v244, s[52:55], s1 offen offset:0 lds
    s_cmp_lg_u32 s6, 5
    s_cbranch_scc1 cs_9
    ds_read_b64_tr_b16 v[172:173], v152 offset:0
    ds_read_b64_tr_b16 v[174:175], v152 offset:2560
    ds_read_b64_tr_b16 v[176:177], v152 offset:5120
    ds_read_b64_tr_b16 v[178:179], v152 offset:7680
    ds_read_b64_tr_b16 v[180:181], v152 offset:64
    ds_read_b64_tr_b16 v[182:183], v152 offset:2624
    ds_read_b64_tr_b16 v[184:185], v152 offset:5184
    ds_read_b64_tr_b16 v[186:187], v152 offset:7744
    ds_read_b64_tr_b16 v[188:189], v152 offset:128
    ds_read_b64_tr_b16 v[190:191], v152 offset:2688
    ds_read_b64_tr_b16 v[192:193], v152 offset:5248
    ds_read_b64_tr_b16 v[194:195], v152 offset:7808
    s_waitcnt lgkmcnt(0)
    v_mfma_f32_16x16x32_bf16 v[156:159], v[196:199], v[172:175], v[156:159]
    v_mfma_f32_16x16x32_bf16 v[160:163], v[196:199], v[180:183], v[160:163]
    v_mfma_f32_16x16x32_bf16 v[164:167], v[196:199], v[188:191], v[164:167]
    v_mfma_f32_16x16x32_bf16 v[156:159], v[196:199], v[176:179], v[156:159]
    v_mfma_f32_16x16x32_bf16 v[160:163], v[196:199], v[184:187], v[160:163]
    v_mfma_f32_16x16x32_bf16 v[164:167], v[196:199], v[192:195], v[164:167]
cs_9:
    s_lshr_b32 s80, s2, 5
    s_bfe_u32 s81, s2, 0x20003
    s_mul_i32 s80, s80, 3
    s_lshr_b32 s4, s80, 1
    s_sub_u32 s80, s4, 13
    s_cmp_ge_u32 s4, 13
    s_cselect_b32 s4, s80, s4
    s_lshl_b32 s4, s4, 12
    s_lshl_b32 s3, s6, 2
    s_add_u32 s3, s3, s14
    s_mul_i32 s3, s3, 51200
    s_mov_b32 s80, 0
    s_sub_u32 s81, s80, 5
    s_cmp_ge_u32 s80, 5
    s_cselect_b32 s80, s81, s80
    s_sub_u32 s81, s80, 5
    s_cmp_ge_u32 s80, 5
    s_cselect_b32 s80, s81, s80
    s_lshl_b32 s16, s80, 12
    s_mul_i32 s21, s80, 10240
    s_add_u32 s21, s21, s3
    s_add_u32 s80, s80, 1
    s_cmp_eq_u32 s80, 5
    s_cselect_b32 s80, 0, s80
    s_lshl_b32 s17, s80, 12
    s_mul_i32 s22, s80, 10240
    s_add_u32 s22, s22, s3
    s_add_u32 s80, s80, 1
    s_cmp_eq_u32 s80, 5
    s_cselect_b32 s80, 0, s80
    s_lshl_b32 s18, s80, 12
    s_mul_i32 s23, s80, 10240
    s_add_u32 s23, s23, s3
    s_add_u32 s80, s80, 1
    s_cmp_eq_u32 s80, 5
    s_cselect_b32 s80, 0, s80
    s_lshl_b32 s19, s80, 12
    s_mul_i32 s24, s80, 10240
    s_add_u32 s24, s24, s3
    s_add_u32 s80, s80, 1
    s_cmp_eq_u32 s80, 5
    s_cselect_b32 s80, 0, s80
    s_lshl_b32 s20, s80, 12
    s_mul_i32 s25, s80, 10240
    s_add_u32 s25, s25, s3
    s_waitcnt lgkmcnt(0)
    s_waitcnt vmcnt(14)
    s_barrier
    s_add_u32 s1, s12, 1024
    s_add_u32 m0, s13, 106752
    s_nop 0
    buffer_load_dwordx4 v232, s[48:51], s1 offen offset:0 lds
    buffer_load_dwordx4 v233, s[48:51], s1 offen offset:1024 lds
    buffer_load_dwordx4 v234, s[48:51], s1 offen offset:2048 lds
    buffer_load_dwordx4 v235, s[48:51], s1 offen offset:3072 lds
    s_add_u32 m0, s13, 110848
    s_nop 0
    buffer_load_dwordx4 v236, s[48:51], s1 offen offset:0 lds
    buffer_load_dwordx4 v237, s[48:51], s1 offen offset:1024 lds
    buffer_load_dwordx4 v238, s[48:51], s1 offen offset:2048 lds
    buffer_load_dwordx4 v239, s[48:51], s1 offen offset:3072 lds
    s_add_u32 s1, s101, 1769472
    s_add_u32 m0, s100, 106752
    s_nop 0
    buffer_load_dwordx4 v240, s[52:55], s1 offen offset:0 lds
    buffer_load_dwordx4 v241, s[52:55], s1 offen offset:1024 lds
    buffer_load_dwordx4 v242, s[52:55], s1 offen offset:2048 lds
    buffer_load_dwordx4 v243, s[52:55], s1 offen offset:3072 lds
    s_add_u32 m0, s100, 110848
    s_nop 0
    buffer_load_dwordx4 v244, s[52:55], s1 offen offset:0 lds
    s_cmp_lg_u32 s6, 6
    s_cbranch_scc1 cs_10
    ds_read_b64_tr_b16 v[172:173], v150 offset:0
    ds_read_b64_tr_b16 v[174:175], v150 offset:2560
    ds_read_b64_tr_b16 v[176:177], v150 offset:5120
    ds_read_b64_tr_b16 v[178:179], v150 offset:7680
    ds_read_b64_tr_b16 v[180:181], v150 offset:64
    ds_read_b64_tr_b16 v[182:183], v150 offset:2624
    ds_read_b64_tr_b16 v[184:185], v150 offset:5184
    ds_read_b64_tr_b16 v[186:187], v150 offset:7744
    ds_read_b64_tr_b16 v[188:189], v150 offset:128
    ds_read_b64_tr_b16 v[190:191], v150 offset:2688
    ds_read_b64_tr_b16 v[192:193], v150 offset:5248
    ds_read_b64_tr_b16 v[194:195], v150 offset:7808
    s_waitcnt lgkmcnt(0)
    v_mfma_f32_16x16x32_bf16 v[156:159], v[196:199], v[172:175], v[156:159]
    v_mfma_f32_16x16x32_bf16 v[160:163], v[196:199], v[180:183], v[160:163]
    v_mfma_f32_16x16x32_bf16 v[164:167], v[196:199], v[188:191], v[164:167]
    v_mfma_f32_16x16x32_bf16 v[156:159], v[196:199], v[176:179], v[156:159]
    v_mfma_f32_16x16x32_bf16 v[160:163], v[196:199], v[184:187], v[160:163]
    v_mfma_f32_16x16x32_bf16 v[164:167], v[196:199], v[192:195], v[164:167]
cs_10:
    s_lshl_b32 s80, s7, 3
    s_add_u32 s80, s80, s6
    s_lshl_b32 s80, s80, 2
    s_add_u32 s80, s80, s14
    s_lshl_b32 s80, s80, 8
    s_add_u32 s80, s80, 0x10000
    s_nop 7
    s_nop 3
    v_mov_b32 v108, v156
    v_mov_b32 v109, v160
    v_mov_b32 v110, v164
    v_mov_b32 v111, s15
    s_mov_b64 exec, 0xffff
    buffer_store_dwordx4 v[108:111], v0, s[64:67], s80 offen sc1
    s_mov_b64 exec, -1
    s_waitcnt vmcnt(14)
    s_barrier
    s_lshl_b32 s80, s6, 8
    s_lshl_b32 s81, s14, 6
    s_add_u32 s80, s80, s81
    v_add_u32 v4, s80, v1
    v_lshlrev_b32 v4, 4, v4
    s_mul_i32 s9, s7, 20480
    s_add_u32 s9, s9, 0x10000
    s_mul_i32 s81, s14, 40
    v_min_u32 v5, 39, v1
    v_add_u32 v5, s81, v5
    v_lshlrev_b32 v6, 3, v5
    buffer_load_dwordx4 v[168:171], v4, s[64:67], 0 offen sc1
    buffer_load_dwordx4 v[228:231], v7, s[64:67], 0 offen sc1
    ds_read_b64_tr_b16 v[172:173], v151 offset:0
    ds_read_b64_tr_b16 v[174:175], v151 offset:2560
    ds_read_b64_tr_b16 v[176:177], v151 offset:5120
    ds_read_b64_tr_b16 v[178:179], v151 offset:7680
    ds_read_b64_tr_b16 v[180:181], v151 offset:64
    ds_read_b64_tr_b16 v[182:183], v151 offset:2624
    ds_read_b64_tr_b16 v[184:185], v151 offset:5184
    ds_read_b64_tr_b16 v[186:187], v151 offset:7744
    ds_read_b64_tr_b16 v[188:189], v151 offset:128
    ds_read_b64_tr_b16 v[190:191], v151 offset:2688
    ds_read_b64_tr_b16 v[192:193], v151 offset:5248
    ds_read_b64_tr_b16 v[194:195], v151 offset:7808
    s_add_u32 s1, s12, 1152
    s_add_u32 m0, s13, 0
    s_nop 0
    buffer_load_dwordx4 v232, s[48:51], s1 offen offset:0 lds
    buffer_load_dwordx4 v233, s[48:51], s1 offen offset:1024 lds
    buffer_load_dwordx4 v234, s[48:51], s1 offen offset:2048 lds
    s_waitcnt lgkmcnt(0)
    buffer_load_dwordx4 v235, s[48:51], s1 offen offset:3072 lds
    v_mfma_f32_16x16x32_bf16 v[156:159], v[196:199], v[172:175], 0
    s_add_u32 m0, s13, 4096
    s_nop 0
    buffer_load_dwordx4 v236, s[48:51], s1 offen offset:0 lds
    v_mfma_f32_16x16x32_bf16 v[160:163], v[196:199], v[180:183], 0
    buffer_load_dwordx4 v237, s[48:51], s1 offen offset:1024 lds
    v_mfma_f32_16x16x32_bf16 v[164:167], v[196:199], v[188:191], 0
    buffer_load_dwordx4 v238, s[48:51], s1 offen offset:2048 lds
    v_mfma_f32_16x16x32_bf16 v[156:159], v[196:199], v[176:179], v[156:159]
    buffer_load_dwordx4 v239, s[48:51], s1 offen offset:3072 lds
    v_mfma_f32_16x16x32_bf16 v[160:163], v[196:199], v[184:187], v[160:163]
    s_add_u32 s1, s101, 1990656
    s_add_u32 m0, s100, 0
    s_nop 0
    buffer_load_dwordx4 v240, s[52:55], s1 offen offset:0 lds
    v_mfma_f32_16x16x32_bf16 v[164:167], v[196:199], v[192:195], v[164:167]
    buffer_load_dwordx4 v241, s[52:55], s1 offen offset:1024 lds
    buffer_load_dwordx4 v242, s[52:55], s1 offen offset:2048 lds
    buffer_load_dwordx4 v243, s[52:55], s1 offen offset:3072 lds
    s_add_u32 m0, s100, 4096
    s_nop 0
    buffer_load_dwordx4 v244, s[52:55], s1 offen offset:0 lds
    s_add_u32 s80, s11, 0x0
    v_add_u32 v242, s80, v0
    s_add_u32 s80, s11, 0xa000
    v_add_u32 v243, s80, v0
    s_add_u32 s80, s11, 0x14000
    v_add_u32 v244, s80, v0
    s_add_u32 s80, s11, 0x1e000
    v_add_u32 v245, s80, v0
    s_waitcnt vmcnt(16)
    s_barrier
    s_lshl_b32 s95, s7, 13
    s_lshl_b32 s81, s14, 8
    s_add_u32 s95, s95, s81
    s_add_u32 s95, s95, 0x10000
    s_add_u32 s98, s95, 4096
    v_lshrrev_b32 v2, 4, v1
    v_lshlrev_b32 v2, 10, v2
    v_and_b32 v3, 15, v1
    v_lshl_add_u32 v116, v3, 4, v2
    buffer_load_dwordx4 v[108:111], v116, s[64:67], s95 offen offset:0 sc1
    buffer_load_dwordx4 v[112:115], v116, s[64:67], s98 offen offset:0 sc1
    s_mov_b32 s80, 0
    s_waitcnt vmcnt(15)
parallel_sum__ssm_conv_s5__glu_gated_bilinear__prompt_kernel_hg_gp:
    v_xor_b32 v2, s15, v169
    v_xor_b32 v3, s15, v171
    v_or_b32 v2, v2, v3
    v_xor_b32 v3, s15, v229
    v_or_b32 v2, v2, v3
    v_xor_b32 v3, s15, v231
    v_or_b32 v2, v2, v3
    v_cmp_ne_u32 vcc, 0, v2
    s_cmp_eq_u64 vcc, 0
    s_cbranch_scc1 parallel_sum__ssm_conv_s5__glu_gated_bilinear__prompt_kernel_hg_gp_ok
    s_add_u32 s80, s80, 1
    s_cmp_lt_u32 s80, 0x20000
    s_cbranch_scc0 parallel_sum__ssm_conv_s5__glu_gated_bilinear__prompt_kernel_hg_gp_ok
    s_sleep 2
    buffer_load_dwordx4 v[168:171], v4, s[64:67], 0 offen sc1
    buffer_load_dwordx4 v[228:231], v7, s[64:67], 0 offen sc1
    s_waitcnt vmcnt(0)
    s_branch parallel_sum__ssm_conv_s5__glu_gated_bilinear__prompt_kernel_hg_gp
parallel_sum__ssm_conv_s5__glu_gated_bilinear__prompt_kernel_hg_gp_ok:
    ds_read_b64_tr_b16 v[172:173], v152 offset:0
    ds_read_b64_tr_b16 v[174:175], v152 offset:2560
    ds_read_b64_tr_b16 v[176:177], v152 offset:5120
    ds_read_b64_tr_b16 v[178:179], v152 offset:7680
    ds_read_b64_tr_b16 v[180:181], v152 offset:64
    ds_read_b64_tr_b16 v[182:183], v152 offset:2624
    ds_read_b64_tr_b16 v[184:185], v152 offset:5184
    ds_read_b64_tr_b16 v[186:187], v152 offset:7744
    ds_read_b64_tr_b16 v[188:189], v152 offset:128
    ds_read_b64_tr_b16 v[190:191], v152 offset:2688
    ds_read_b64_tr_b16 v[192:193], v152 offset:5248
    ds_read_b64_tr_b16 v[194:195], v152 offset:7808
    s_add_u32 s82, s4, 0
    s_sub_u32 s83, s82, 53248
    s_cmp_ge_u32 s82, 53248
    s_cselect_b32 s82, s83, s82
    s_mul_i32 s82, s82, 5
    s_add_u32 s82, s82, s10
    s_add_u32 m0, s11, 61440
    s_nop 0
    buffer_load_dwordx4 v248, s[60:63], s82 offen offset:0 sc1 lds
    buffer_load_dwordx4 v249, s[60:63], s82 offen offset:1024 sc1 lds
    buffer_load_dwordx4 v250, s[60:63], s82 offen offset:2048 sc1 lds
    buffer_load_dwordx4 v251, s[60:63], s82 offen offset:3072 sc1 lds
    s_add_u32 m0, s11, 65536
    s_nop 0
    buffer_load_dwordx4 v252, s[60:63], s82 offen offset:0 sc1 lds
    s_add_u32 s82, s4, 4096
    s_sub_u32 s83, s82, 53248
    s_cmp_ge_u32 s82, 53248
    s_cselect_b32 s82, s83, s82
    s_mul_i32 s82, s82, 5
    s_add_u32 s82, s82, s10
    s_add_u32 m0, s11, 81920
    s_nop 0
    buffer_load_dwordx4 v248, s[60:63], s82 offen offset:0 sc1 lds
    buffer_load_dwordx4 v249, s[60:63], s82 offen offset:1024 sc1 lds
    buffer_load_dwordx4 v250, s[60:63], s82 offen offset:2048 sc1 lds
    buffer_load_dwordx4 v251, s[60:63], s82 offen offset:3072 sc1 lds
    s_add_u32 m0, s11, 86016
    s_nop 0
    buffer_load_dwordx4 v252, s[60:63], s82 offen offset:0 sc1 lds
    s_add_u32 s80, s21, 0
    buffer_load_dwordx4 v[8:11], v0, s[60:63], s80 offen offset:0 sc1
    buffer_load_dwordx4 v[12:15], v0, s[60:63], s80 offen offset:1024 sc1
    buffer_load_dwordx4 v[16:19], v0, s[60:63], s80 offen offset:2048 sc1
    buffer_load_dwordx4 v[20:23], v0, s[60:63], s80 offen offset:3072 sc1
    s_add_u32 s80, s21, 4096
    buffer_load_dwordx4 v[24:27], v0, s[60:63], s80 offen offset:0 sc1
    s_add_u32 s80, s21, 4096
    buffer_load_dwordx4 v[28:31], v0, s[60:63], s80 offen offset:1024 sc1
    buffer_load_dwordx4 v[32:35], v0, s[60:63], s80 offen offset:2048 sc1
    buffer_load_dwordx4 v[36:39], v0, s[60:63], s80 offen offset:3072 sc1
    s_add_u32 s80, s21, 8192
    buffer_load_dwordx4 v[40:43], v0, s[60:63], s80 offen offset:0 sc1
    buffer_load_dwordx4 v[44:47], v0, s[60:63], s80 offen offset:1024 sc1
    s_waitcnt lgkmcnt(0)
    v_mfma_f32_16x16x32_bf16 v[156:159], v[196:199], v[172:175], v[156:159]
    v_mfma_f32_16x16x32_bf16 v[160:163], v[196:199], v[180:183], v[160:163]
    v_mfma_f32_16x16x32_bf16 v[164:167], v[196:199], v[188:191], v[164:167]
    v_mfma_f32_16x16x32_bf16 v[156:159], v[196:199], v[176:179], v[156:159]
    v_mfma_f32_16x16x32_bf16 v[160:163], v[196:199], v[184:187], v[160:163]
    v_mfma_f32_16x16x32_bf16 v[164:167], v[196:199], v[192:195], v[164:167]
    s_lshl_b32 s81, s14, 6
    v_add_u32 v5, s81, v1
    v_lshlrev_b32 v5, 3, v5
    v_add_u32 v5, 0xd080, v5
    v_mov_b32 v169, v170
    ds_write_b64 v5, v[168:169]
    s_waitcnt lgkmcnt(0)
    s_waitcnt vmcnt(22)
    s_barrier
    ds_read_b64_tr_b16 v[172:173], v150 offset:0
    ds_read_b64_tr_b16 v[174:175], v150 offset:2560
    ds_read_b64_tr_b16 v[176:177], v150 offset:5120
    ds_read_b64_tr_b16 v[178:179], v150 offset:7680
    ds_read_b64_tr_b16 v[180:181], v150 offset:64
    ds_read_b64_tr_b16 v[182:183], v150 offset:2624
    ds_read_b64_tr_b16 v[184:185], v150 offset:5184
    ds_read_b64_tr_b16 v[186:187], v150 offset:7744
    ds_read_b64_tr_b16 v[188:189], v150 offset:128
    ds_read_b64_tr_b16 v[190:191], v150 offset:2688
    ds_read_b64_tr_b16 v[192:193], v150 offset:5248
    ds_read_b64_tr_b16 v[194:195], v150 offset:7808
    s_add_u32 s82, s4, 8192
    s_sub_u32 s83, s82, 53248
    s_cmp_ge_u32 s82, 53248
    s_cselect_b32 s82, s83, s82
    s_mul_i32 s82, s82, 5
    s_add_u32 s82, s82, s10
    s_add_u32 m0, s11, 102400
    s_nop 0
    buffer_load_dwordx4 v248, s[60:63], s82 offen offset:0 sc1 lds
    buffer_load_dwordx4 v249, s[60:63], s82 offen offset:1024 sc1 lds
    buffer_load_dwordx4 v250, s[60:63], s82 offen offset:2048 sc1 lds
    buffer_load_dwordx4 v251, s[60:63], s82 offen offset:3072 sc1 lds
    s_add_u32 m0, s11, 106496
    s_nop 0
    buffer_load_dwordx4 v252, s[60:63], s82 offen offset:0 sc1 lds
    s_add_u32 s82, s4, 12288
    s_sub_u32 s83, s82, 53248
    s_cmp_ge_u32 s82, 53248
    s_cselect_b32 s82, s83, s82
    s_mul_i32 s82, s82, 5
    s_add_u32 s82, s82, s10
    s_add_u32 m0, s11, 122880
    s_nop 0
    buffer_load_dwordx4 v248, s[60:63], s82 offen offset:0 sc1 lds
    buffer_load_dwordx4 v249, s[60:63], s82 offen offset:1024 sc1 lds
    buffer_load_dwordx4 v250, s[60:63], s82 offen offset:2048 sc1 lds
    buffer_load_dwordx4 v251, s[60:63], s82 offen offset:3072 sc1 lds
    s_add_u32 m0, s11, 126976
    s_nop 0
    buffer_load_dwordx4 v252, s[60:63], s82 offen offset:0 sc1 lds
    s_waitcnt lgkmcnt(0)
    v_mfma_f32_16x16x32_bf16 v[156:159], v[196:199], v[172:175], v[156:159]
    v_mfma_f32_16x16x32_bf16 v[160:163], v[196:199], v[180:183], v[160:163]
    v_mfma_f32_16x16x32_bf16 v[164:167], v[196:199], v[188:191], v[164:167]
    v_mfma_f32_16x16x32_bf16 v[156:159], v[196:199], v[176:179], v[156:159]
    v_mfma_f32_16x16x32_bf16 v[160:163], v[196:199], v[184:187], v[160:163]
    v_mfma_f32_16x16x32_bf16 v[164:167], v[196:199], v[192:195], v[164:167]
    s_nop 2
    s_mov_b32 s80, 0
    s_waitcnt vmcnt(30)
parallel_sum__ssm_conv_s5__glu_gated_bilinear__prompt_kernel_hg_g2:
    v_xor_b32 v2, s15, v111
    v_xor_b32 v3, s15, v115
    v_or_b32 v2, v2, v3
    v_cmp_ne_u32 vcc, 0, v2
    s_cmp_eq_u64 vcc, 0
    s_cbranch_scc1 parallel_sum__ssm_conv_s5__glu_gated_bilinear__prompt_kernel_hg_g2_ok
    s_add_u32 s80, s80, 1
    s_cmp_lt_u32 s80, 0x20000
    s_cbranch_scc0 parallel_sum__ssm_conv_s5__glu_gated_bilinear__prompt_kernel_hg_g2_ok
    s_sleep 1
    buffer_load_dwordx4 v[108:111], v116, s[64:67], s95 offen offset:0 sc1
    buffer_load_dwordx4 v[112:115], v116, s[64:67], s98 offen offset:0 sc1
    s_waitcnt vmcnt(0)
    s_branch parallel_sum__ssm_conv_s5__glu_gated_bilinear__prompt_kernel_hg_g2
parallel_sum__ssm_conv_s5__glu_gated_bilinear__prompt_kernel_hg_g2_ok:
    v_add_f32 v146, v108, v112
    v_add_f32 v147, v109, v113
    v_add_f32 v148, v110, v114
    v_mov_b32 v196, v146
    v_mov_b32 v197, v147
    v_mov_b32 v198, v148
    s_nop 1
    v_permlane16_swap_b32 v146, v196
    v_permlane16_swap_b32 v147, v197
    v_permlane16_swap_b32 v148, v198
    s_nop 1
    v_add_f32 v146, v146, v196
    v_add_f32 v147, v147, v197
    v_add_f32 v148, v148, v198
    v_mov_b32 v196, v146
    v_mov_b32 v197, v147
    v_mov_b32 v198, v148
    s_nop 1
    v_permlane32_swap_b32 v146, v196
    v_permlane32_swap_b32 v147, v197
    v_permlane32_swap_b32 v148, v198
    s_nop 1
    v_add_f32 v146, v146, v196
    v_add_f32 v147, v147, v197
    v_add_f32 v148, v148, v198
    v_add_f32 v146, v146, v156
    v_add_f32 v147, v147, v160
    v_add_f32 v148, v148, v164
    s_and_b32 s80, s14, 1
    s_mul_i32 s80, s80, 320
    s_lshr_b32 s81, s14, 1
    s_lshl_b32 s81, s81, 6
    s_add_u32 s80, s80, s81
    s_add_u32 s80, s80, 0xd880
    v_lshl_add_u32 v196, v1, 2, s80
    s_mov_b64 exec, 0xffff
    ds_write_b32 v196, v146 offset:0
    ds_write_b32 v196, v147 offset:128
    s_cmp_lt_u32 s14, 2
    s_cselect_b64 exec, exec, 0
    ds_write_b32 v196, v148 offset:256
    s_mov_b64 exec, -1
    s_waitcnt lgkmcnt(0)
    s_barrier
    s_add_u32 s82, s4, 16384
    s_sub_u32 s83, s82, 53248
    s_cmp_ge_u32 s82, 53248
    s_cselect_b32 s82, s83, s82
    s_mul_i32 s82, s82, 5
    s_add_u32 s82, s82, s10
    s_add_u32 m0, s11, 143360
    s_nop 0
    buffer_load_dwordx4 v248, s[60:63], s82 offen offset:0 sc1 lds
    buffer_load_dwordx4 v249, s[60:63], s82 offen offset:1024 sc1 lds
    buffer_load_dwordx4 v250, s[60:63], s82 offen offset:2048 sc1 lds
    buffer_load_dwordx4 v251, s[60:63], s82 offen offset:3072 sc1 lds
    s_add_u32 m0, s11, 147456
    s_nop 0
    buffer_load_dwordx4 v252, s[60:63], s82 offen offset:0 sc1 lds
    buffer_load_dwordx2 v[208:209], v247, s[48:51], 0 offen offset:0
    buffer_load_dwordx2 v[218:219], v246, s[72:75], 0 offen offset:0
    buffer_load_dwordx2 v[210:211], v247, s[48:51], 0 offen offset:32
    buffer_load_dwordx2 v[220:221], v246, s[72:75], 0 offen offset:32
    buffer_load_dwordx2 v[212:213], v247, s[48:51], 0 offen offset:64
    buffer_load_dwordx2 v[222:223], v246, s[72:75], 0 offen offset:64
    buffer_load_dwordx2 v[214:215], v247, s[48:51], 0 offen offset:96
    buffer_load_dwordx2 v[224:225], v246, s[72:75], 0 offen offset:96
    buffer_load_dwordx2 v[216:217], v247, s[48:51], 0 offen offset:128
    buffer_load_dwordx2 v[226:227], v246, s[72:75], 0 offen offset:128
    v_and_b32 v2, 31, v1
    v_lshlrev_b32 v2, 2, v2
    s_lshl_b32 s9, s7, 8
    s_add_u32 s9, s9, 0xe0000
    s_lshl_b32 s0, s7, 2
    s_mul_i32 s0, s0, 96256
    s_lshr_b32 s80, s14, 1
    s_mul_i32 s80, s80, 20480
    s_add_u32 s0, s0, s80
    s_and_b32 s80, s14, 1
    s_lshl_b32 s81, s80, 11
    s_add_u32 s0, s0, s81
    v_lshrrev_b32 v3, 4, v1
    v_bfe_u32 v4, v1, 1, 2
    v_add_u32 v3, v3, v4
    v_lshlrev_b32 v3, 4, v3
    v_and_b32 v4, 15, v1
    v_mul_u32_u24 v4, 320, v4
    v_add_u32 v3, v3, v4
    s_add_u32 s80, s11, 0x14000
    v_add_u32 v3, s80, v3
    s_add_u32 s81, s14, 0
    s_and_b32 s81, s81, 3
    s_mul_i32 s80, s81, 96256
    s_add_u32 s8, s0, s80
    s_mul_i32 s80, s81, 20480
    v_add_u32 v4, s80, v3
    s_add_u32 s81, s14, 1
    s_and_b32 s81, s81, 3
    s_mul_i32 s80, s81, 96256
    s_add_u32 s12, s0, s80
    s_mul_i32 s80, s81, 20480
    v_add_u32 v5, s80, v3
    s_add_u32 s81, s14, 2
    s_and_b32 s81, s81, 3
    s_mul_i32 s80, s81, 96256
    s_add_u32 s13, s0, s80
    s_mul_i32 s80, s81, 20480
    v_add_u32 v6, s80, v3
    s_add_u32 s81, s14, 3
    s_and_b32 s81, s81, 3
    s_mul_i32 s80, s81, 96256
    s_add_u32 s100, s0, s80
    s_mul_i32 s80, s81, 20480
    v_add_u32 v7, s80, v3
    s_waitcnt lgkmcnt(0)
    s_waitcnt vmcnt(10)
    s_barrier
    s_add_u32 s82, s4, 20480
    s_sub_u32 s83, s82, 53248
    s_cmp_ge_u32 s82, 53248
    s_cselect_b32 s82, s83, s82
    s_mul_i32 s82, s82, 5
    s_add_u32 s82, s82, s10
    s_add_u32 m0, s11, 0
    s_nop 0
    buffer_load_dwordx4 v248, s[60:63], s82 offen offset:0 sc1 lds
    buffer_load_dwordx4 v249, s[60:63], s82 offen offset:1024 sc1 lds
    buffer_load_dwordx4 v250, s[60:63], s82 offen offset:2048 sc1 lds
    buffer_load_dwordx4 v251, s[60:63], s82 offen offset:3072 sc1 lds
    s_add_u32 m0, s11, 4096
    s_nop 0
    buffer_load_dwordx4 v252, s[60:63], s82 offen offset:0 sc1 lds
    s_add_u32 s82, s4, 24576
    s_sub_u32 s83, s82, 53248
    s_cmp_ge_u32 s82, 53248
    s_cselect_b32 s82, s83, s82
    s_mul_i32 s82, s82, 5
    s_add_u32 s82, s82, s10
    s_add_u32 m0, s11, 20480
    s_nop 0
    buffer_load_dwordx4 v248, s[60:63], s82 offen offset:0 sc1 lds
    buffer_load_dwordx4 v249, s[60:63], s82 offen offset:1024 sc1 lds
    buffer_load_dwordx4 v250, s[60:63], s82 offen offset:2048 sc1 lds
    buffer_load_dwordx4 v251, s[60:63], s82 offen offset:3072 sc1 lds
    s_add_u32 m0, s11, 24576
    s_nop 0
    buffer_load_dwordx4 v252, s[60:63], s82 offen offset:0 sc1 lds
    s_add_u32 s82, s4, 28672
    s_sub_u32 s83, s82, 53248
    s_cmp_ge_u32 s82, 53248
    s_cselect_b32 s82, s83, s82
    s_mul_i32 s82, s82, 5
    s_add_u32 s82, s82, s10
    s_add_u32 m0, s11, 40960
    s_nop 0
    buffer_load_dwordx4 v248, s[60:63], s82 offen offset:0 sc1 lds
    buffer_load_dwordx4 v249, s[60:63], s82 offen offset:1024 sc1 lds
    buffer_load_dwordx4 v250, s[60:63], s82 offen offset:2048 sc1 lds
    buffer_load_dwordx4 v251, s[60:63], s82 offen offset:3072 sc1 lds
    s_add_u32 m0, s11, 45056
    s_nop 0
    buffer_load_dwordx4 v252, s[60:63], s82 offen offset:0 sc1 lds
    s_barrier
    s_add_u32 s82, s4, 32768
    s_sub_u32 s83, s82, 53248
    s_cmp_ge_u32 s82, 53248
    s_cselect_b32 s82, s83, s82
    s_mul_i32 s82, s82, 5
    s_add_u32 s82, s82, s10
    s_add_u32 m0, s11, 61440
    s_nop 0
    buffer_load_dwordx4 v248, s[60:63], s82 offen offset:0 sc1 lds
    buffer_load_dwordx4 v249, s[60:63], s82 offen offset:1024 sc1 lds
    buffer_load_dwordx4 v250, s[60:63], s82 offen offset:2048 sc1 lds
    buffer_load_dwordx4 v251, s[60:63], s82 offen offset:3072 sc1 lds
    s_add_u32 m0, s11, 65536
    s_nop 0
    buffer_load_dwordx4 v252, s[60:63], s82 offen offset:0 sc1 lds
    s_add_u32 s82, s4, 36864
    s_sub_u32 s83, s82, 53248
    s_cmp_ge_u32 s82, 53248
    s_cselect_b32 s82, s83, s82
    s_mul_i32 s82, s82, 5
    s_add_u32 s82, s82, s10
    s_add_u32 m0, s11, 81920
    s_nop 0
    buffer_load_dwordx4 v248, s[60:63], s82 offen offset:0 sc1 lds
    buffer_load_dwordx4 v249, s[60:63], s82 offen offset:1024 sc1 lds
    buffer_load_dwordx4 v250, s[60:63], s82 offen offset:2048 sc1 lds
    buffer_load_dwordx4 v251, s[60:63], s82 offen offset:3072 sc1 lds
    s_add_u32 m0, s11, 86016
    s_nop 0
    buffer_load_dwordx4 v252, s[60:63], s82 offen offset:0 sc1 lds
    s_add_u32 s82, s4, 40960
    s_sub_u32 s83, s82, 53248
    s_cmp_ge_u32 s82, 53248
    s_cselect_b32 s82, s83, s82
    s_mul_i32 s82, s82, 5
    s_add_u32 s82, s82, s10
    s_add_u32 m0, s11, 102400
    s_nop 0
    buffer_load_dwordx4 v248, s[60:63], s82 offen offset:0 sc1 lds
    buffer_load_dwordx4 v249, s[60:63], s82 offen offset:1024 sc1 lds
    buffer_load_dwordx4 v250, s[60:63], s82 offen offset:2048 sc1 lds
    buffer_load_dwordx4 v251, s[60:63], s82 offen offset:3072 sc1 lds
    s_add_u32 m0, s11, 106496
    s_nop 0
    buffer_load_dwordx4 v252, s[60:63], s82 offen offset:0 sc1 lds
    s_add_u32 s82, s4, 45056
    s_sub_u32 s83, s82, 53248
    s_cmp_ge_u32 s82, 53248
    s_cselect_b32 s82, s83, s82
    s_mul_i32 s82, s82, 5
    s_add_u32 s82, s82, s10
    s_add_u32 m0, s11, 122880
    s_nop 0
    buffer_load_dwordx4 v248, s[60:63], s82 offen offset:0 sc1 lds
    buffer_load_dwordx4 v249, s[60:63], s82 offen offset:1024 sc1 lds
    buffer_load_dwordx4 v250, s[60:63], s82 offen offset:2048 sc1 lds
    buffer_load_dwordx4 v251, s[60:63], s82 offen offset:3072 sc1 lds
    s_add_u32 m0, s11, 126976
    s_nop 0
    buffer_load_dwordx4 v252, s[60:63], s82 offen offset:0 sc1 lds
    s_add_u32 s82, s4, 49152
    s_sub_u32 s83, s82, 53248
    s_cmp_ge_u32 s82, 53248
    s_cselect_b32 s82, s83, s82
    s_mul_i32 s82, s82, 5
    s_add_u32 s82, s82, s10
    s_add_u32 m0, s11, 143360
    s_nop 0
    buffer_load_dwordx4 v248, s[60:63], s82 offen offset:0 sc1 lds
    buffer_load_dwordx4 v249, s[60:63], s82 offen offset:1024 sc1 lds
    buffer_load_dwordx4 v250, s[60:63], s82 offen offset:2048 sc1 lds
    buffer_load_dwordx4 v251, s[60:63], s82 offen offset:3072 sc1 lds
    s_add_u32 m0, s11, 147456
    s_nop 0
    buffer_load_dwordx4 v252, s[60:63], s82 offen offset:0 sc1 lds
    s_waitcnt lgkmcnt(0)
    s_waitcnt vmcnt(40)
    v_lshlrev_b32 v128, 16, v208
    v_and_b32 v129, 0xffff0000, v208
    v_lshlrev_b32 v130, 16, v209
    v_and_b32 v131, 0xffff0000, v209
    v_lshlrev_b32 v232, 16, v218
    v_and_b32 v233, 0xffff0000, v218
    v_lshlrev_b32 v234, 16, v219
    v_and_b32 v235, 0xffff0000, v219
    v_sub_f32 v236, v128, v228
    v_sub_f32 v237, v129, v228
    v_sub_f32 v238, v130, v228
    v_sub_f32 v239, v131, v228
    v_cvt_pk_bf16_f32 v240, v236, v237
    v_cvt_pk_bf16_f32 v241, v238, v239
    v_lshlrev_b32 v236, 16, v240
    v_and_b32 v237, 0xffff0000, v240
    v_lshlrev_b32 v238, 16, v241
    v_and_b32 v239, 0xffff0000, v241
    v_mul_f32 v236, v236, v230
    v_mul_f32 v237, v237, v230
    v_mul_f32 v238, v238, v230
    v_mul_f32 v239, v239, v230
    v_cvt_pk_bf16_f32 v240, v236, v237
    v_cvt_pk_bf16_f32 v241, v238, v239
    v_lshlrev_b32 v236, 16, v240
    v_and_b32 v237, 0xffff0000, v240
    v_lshlrev_b32 v238, 16, v241
    v_and_b32 v239, 0xffff0000, v241
    v_mul_f32 v236, v236, v232
    v_mul_f32 v237, v237, v233
    v_mul_f32 v238, v238, v234
    v_mul_f32 v239, v239, v235
    v_cvt_pk_bf16_f32 v240, v236, v237
    v_cvt_pk_bf16_f32 v241, v238, v239
    v_lshlrev_b32 v236, 16, v240
    v_and_b32 v237, 0xffff0000, v240
    v_lshlrev_b32 v238, 16, v241
    v_and_b32 v239, 0xffff0000, v241
    v_add_f32 v128, v236, v128
    v_add_f32 v129, v237, v129
    v_add_f32 v130, v238, v130
    v_add_f32 v131, v239, v131
    v_lshlrev_b32 v132, 16, v210
    v_and_b32 v133, 0xffff0000, v210
    v_lshlrev_b32 v134, 16, v211
    v_and_b32 v135, 0xffff0000, v211
    v_lshlrev_b32 v232, 16, v220
    v_and_b32 v233, 0xffff0000, v220
    v_lshlrev_b32 v234, 16, v221
    v_and_b32 v235, 0xffff0000, v221
    v_sub_f32 v236, v132, v228
    v_sub_f32 v237, v133, v228
    v_sub_f32 v238, v134, v228
    v_sub_f32 v239, v135, v228
    v_cvt_pk_bf16_f32 v240, v236, v237
    v_cvt_pk_bf16_f32 v241, v238, v239
    v_lshlrev_b32 v236, 16, v240
    v_and_b32 v237, 0xffff0000, v240
    v_lshlrev_b32 v238, 16, v241
    v_and_b32 v239, 0xffff0000, v241
    v_mul_f32 v236, v236, v230
    v_mul_f32 v237, v237, v230
    v_mul_f32 v238, v238, v230
    v_mul_f32 v239, v239, v230
    v_cvt_pk_bf16_f32 v240, v236, v237
    v_cvt_pk_bf16_f32 v241, v238, v239
    v_lshlrev_b32 v236, 16, v240
    v_and_b32 v237, 0xffff0000, v240
    v_lshlrev_b32 v238, 16, v241
    v_and_b32 v239, 0xffff0000, v241
    v_mul_f32 v236, v236, v232
    v_mul_f32 v237, v237, v233
    v_mul_f32 v238, v238, v234
    v_mul_f32 v239, v239, v235
    v_cvt_pk_bf16_f32 v240, v236, v237
    v_cvt_pk_bf16_f32 v241, v238, v239
    v_lshlrev_b32 v236, 16, v240
    v_and_b32 v237, 0xffff0000, v240
    v_lshlrev_b32 v238, 16, v241
    v_and_b32 v239, 0xffff0000, v241
    v_add_f32 v132, v236, v132
    v_add_f32 v133, v237, v133
    v_add_f32 v134, v238, v134
    v_add_f32 v135, v239, v135
    v_lshlrev_b32 v136, 16, v212
    v_and_b32 v137, 0xffff0000, v212
    v_lshlrev_b32 v138, 16, v213
    v_and_b32 v139, 0xffff0000, v213
    v_lshlrev_b32 v232, 16, v222
    v_and_b32 v233, 0xffff0000, v222
    v_lshlrev_b32 v234, 16, v223
    v_and_b32 v235, 0xffff0000, v223
    v_sub_f32 v236, v136, v228
    v_sub_f32 v237, v137, v228
    v_sub_f32 v238, v138, v228
    v_sub_f32 v239, v139, v228
    v_cvt_pk_bf16_f32 v240, v236, v237
    v_cvt_pk_bf16_f32 v241, v238, v239
    v_lshlrev_b32 v236, 16, v240
    v_and_b32 v237, 0xffff0000, v240
    v_lshlrev_b32 v238, 16, v241
    v_and_b32 v239, 0xffff0000, v241
    v_mul_f32 v236, v236, v230
    v_mul_f32 v237, v237, v230
    v_mul_f32 v238, v238, v230
    v_mul_f32 v239, v239, v230
    v_cvt_pk_bf16_f32 v240, v236, v237
    v_cvt_pk_bf16_f32 v241, v238, v239
    v_lshlrev_b32 v236, 16, v240
    v_and_b32 v237, 0xffff0000, v240
    v_lshlrev_b32 v238, 16, v241
    v_and_b32 v239, 0xffff0000, v241
    v_mul_f32 v236, v236, v232
    v_mul_f32 v237, v237, v233
    v_mul_f32 v238, v238, v234
    v_mul_f32 v239, v239, v235
    v_cvt_pk_bf16_f32 v240, v236, v237
    v_cvt_pk_bf16_f32 v241, v238, v239
    v_lshlrev_b32 v236, 16, v240
    v_and_b32 v237, 0xffff0000, v240
    v_lshlrev_b32 v238, 16, v241
    v_and_b32 v239, 0xffff0000, v241
    v_add_f32 v136, v236, v136
    v_add_f32 v137, v237, v137
    v_add_f32 v138, v238, v138
    v_add_f32 v139, v239, v139
    v_lshlrev_b32 v140, 16, v214
    v_and_b32 v141, 0xffff0000, v214
    v_lshlrev_b32 v142, 16, v215
    v_and_b32 v143, 0xffff0000, v215
    v_lshlrev_b32 v232, 16, v224
    v_and_b32 v233, 0xffff0000, v224
    v_lshlrev_b32 v234, 16, v225
    v_and_b32 v235, 0xffff0000, v225
    v_sub_f32 v236, v140, v228
    v_sub_f32 v237, v141, v228
    v_sub_f32 v238, v142, v228
    v_sub_f32 v239, v143, v228
    v_cvt_pk_bf16_f32 v240, v236, v237
    v_cvt_pk_bf16_f32 v241, v238, v239
    v_lshlrev_b32 v236, 16, v240
    v_and_b32 v237, 0xffff0000, v240
    v_lshlrev_b32 v238, 16, v241
    v_and_b32 v239, 0xffff0000, v241
    v_mul_f32 v236, v236, v230
    v_mul_f32 v237, v237, v230
    v_mul_f32 v238, v238, v230
    v_mul_f32 v239, v239, v230
    v_cvt_pk_bf16_f32 v240, v236, v237
    v_cvt_pk_bf16_f32 v241, v238, v239
    v_lshlrev_b32 v236, 16, v240
    v_and_b32 v237, 0xffff0000, v240
    v_lshlrev_b32 v238, 16, v241
    v_and_b32 v239, 0xffff0000, v241
    v_mul_f32 v236, v236, v232
    v_mul_f32 v237, v237, v233
    v_mul_f32 v238, v238, v234
    v_mul_f32 v239, v239, v235
    v_cvt_pk_bf16_f32 v240, v236, v237
    v_cvt_pk_bf16_f32 v241, v238, v239
    v_lshlrev_b32 v236, 16, v240
    v_and_b32 v237, 0xffff0000, v240
    v_lshlrev_b32 v238, 16, v241
    v_and_b32 v239, 0xffff0000, v241
    v_add_f32 v140, v236, v140
    v_add_f32 v141, v237, v141
    v_add_f32 v142, v238, v142
    v_add_f32 v143, v239, v143
    v_lshlrev_b32 v144, 16, v216
    v_and_b32 v145, 0xffff0000, v216
    v_lshlrev_b32 v146, 16, v217
    v_and_b32 v147, 0xffff0000, v217
    v_lshlrev_b32 v232, 16, v226
    v_and_b32 v233, 0xffff0000, v226
    v_lshlrev_b32 v234, 16, v227
    v_and_b32 v235, 0xffff0000, v227
    v_sub_f32 v236, v144, v228
    v_sub_f32 v237, v145, v228
    v_sub_f32 v238, v146, v228
    v_sub_f32 v239, v147, v228
    v_cvt_pk_bf16_f32 v240, v236, v237
    v_cvt_pk_bf16_f32 v241, v238, v239
    v_lshlrev_b32 v236, 16, v240
    v_and_b32 v237, 0xffff0000, v240
    v_lshlrev_b32 v238, 16, v241
    v_and_b32 v239, 0xffff0000, v241
    v_mul_f32 v236, v236, v230
    v_mul_f32 v237, v237, v230
    v_mul_f32 v238, v238, v230
    v_mul_f32 v239, v239, v230
    v_cvt_pk_bf16_f32 v240, v236, v237
    v_cvt_pk_bf16_f32 v241, v238, v239
    v_lshlrev_b32 v236, 16, v240
    v_and_b32 v237, 0xffff0000, v240
    v_lshlrev_b32 v238, 16, v241
    v_and_b32 v239, 0xffff0000, v241
    v_mul_f32 v236, v236, v232
    v_mul_f32 v237, v237, v233
    v_mul_f32 v238, v238, v234
    v_mul_f32 v239, v239, v235
    v_cvt_pk_bf16_f32 v240, v236, v237
    v_cvt_pk_bf16_f32 v241, v238, v239
    v_lshlrev_b32 v236, 16, v240
    v_and_b32 v237, 0xffff0000, v240
    v_lshlrev_b32 v238, 16, v241
    v_and_b32 v239, 0xffff0000, v241
    v_add_f32 v144, v236, v144
    v_add_f32 v145, v237, v145
    v_add_f32 v146, v238, v146
    v_add_f32 v147, v239, v147
    s_cmp_lg_u32 s14, 0
    s_cbranch_scc1 parallel_sum__ssm_conv_s5__glu_gated_bilinear__prompt_kernel_hg_e3n
    s_add_u32 s0, s9, 128
    s_mov_b32 s80, 0
parallel_sum__ssm_conv_s5__glu_gated_bilinear__prompt_kernel_hg_pollg:
    buffer_load_dword v3, v2, s[64:67], s0 offen sc1
    s_waitcnt vmcnt(0)
    v_cmp_ne_u32 vcc, s15, v3
    s_and_b32 s82, vcc_lo, 0x3fffff
    s_cbranch_scc0 parallel_sum__ssm_conv_s5__glu_gated_bilinear__prompt_kernel_hg_pollg_ok
    s_add_u32 s80, s80, 1
    s_cmp_lt_u32 s80, 0x20000
    s_cbranch_scc0 parallel_sum__ssm_conv_s5__glu_gated_bilinear__prompt_kernel_hg_pollg_ok
    s_sleep 2
    s_branch parallel_sum__ssm_conv_s5__glu_gated_bilinear__prompt_kernel_hg_pollg
parallel_sum__ssm_conv_s5__glu_gated_bilinear__prompt_kernel_hg_pollg_ok:
    s_add_u32 s80, s22, 0
    buffer_load_dwordx4 v[48:51], v0, s[60:63], s80 offen offset:0 sc1
    buffer_load_dwordx4 v[52:55], v0, s[60:63], s80 offen offset:1024 sc1
    buffer_load_dwordx4 v[56:59], v0, s[60:63], s80 offen offset:2048 sc1
    buffer_load_dwordx4 v[60:63], v0, s[60:63], s80 offen offset:3072 sc1
    s_add_u32 s80, s22, 4096
    buffer_load_dwordx4 v[64:67], v0, s[60:63], s80 offen offset:0 sc1
    s_add_u32 s80, s22, 4096
    buffer_load_dwordx4 v[68:71], v0, s[60:63], s80 offen offset:1024 sc1
    buffer_load_dwordx4 v[72:75], v0, s[60:63], s80 offen offset:2048 sc1
    buffer_load_dwordx4 v[76:79], v0, s[60:63], s80 offen offset:3072 sc1
    s_add_u32 s80, s22, 8192
    buffer_load_dwordx4 v[80:83], v0, s[60:63], s80 offen offset:0 sc1
    buffer_load_dwordx4 v[84:87], v0, s[60:63], s80 offen offset:1024 sc1
    s_branch parallel_sum__ssm_conv_s5__glu_gated_bilinear__prompt_kernel_hg_e3
parallel_sum__ssm_conv_s5__glu_gated_bilinear__prompt_kernel_hg_e3n:
    s_add_u32 s80, s22, 0
    buffer_load_dwordx4 v[48:51], v0, s[60:63], s80 offen offset:0 sc1
    buffer_load_dwordx4 v[52:55], v0, s[60:63], s80 offen offset:1024 sc1
    buffer_load_dwordx4 v[56:59], v0, s[60:63], s80 offen offset:2048 sc1
    buffer_load_dwordx4 v[60:63], v0, s[60:63], s80 offen offset:3072 sc1
    s_add_u32 s80, s22, 4096
    buffer_load_dwordx4 v[64:67], v0, s[60:63], s80 offen offset:0 sc1
    s_add_u32 s80, s22, 4096
    buffer_load_dwordx4 v[68:71], v0, s[60:63], s80 offen offset:1024 sc1
    buffer_load_dwordx4 v[72:75], v0, s[60:63], s80 offen offset:2048 sc1
    buffer_load_dwordx4 v[76:79], v0, s[60:63], s80 offen offset:3072 sc1
    s_add_u32 s80, s22, 8192
    buffer_load_dwordx4 v[80:83], v0, s[60:63], s80 offen offset:0 sc1
    buffer_load_dwordx4 v[84:87], v0, s[60:63], s80 offen offset:1024 sc1
    s_waitcnt vmcnt(10)
parallel_sum__ssm_conv_s5__glu_gated_bilinear__prompt_kernel_hg_e3:
    s_waitcnt lgkmcnt(0)
    s_barrier
    s_add_u32 s80, s23, 0
    buffer_load_dwordx4 v[88:91], v0, s[60:63], s80 offen offset:0 sc1
    buffer_load_dwordx4 v[92:95], v0, s[60:63], s80 offen offset:1024 sc1
    buffer_load_dwordx4 v[96:99], v0, s[60:63], s80 offen offset:2048 sc1
    buffer_load_dwordx4 v[100:103], v0, s[60:63], s80 offen offset:3072 sc1
    s_add_u32 s80, s23, 4096
    buffer_load_dwordx4 v[104:107], v0, s[60:63], s80 offen offset:0 sc1
    s_add_u32 s80, s23, 4096
    buffer_load_dwordx4 v[108:111], v0, s[60:63], s80 offen offset:1024 sc1
    buffer_load_dwordx4 v[112:115], v0, s[60:63], s80 offen offset:2048 sc1
    buffer_load_dwordx4 v[116:119], v0, s[60:63], s80 offen offset:3072 sc1
    s_add_u32 s80, s23, 8192
    buffer_load_dwordx4 v[120:123], v0, s[60:63], s80 offen offset:0 sc1
    buffer_load_dwordx4 v[124:127], v0, s[60:63], s80 offen offset:1024 sc1
    s_branch parallel_sum__ssm_conv_s5__glu_gated_bilinear__prompt_kernel_p2h
parallel_sum__ssm_conv_s5__glu_gated_bilinear__prompt_kernel_hssm:
    v_lshlrev_b32 v0, 4, v1
    s_mov_b32 s68, s40
    s_mov_b32 s69, s41
    s_mov_b32 s70, 0x21c000
    s_mov_b32 s71, 0x00020000
    s_add_u32 s1, s12, 128
    s_add_u32 m0, s13, 53376
    s_nop 0
    buffer_load_dwordx4 v232, s[48:51], s1 offen offset:0 lds
    buffer_load_dwordx4 v233, s[48:51], s1 offen offset:1024 lds
    buffer_load_dwordx4 v234, s[48:51], s1 offen offset:2048 lds
    buffer_load_dwordx4 v235, s[48:51], s1 offen offset:3072 lds
    s_add_u32 m0, s13, 57472
    s_nop 0
    buffer_load_dwordx4 v236, s[48:51], s1 offen offset:0 lds
    buffer_load_dwordx4 v237, s[48:51], s1 offen offset:1024 lds
    buffer_load_dwordx4 v238, s[48:51], s1 offen offset:2048 lds
    buffer_load_dwordx4 v239, s[48:51], s1 offen offset:3072 lds
    s_add_u32 s1, s101, 128
    s_add_u32 m0, s100, 53376
    s_nop 0
    buffer_load_dwordx4 v240, s[52:55], s1 offen offset:0 lds
    buffer_load_dwordx4 v241, s[52:55], s1 offen offset:1024 lds
    buffer_load_dwordx4 v242, s[52:55], s1 offen offset:2048 lds
    buffer_load_dwordx4 v243, s[52:55], s1 offen offset:3072 lds
    v_add_u32 v150, s100, v0
    v_add_u32 v151, 0xd080, v150
    v_add_u32 v152, 0x1a100, v150
    v_mov_b32 v153, 0x3f803f80
    s_mov_b32 s76, s44
    s_mov_b32 s77, s45
    s_mov_b32 s78, 0x100
    s_mov_b32 s79, 0x00020000
    v_mov_b32 v101, 0
    s_waitcnt vmcnt(12)
    s_barrier
    s_lshl_b32 s80, s2, 2
    s_add_u32 s80, s80, s14
    s_cmp_lg_u32 s80, 0
    s_cbranch_scc1 parallel_sum__ssm_conv_s5__glu_gated_bilinear__prompt_kernel_hs_nn
    s_memrealtime s[82:83]
    s_waitcnt lgkmcnt(0)
    s_or_b32 s82, s82, 1
    v_mov_b32 v2, s82
    s_mov_b64 exec, 1
    buffer_store_dword v2, v101, s[76:79], 0 offen sc1
    s_mov_b64 exec, -1
parallel_sum__ssm_conv_s5__glu_gated_bilinear__prompt_kernel_hs_nn:
    ds_read_b128 v[172:175], v150 offset:0
    ds_read_b128 v[176:179], v150 offset:1024
    ds_read_b128 v[180:183], v150 offset:2048
    ds_read_b128 v[184:187], v150 offset:3072
    s_add_u32 s1, s12, 256
    s_add_u32 m0, s13, 106752
    s_nop 0
    buffer_load_dwordx4 v232, s[48:51], s1 offen offset:0 lds
    buffer_load_dwordx4 v233, s[48:51], s1 offen offset:1024 lds
    buffer_load_dwordx4 v234, s[48:51], s1 offen offset:2048 lds
    s_waitcnt lgkmcnt(0)
    v_lshlrev_b32 v196, 16, v172
    v_and_b32 v197, 0xffff0000, v172
    v_add_f32 v146, v196, v197
    v_lshlrev_b32 v198, 16, v176
    v_and_b32 v199, 0xffff0000, v176
    v_add_f32 v147, v198, v199
    buffer_load_dwordx4 v235, s[48:51], s1 offen offset:3072 lds
    v_lshlrev_b32 v196, 16, v180
    v_and_b32 v197, 0xffff0000, v180
    v_add_f32 v148, v196, v197
    v_lshlrev_b32 v198, 16, v184
    v_and_b32 v199, 0xffff0000, v184
    v_add_f32 v149, v198, v199
    v_lshlrev_b32 v196, 16, v173
    s_add_u32 m0, s13, 110848
    s_nop 0
    buffer_load_dwordx4 v236, s[48:51], s1 offen offset:0 lds
    v_and_b32 v197, 0xffff0000, v173
    v_add_f32 v196, v196, v197
    v_add_f32 v146, v146, v196
    v_lshlrev_b32 v198, 16, v177
    v_and_b32 v199, 0xffff0000, v177
    v_add_f32 v198, v198, v199
    v_add_f32 v147, v147, v198
    buffer_load_dwordx4 v237, s[48:51], s1 offen offset:1024 lds
    v_lshlrev_b32 v196, 16, v181
    v_and_b32 v197, 0xffff0000, v181
    v_add_f32 v196, v196, v197
    v_add_f32 v148, v148, v196
    v_lshlrev_b32 v198, 16, v185
    v_and_b32 v199, 0xffff0000, v185
    v_add_f32 v198, v198, v199
    buffer_load_dwordx4 v238, s[48:51], s1 offen offset:2048 lds
    v_add_f32 v149, v149, v198
    v_lshlrev_b32 v196, 16, v174
    v_and_b32 v197, 0xffff0000, v174
    v_add_f32 v196, v196, v197
    v_add_f32 v146, v146, v196
    v_lshlrev_b32 v198, 16, v178
    v_and_b32 v199, 0xffff0000, v178
    buffer_load_dwordx4 v239, s[48:51], s1 offen offset:3072 lds
    v_add_f32 v198, v198, v199
    v_add_f32 v147, v147, v198
    v_lshlrev_b32 v196, 16, v182
    v_and_b32 v197, 0xffff0000, v182
    v_add_f32 v196, v196, v197
    v_add_f32 v148, v148, v196
    v_lshlrev_b32 v198, 16, v186
    s_add_u32 s1, s101, 256
    s_add_u32 m0, s100, 106752
    s_nop 0
    buffer_load_dwordx4 v240, s[52:55], s1 offen offset:0 lds
    v_and_b32 v199, 0xffff0000, v186
    v_add_f32 v198, v198, v199
    v_add_f32 v149, v149, v198
    v_lshlrev_b32 v196, 16, v175
    v_and_b32 v197, 0xffff0000, v175
    v_add_f32 v196, v196, v197
    v_add_f32 v146, v146, v196
    buffer_load_dwordx4 v241, s[52:55], s1 offen offset:1024 lds
    v_lshlrev_b32 v198, 16, v179
    v_and_b32 v199, 0xffff0000, v179
    v_add_f32 v198, v198, v199
    v_add_f32 v147, v147, v198
    v_lshlrev_b32 v196, 16, v183
    v_and_b32 v197, 0xffff0000, v183
    v_add_f32 v196, v196, v197
    buffer_load_dwordx4 v242, s[52:55], s1 offen offset:2048 lds
    v_add_f32 v148, v148, v196
    v_lshlrev_b32 v198, 16, v187
    v_and_b32 v199, 0xffff0000, v187
    v_add_f32 v198, v198, v199
    v_add_f32 v149, v149, v198
    buffer_load_dwordx4 v243, s[52:55], s1 offen offset:3072 lds
    v_lshlrev_b32 v248, 4, v1
    v_lshlrev_b32 v249, 4, v1
    v_lshlrev_b32 v250, 4, v1
    v_lshlrev_b32 v251, 4, v1
    v_add_u32 v252, 4096, v248
    s_mul_i32 s10, s6, 276480
    s_mul_i32 s11, s14, 5120
    s_add_u32 s10, s10, s11
    s_add_u32 s10, s10, 0x200000
    s_waitcnt vmcnt(12)
    s_barrier
    ds_read_b128 v[172:175], v151 offset:0
    ds_read_b128 v[176:179], v151 offset:1024
    ds_read_b128 v[180:183], v151 offset:2048
    ds_read_b128 v[184:187], v151 offset:3072
    s_add_u32 s1, s12, 384
    s_add_u32 m0, s13, 0
    s_nop 0
    buffer_load_dwordx4 v232, s[48:51], s1 offen offset:0 lds
    buffer_load_dwordx4 v233, s[48:51], s1 offen offset:1024 lds
    buffer_load_dwordx4 v234, s[48:51], s1 offen offset:2048 lds
    s_waitcnt lgkmcnt(0)
    v_lshlrev_b32 v196, 16, v172
    v_and_b32 v197, 0xffff0000, v172
    v_add_f32 v196, v196, v197
    v_add_f32 v146, v146, v196
    v_lshlrev_b32 v198, 16, v176
    v_and_b32 v199, 0xffff0000, v176
    buffer_load_dwordx4 v235, s[48:51], s1 offen offset:3072 lds
    v_add_f32 v198, v198, v199
    v_add_f32 v147, v147, v198
    v_lshlrev_b32 v196, 16, v180
    v_and_b32 v197, 0xffff0000, v180
    v_add_f32 v196, v196, v197
    v_add_f32 v148, v148, v196
    v_lshlrev_b32 v198, 16, v184
    s_add_u32 m0, s13, 4096
    s_nop 0
    buffer_load_dwordx4 v236, s[48:51], s1 offen offset:0 lds
    v_and_b32 v199, 0xffff0000, v184
    v_add_f32 v198, v198, v199
    v_add_f32 v149, v149, v198
    v_lshlrev_b32 v196, 16, v173
    v_and_b32 v197, 0xffff0000, v173
    v_add_f32 v196, v196, v197
    v_add_f32 v146, v146, v196
    buffer_load_dwordx4 v237, s[48:51], s1 offen offset:1024 lds
    v_lshlrev_b32 v198, 16, v177
    v_and_b32 v199, 0xffff0000, v177
    v_add_f32 v198, v198, v199
    v_add_f32 v147, v147, v198
    v_lshlrev_b32 v196, 16, v181
    v_and_b32 v197, 0xffff0000, v181
    v_add_f32 v196, v196, v197
    buffer_load_dwordx4 v238, s[48:51], s1 offen offset:2048 lds
    v_add_f32 v148, v148, v196
    v_lshlrev_b32 v198, 16, v185
    v_and_b32 v199, 0xffff0000, v185
    v_add_f32 v198, v198, v199
    v_add_f32 v149, v149, v198
    v_lshlrev_b32 v196, 16, v174
    v_and_b32 v197, 0xffff0000, v174
    buffer_load_dwordx4 v239, s[48:51], s1 offen offset:3072 lds
    v_add_f32 v196, v196, v197
    v_add_f32 v146, v146, v196
    v_lshlrev_b32 v198, 16, v178
    v_and_b32 v199, 0xffff0000, v178
    v_add_f32 v198, v198, v199
    v_add_f32 v147, v147, v198
    v_lshlrev_b32 v196, 16, v182
    s_add_u32 s1, s101, 384
    s_add_u32 m0, s100, 0
    s_nop 0
    buffer_load_dwordx4 v240, s[52:55], s1 offen offset:0 lds
    v_and_b32 v197, 0xffff0000, v182
    v_add_f32 v196, v196, v197
    v_add_f32 v148, v148, v196
    v_lshlrev_b32 v198, 16, v186
    v_and_b32 v199, 0xffff0000, v186
    v_add_f32 v198, v198, v199
    v_add_f32 v149, v149, v198
    buffer_load_dwordx4 v241, s[52:55], s1 offen offset:1024 lds
    v_lshlrev_b32 v196, 16, v175
    v_and_b32 v197, 0xffff0000, v175
    v_add_f32 v196, v196, v197
    v_add_f32 v146, v146, v196
    v_lshlrev_b32 v198, 16, v179
    v_and_b32 v199, 0xffff0000, v179
    v_add_f32 v198, v198, v199
    buffer_load_dwordx4 v242, s[52:55], s1 offen offset:2048 lds
    v_add_f32 v147, v147, v198
    v_lshlrev_b32 v196, 16, v183
    v_and_b32 v197, 0xffff0000, v183
    v_add_f32 v196, v196, v197
    v_add_f32 v148, v148, v196
    v_lshlrev_b32 v198, 16, v187
    v_and_b32 v199, 0xffff0000, v187
    buffer_load_dwordx4 v243, s[52:55], s1 offen offset:3072 lds
    v_add_f32 v198, v198, v199
    v_add_f32 v149, v149, v198
    s_lshl_b32 s80, s6, 8
    s_lshl_b32 s81, s7, 3
    s_add_u32 s80, s80, s81
    s_lshl_b32 s81, s14, 1
    s_add_u32 s80, s80, s81
    v_lshrrev_b32 v2, 5, v1
    v_add_u32 v100, s80, v2
    v_mul_u32_u24 v2, 1280, v100
    v_and_b32 v3, 31, v1
    v_lshl_add_u32 v104, v3, 3, v2
    buffer_load_dwordx2 v[136:137], v104, s[48:51], 0 offen offset:0
    buffer_load_dwordx2 v[138:139], v104, s[48:51], 0 offen offset:256
    buffer_load_dwordx2 v[140:141], v104, s[48:51], 0 offen offset:512
    buffer_load_dwordx2 v[142:143], v104, s[48:51], 0 offen offset:768
    buffer_load_dwordx2 v[144:145], v104, s[48:51], 0 offen offset:1024
    s_cmp_lt_u32 s7, 16
    s_cselect_b32 s72, s26, s28
    s_cselect_b32 s73, s27, s29
    s_mov_b32 s74, 0xc8000
    s_mov_b32 s75, 0x00020000
    v_and_b32 v7, 15, v1
    v_mul_u32_u24 v7, 1280, v7
    v_lshrrev_b32 v2, 4, v1
    v_lshl_add_u32 v7, v2, 4, v7
    s_and_b32 s80, s7, 7
    s_lshl_b32 s80, s80, 2
    s_add_u32 s80, s80, s14
    s_mul_i32 s8, s6, 102400
    s_bfe_u32 s81, s7, 0x10003
    s_lshl_b32 s81, s81, 7
    s_add_u32 s8, s8, s81
    s_lshl_b32 s0, s6, 2
    s_lshr_b32 s81, s7, 3
    s_add_u32 s0, s0, s81
    s_mul_i32 s0, s0, 50
    s_mul_i32 s81, s80, 0x3334
    s_lshr_b32 s81, s81, 16
    s_mul_i32 s82, s81, 5
    s_sub_u32 s82, s80, s82
    s_mul_i32 s82, s82, 20480
    s_add_u32 s82, s82, s8
    s_lshr_b32 s83, s81, 1
    s_lshl_b32 s83, s83, 8
    s_add_u32 s82, s82, s83
    s_and_b32 s83, s81, 1
    s_lshl_b32 s83, s83, 6
    s_add_u32 s82, s82, s83
    buffer_load_dwordx4 v[200:203], v7, s[72:75], s82 offen
    s_add_u32 s3, s0, s80
    s_lshl_b32 s3, s3, 10
    s_add_u32 s80, s80, 32
    s_cmp_lt_u32 s80, 50
    s_cselect_b64 s[34:35], -1, 0
    s_mov_b64 exec, s[34:35]
    s_mul_i32 s81, s80, 0x3334
    s_lshr_b32 s81, s81, 16
    s_mul_i32 s82, s81, 5
    s_sub_u32 s82, s80, s82
    s_mul_i32 s82, s82, 20480
    s_add_u32 s82, s82, s8
    s_lshr_b32 s83, s81, 1
    s_lshl_b32 s83, s83, 8
    s_add_u32 s82, s82, s83
    s_and_b32 s83, s81, 1
    s_lshl_b32 s83, s83, 6
    s_add_u32 s82, s82, s83
    buffer_load_dwordx4 v[204:207], v7, s[72:75], s82 offen
    s_add_u32 s4, s0, s80
    s_lshl_b32 s4, s4, 10
    s_mov_b64 exec, -1
    v_lshlrev_b32 v0, 4, v1
    s_and_b32 s80, s7, 7
    s_lshl_b32 s80, s80, 2
    s_add_u32 s80, s80, s14
    s_lshr_b32 s19, s7, 3
    s_mov_b32 s22, 0xcccccccd
    s_mul_i32 s23, s6, 276480
    s_add_u32 s23, s23, 0x200000
    s_mul_i32 s24, s6, 160
    s_mul_i32 s82, s80, 0x3334
    s_lshr_b32 s82, s82, 16
    s_mul_i32 s83, s82, 5
    s_sub_u32 s83, s80, s83
    s_lshl_b32 s82, s82, 2
    s_add_u32 s82, s82, s19
    s_lshl_b32 s81, s83, 6
    v_add_u32 v2, s81, v1
    v_mul_hi_u32 v3, v2, s22
    v_lshrrev_b32 v3, 3, v3
    v_mul_u32_u24 v4, 10, v3
    v_sub_u32 v2, v2, v4
    v_mul_u32_u24 v3, 1280, v3
    v_lshl_add_u32 v20, v2, 4, v3
    s_mul_i32 s16, s82, 5120
    s_add_u32 s16, s16, s23
    s_lshl_b32 s83, s83, 10
    s_add_u32 s16, s16, s83
    s_mul_i32 s82, s82, 40960
    s_add_u32 s82, s82, s24
    buffer_load_dwordx4 v[8:11], v20, s[68:71], s82 offen
    s_add_u32 s80, s80, 32
    s_mul_i32 s82, s80, 0x3334
    s_lshr_b32 s82, s82, 16
    s_mul_i32 s83, s82, 5
    s_sub_u32 s83, s80, s83
    s_lshl_b32 s82, s82, 2
    s_add_u32 s82, s82, s19
    s_lshl_b32 s81, s83, 6
    v_add_u32 v2, s81, v1
    v_mul_hi_u32 v3, v2, s22
    v_lshrrev_b32 v3, 3, v3
    v_mul_u32_u24 v4, 10, v3
    v_sub_u32 v2, v2, v4
    v_mul_u32_u24 v3, 1280, v3
    v_lshl_add_u32 v21, v2, 4, v3
    s_mul_i32 s17, s82, 5120
    s_add_u32 s17, s17, s23
    s_lshl_b32 s83, s83, 10
    s_add_u32 s17, s17, s83
    s_mul_i32 s82, s82, 40960
    s_add_u32 s82, s82, s24
    buffer_load_dwordx4 v[12:15], v21, s[68:71], s82 offen
    s_add_u32 s80, s80, 32
    s_mul_i32 s82, s80, 0x3334
    s_lshr_b32 s82, s82, 16
    s_mul_i32 s83, s82, 5
    s_sub_u32 s83, s80, s83
    s_lshl_b32 s82, s82, 2
    s_add_u32 s82, s82, s19
    s_lshl_b32 s81, s83, 6
    v_add_u32 v2, s81, v1
    v_mul_hi_u32 v3, v2, s22
    v_lshrrev_b32 v3, 3, v3
    v_mul_u32_u24 v4, 10, v3
    v_sub_u32 v2, v2, v4
    v_mul_u32_u24 v3, 1280, v3
    v_lshl_add_u32 v22, v2, 4, v3
    s_mul_i32 s18, s82, 5120
    s_add_u32 s18, s18, s23
    s_lshl_b32 s83, s83, 10
    s_add_u32 s18, s18, s83
    s_mul_i32 s82, s82, 40960
    s_add_u32 s82, s82, s24
    s_cmp_lt_u32 s19, 2
    s_cselect_b32 s81, 6, 1
    s_add_u32 s81, s81, 64
    s_cmp_lt_u32 s80, s81
    s_cselect_b64 s[20:21], -1, 0
    s_mov_b64 exec, s[20:21]
    buffer_load_dwordx4 v[16:19], v22, s[68:71], s82 offen
    s_mov_b64 exec, -1
    s_waitcnt vmcnt(22)
    s_barrier
    ds_read_b128 v[172:175], v152 offset:0
    ds_read_b128 v[176:179], v152 offset:1024
    ds_read_b128 v[180:183], v152 offset:2048
    ds_read_b128 v[184:187], v152 offset:3072
    s_add_u32 s1, s12, 512
    s_add_u32 m0, s13, 53376
    s_nop 0
    buffer_load_dwordx4 v232, s[48:51], s1 offen offset:0 lds
    buffer_load_dwordx4 v233, s[48:51], s1 offen offset:1024 lds
    buffer_load_dwordx4 v234, s[48:51], s1 offen offset:2048 lds
    s_waitcnt lgkmcnt(0)
    v_lshlrev_b32 v196, 16, v172
    v_and_b32 v197, 0xffff0000, v172
    v_add_f32 v196, v196, v197
    v_add_f32 v146, v146, v196
    v_lshlrev_b32 v198, 16, v176
    v_and_b32 v199, 0xffff0000, v176
    buffer_load_dwordx4 v235, s[48:51], s1 offen offset:3072 lds
    v_add_f32 v198, v198, v199
    v_add_f32 v147, v147, v198
    v_lshlrev_b32 v196, 16, v180
    v_and_b32 v197, 0xffff0000, v180
    v_add_f32 v196, v196, v197
    v_add_f32 v148, v148, v196
    v_lshlrev_b32 v198, 16, v184
    s_add_u32 m0, s13, 57472
    s_nop 0
    buffer_load_dwordx4 v236, s[48:51], s1 offen offset:0 lds
    v_and_b32 v199, 0xffff0000, v184
    v_add_f32 v198, v198, v199
    v_add_f32 v149, v149, v198
    v_lshlrev_b32 v196, 16, v173
    v_and_b32 v197, 0xffff0000, v173
    v_add_f32 v196, v196, v197
    v_add_f32 v146, v146, v196
    buffer_load_dwordx4 v237, s[48:51], s1 offen offset:1024 lds
    v_lshlrev_b32 v198, 16, v177
    v_and_b32 v199, 0xffff0000, v177
    v_add_f32 v198, v198, v199
    v_add_f32 v147, v147, v198
    v_lshlrev_b32 v196, 16, v181
    v_and_b32 v197, 0xffff0000, v181
    v_add_f32 v196, v196, v197
    buffer_load_dwordx4 v238, s[48:51], s1 offen offset:2048 lds
    v_add_f32 v148, v148, v196
    v_lshlrev_b32 v198, 16, v185
    v_and_b32 v199, 0xffff0000, v185
    v_add_f32 v198, v198, v199
    v_add_f32 v149, v149, v198
    v_lshlrev_b32 v196, 16, v174
    v_and_b32 v197, 0xffff0000, v174
    buffer_load_dwordx4 v239, s[48:51], s1 offen offset:3072 lds
    v_add_f32 v196, v196, v197
    v_add_f32 v146, v146, v196
    v_lshlrev_b32 v198, 16, v178
    v_and_b32 v199, 0xffff0000, v178
    v_add_f32 v198, v198, v199
    v_add_f32 v147, v147, v198
    v_lshlrev_b32 v196, 16, v182
    s_add_u32 s1, s101, 512
    s_add_u32 m0, s100, 53376
    s_nop 0
    buffer_load_dwordx4 v240, s[52:55], s1 offen offset:0 lds
    v_and_b32 v197, 0xffff0000, v182
    v_add_f32 v196, v196, v197
    v_add_f32 v148, v148, v196
    v_lshlrev_b32 v198, 16, v186
    v_and_b32 v199, 0xffff0000, v186
    v_add_f32 v198, v198, v199
    v_add_f32 v149, v149, v198
    buffer_load_dwordx4 v241, s[52:55], s1 offen offset:1024 lds
    v_lshlrev_b32 v196, 16, v175
    v_and_b32 v197, 0xffff0000, v175
    v_add_f32 v196, v196, v197
    v_add_f32 v146, v146, v196
    v_lshlrev_b32 v198, 16, v179
    v_and_b32 v199, 0xffff0000, v179
    v_add_f32 v198, v198, v199
    buffer_load_dwordx4 v242, s[52:55], s1 offen offset:2048 lds
    v_add_f32 v147, v147, v198
    v_lshlrev_b32 v196, 16, v183
    v_and_b32 v197, 0xffff0000, v183
    v_add_f32 v196, v196, v197
    v_add_f32 v148, v148, v196
    v_lshlrev_b32 v198, 16, v187
    v_and_b32 v199, 0xffff0000, v187
    buffer_load_dwordx4 v243, s[52:55], s1 offen offset:3072 lds
    v_add_f32 v198, v198, v199
    v_add_f32 v149, v149, v198
    s_waitcnt vmcnt(22)
    s_barrier
    s_waitcnt vmcnt(12)
    buffer_store_dwordx4 v[8:11], v0, s[60:63], s16 offen sc1
    buffer_store_dwordx4 v[12:15], v0, s[60:63], s17 offen sc1
    s_mov_b64 exec, s[20:21]
    buffer_store_dwordx4 v[16:19], v0, s[60:63], s18 offen sc1
    s_mov_b64 exec, -1
    ds_read_b128 v[172:175], v150 offset:0
    ds_read_b128 v[176:179], v150 offset:1024
    ds_read_b128 v[180:183], v150 offset:2048
    ds_read_b128 v[184:187], v150 offset:3072
    s_add_u32 s1, s12, 640
    s_add_u32 m0, s13, 106752
    s_nop 0
    buffer_load_dwordx4 v232, s[48:51], s1 offen offset:0 lds
    v_lshlrev_b32 v108, 16, v136
    v_and_b32 v109, 0xffff0000, v136
    v_lshlrev_b32 v110, 16, v137
    v_and_b32 v111, 0xffff0000, v137
    v_lshlrev_b32 v112, 16, v138
    v_and_b32 v113, 0xffff0000, v138
    v_lshlrev_b32 v114, 16, v139
    v_and_b32 v115, 0xffff0000, v139
    v_lshlrev_b32 v116, 16, v140
    v_and_b32 v117, 0xffff0000, v140
    v_lshlrev_b32 v118, 16, v141
    v_and_b32 v119, 0xffff0000, v141
    v_lshlrev_b32 v120, 16, v142
    v_and_b32 v121, 0xffff0000, v142
    v_lshlrev_b32 v122, 16, v143
    v_and_b32 v123, 0xffff0000, v143
    buffer_load_dwordx4 v233, s[48:51], s1 offen offset:1024 lds
    v_lshlrev_b32 v124, 16, v144
    v_and_b32 v125, 0xffff0000, v144
    v_lshlrev_b32 v126, 16, v145
    v_and_b32 v127, 0xffff0000, v145
    v_add_f32 v2, v108, v109
    v_add_f32 v3, v110, v111
    v_add_f32 v2, v2, v112
    v_add_f32 v3, v3, v113
    v_add_f32 v2, v2, v114
    v_add_f32 v3, v3, v115
    v_add_f32 v2, v2, v116
    v_add_f32 v3, v3, v117
    v_add_f32 v2, v2, v118
    v_add_f32 v3, v3, v119
    v_add_f32 v2, v2, v120
    v_add_f32 v3, v3, v121
    buffer_load_dwordx4 v234, s[48:51], s1 offen offset:2048 lds
    v_add_f32 v2, v2, v122
    v_add_f32 v3, v3, v123
    v_add_f32 v2, v2, v124
    v_add_f32 v3, v3, v125
    v_add_f32 v2, v2, v126
    v_add_f32 v3, v3, v127
    v_add_f32 v2, v2, v3
    s_nop 1
    v_add_f32 v2, v2, v2 row_ror:8 row_mask:0xf bank_mask:0xf
    s_nop 1
    v_add_f32 v2, v2, v2 row_ror:4 row_mask:0xf bank_mask:0xf
    s_nop 1
    v_add_f32 v2, v2, v2 row_ror:2 row_mask:0xf bank_mask:0xf
    s_nop 1
    v_add_f32 v2, v2, v2 row_ror:1 row_mask:0xf bank_mask:0xf
    v_mov_b32 v4, v2
    buffer_load_dwordx4 v235, s[48:51], s1 offen offset:3072 lds
    s_nop 1
    v_permlane16_swap_b32 v2, v4
    s_nop 1
    v_add_f32 v2, v2, v4
    v_mul_f32 v2, 0x3acccccd, v2
    v_sub_f32 v108, v108, v2
    v_sub_f32 v109, v109, v2
    v_sub_f32 v110, v110, v2
    v_sub_f32 v111, v111, v2
    v_sub_f32 v112, v112, v2
    v_sub_f32 v113, v113, v2
    v_sub_f32 v114, v114, v2
    v_sub_f32 v115, v115, v2
    v_sub_f32 v116, v116, v2
    v_sub_f32 v117, v117, v2
    v_sub_f32 v118, v118, v2
    s_add_u32 m0, s13, 110848
    s_nop 0
    buffer_load_dwordx4 v236, s[48:51], s1 offen offset:0 lds
    v_sub_f32 v119, v119, v2
    v_sub_f32 v120, v120, v2
    v_sub_f32 v121, v121, v2
    v_sub_f32 v122, v122, v2
    v_sub_f32 v123, v123, v2
    v_sub_f32 v124, v124, v2
    v_sub_f32 v125, v125, v2
    v_sub_f32 v126, v126, v2
    v_sub_f32 v127, v127, v2
    v_mul_f32 v3, v108, v108
    v_mul_f32 v4, v109, v109
    v_fmac_f32 v3, v110, v110
    v_fmac_f32 v4, v111, v111
    v_fmac_f32 v3, v112, v112
    v_fmac_f32 v4, v113, v113
    v_fmac_f32 v3, v114, v114
    buffer_load_dwordx4 v237, s[48:51], s1 offen offset:1024 lds
    v_fmac_f32 v4, v115, v115
    v_fmac_f32 v3, v116, v116
    v_fmac_f32 v4, v117, v117
    v_fmac_f32 v3, v118, v118
    v_fmac_f32 v4, v119, v119
    v_fmac_f32 v3, v120, v120
    v_fmac_f32 v4, v121, v121
    v_fmac_f32 v3, v122, v122
    v_fmac_f32 v4, v123, v123
    v_fmac_f32 v3, v124, v124
    v_fmac_f32 v4, v125, v125
    v_fmac_f32 v3, v126, v126
    v_fmac_f32 v4, v127, v127
    v_add_f32 v3, v3, v4
    s_nop 1
    v_add_f32 v3, v3, v3 row_ror:8 row_mask:0xf bank_mask:0xf
    buffer_load_dwordx4 v238, s[48:51], s1 offen offset:2048 lds
    s_nop 1
    v_add_f32 v3, v3, v3 row_ror:4 row_mask:0xf bank_mask:0xf
    s_nop 1
    v_add_f32 v3, v3, v3 row_ror:2 row_mask:0xf bank_mask:0xf
    s_nop 1
    v_add_f32 v3, v3, v3 row_ror:1 row_mask:0xf bank_mask:0xf
    v_mov_b32 v4, v3
    s_nop 1
    v_permlane16_swap_b32 v3, v4
    s_nop 1
    v_add_f32 v3, v3, v4
    v_mul_f32 v3, 0x3acccccd, v3
    v_cvt_pk_bf16_f32 v96, v2, v2
    v_lshlrev_b32 v96, 16, v96
    v_cvt_pk_bf16_f32 v3, v3, v3
    v_lshlrev_b32 v3, 16, v3
    buffer_load_dwordx4 v239, s[48:51], s1 offen offset:3072 lds
    v_add_f32 v3, 0x3727c5ac, v3
    v_cvt_pk_bf16_f32 v3, v3, v3
    v_lshlrev_b32 v3, 16, v3
    v_sqrt_f32 v3, v3
    s_nop 0
    v_cvt_pk_bf16_f32 v3, v3, v3
    v_lshlrev_b32 v3, 16, v3
    v_rcp_f32 v98, v3
    s_waitcnt lgkmcnt(0)
    v_lshlrev_b32 v196, 16, v172
    v_and_b32 v197, 0xffff0000, v172
    v_add_f32 v196, v196, v197
    v_add_f32 v146, v146, v196
    v_lshlrev_b32 v198, 16, v176
    v_and_b32 v199, 0xffff0000, v176
    v_add_f32 v198, v198, v199
    s_add_u32 s1, s101, 640
    s_add_u32 m0, s100, 106752
    s_nop 0
    buffer_load_dwordx4 v240, s[52:55], s1 offen offset:0 lds
    v_add_f32 v147, v147, v198
    v_lshlrev_b32 v196, 16, v180
    v_and_b32 v197, 0xffff0000, v180
    v_add_f32 v196, v196, v197
    v_add_f32 v148, v148, v196
    v_lshlrev_b32 v198, 16, v184
    v_and_b32 v199, 0xffff0000, v184
    v_add_f32 v198, v198, v199
    v_add_f32 v149, v149, v198
    v_lshlrev_b32 v196, 16, v173
    v_and_b32 v197, 0xffff0000, v173
    v_add_f32 v196, v196, v197
    v_add_f32 v146, v146, v196
    v_lshlrev_b32 v198, 16, v177
    v_and_b32 v199, 0xffff0000, v177
    v_add_f32 v198, v198, v199
    buffer_load_dwordx4 v241, s[52:55], s1 offen offset:1024 lds
    v_add_f32 v147, v147, v198
    v_lshlrev_b32 v196, 16, v181
    v_and_b32 v197, 0xffff0000, v181
    v_add_f32 v196, v196, v197
    v_add_f32 v148, v148, v196
    v_lshlrev_b32 v198, 16, v185
    v_and_b32 v199, 0xffff0000, v185
    v_add_f32 v198, v198, v199
    v_add_f32 v149, v149, v198
    v_lshlrev_b32 v196, 16, v174
    v_and_b32 v197, 0xffff0000, v174
    v_add_f32 v196, v196, v197
    v_add_f32 v146, v146, v196
    v_lshlrev_b32 v198, 16, v178
    v_and_b32 v199, 0xffff0000, v178
    v_add_f32 v198, v198, v199
    buffer_load_dwordx4 v242, s[52:55], s1 offen offset:2048 lds
    v_add_f32 v147, v147, v198
    v_lshlrev_b32 v196, 16, v182
    v_and_b32 v197, 0xffff0000, v182
    v_add_f32 v196, v196, v197
    v_add_f32 v148, v148, v196
    v_lshlrev_b32 v198, 16, v186
    v_and_b32 v199, 0xffff0000, v186
    v_add_f32 v198, v198, v199
    v_add_f32 v149, v149, v198
    v_lshlrev_b32 v196, 16, v175
    v_and_b32 v197, 0xffff0000, v175
    v_add_f32 v196, v196, v197
    v_add_f32 v146, v146, v196
    v_lshlrev_b32 v198, 16, v179
    v_and_b32 v199, 0xffff0000, v179
    v_add_f32 v198, v198, v199
    buffer_load_dwordx4 v243, s[52:55], s1 offen offset:3072 lds
    v_add_f32 v147, v147, v198
    v_lshlrev_b32 v196, 16, v183
    v_and_b32 v197, 0xffff0000, v183
    v_add_f32 v196, v196, v197
    v_add_f32 v148, v148, v196
    v_lshlrev_b32 v198, 16, v187
    v_and_b32 v199, 0xffff0000, v187
    v_add_f32 v198, v198, v199
    v_add_f32 v149, v149, v198
    buffer_load_dword v97, v101, s[76:79], 0 offen sc1
    s_waitcnt lgkmcnt(0)
    s_waitcnt vmcnt(16)
    s_barrier
    buffer_store_dwordx4 v[200:203], v0, s[60:63], s3 offen sc1
    s_mov_b64 exec, s[34:35]
    buffer_store_dwordx4 v[204:207], v0, s[60:63], s4 offen sc1
    s_mov_b64 exec, -1
    ds_read_b128 v[172:175], v151 offset:0
    ds_read_b128 v[176:179], v151 offset:1024
    ds_read_b128 v[180:183], v151 offset:2048
    ds_read_b128 v[184:187], v151 offset:3072
    s_add_u32 s1, s12, 768
    s_add_u32 m0, s13, 0
    s_nop 0
    buffer_load_dwordx4 v232, s[48:51], s1 offen offset:0 lds
    buffer_load_dwordx4 v233, s[48:51], s1 offen offset:1024 lds
    buffer_load_dwordx4 v234, s[48:51], s1 offen offset:2048 lds
    s_waitcnt lgkmcnt(0)
    v_lshlrev_b32 v196, 16, v172
    v_and_b32 v197, 0xffff0000, v172
    v_add_f32 v196, v196, v197
    v_add_f32 v146, v146, v196
    v_lshlrev_b32 v198, 16, v176
    v_and_b32 v199, 0xffff0000, v176
    buffer_load_dwordx4 v235, s[48:51], s1 offen offset:3072 lds
    v_add_f32 v198, v198, v199
    v_add_f32 v147, v147, v198
    v_lshlrev_b32 v196, 16, v180
    v_and_b32 v197, 0xffff0000, v180
    v_add_f32 v196, v196, v197
    v_add_f32 v148, v148, v196
    v_lshlrev_b32 v198, 16, v184
    s_add_u32 m0, s13, 4096
    s_nop 0
    buffer_load_dwordx4 v236, s[48:51], s1 offen offset:0 lds
    v_and_b32 v199, 0xffff0000, v184
    v_add_f32 v198, v198, v199
    v_add_f32 v149, v149, v198
    v_lshlrev_b32 v196, 16, v173
    v_and_b32 v197, 0xffff0000, v173
    v_add_f32 v196, v196, v197
    v_add_f32 v146, v146, v196
    buffer_load_dwordx4 v237, s[48:51], s1 offen offset:1024 lds
    v_lshlrev_b32 v198, 16, v177
    v_and_b32 v199, 0xffff0000, v177
    v_add_f32 v198, v198, v199
    v_add_f32 v147, v147, v198
    v_lshlrev_b32 v196, 16, v181
    v_and_b32 v197, 0xffff0000, v181
    v_add_f32 v196, v196, v197
    buffer_load_dwordx4 v238, s[48:51], s1 offen offset:2048 lds
    v_add_f32 v148, v148, v196
    v_lshlrev_b32 v198, 16, v185
    v_and_b32 v199, 0xffff0000, v185
    v_add_f32 v198, v198, v199
    v_add_f32 v149, v149, v198
    v_lshlrev_b32 v196, 16, v174
    v_and_b32 v197, 0xffff0000, v174
    buffer_load_dwordx4 v239, s[48:51], s1 offen offset:3072 lds
    v_add_f32 v196, v196, v197
    v_add_f32 v146, v146, v196
    v_lshlrev_b32 v198, 16, v178
    v_and_b32 v199, 0xffff0000, v178
    v_add_f32 v198, v198, v199
    v_add_f32 v147, v147, v198
    v_lshlrev_b32 v196, 16, v182
    s_add_u32 s1, s101, 768
    s_add_u32 m0, s100, 0
    s_nop 0
    buffer_load_dwordx4 v240, s[52:55], s1 offen offset:0 lds
    v_and_b32 v197, 0xffff0000, v182
    v_add_f32 v196, v196, v197
    v_add_f32 v148, v148, v196
    v_lshlrev_b32 v198, 16, v186
    v_and_b32 v199, 0xffff0000, v186
    v_add_f32 v198, v198, v199
    v_add_f32 v149, v149, v198
    buffer_load_dwordx4 v241, s[52:55], s1 offen offset:1024 lds
    v_lshlrev_b32 v196, 16, v175
    v_and_b32 v197, 0xffff0000, v175
    v_add_f32 v196, v196, v197
    v_add_f32 v146, v146, v196
    v_lshlrev_b32 v198, 16, v179
    v_and_b32 v199, 0xffff0000, v179
    v_add_f32 v198, v198, v199
    buffer_load_dwordx4 v242, s[52:55], s1 offen offset:2048 lds
    v_add_f32 v147, v147, v198
    v_lshlrev_b32 v196, 16, v183
    v_and_b32 v197, 0xffff0000, v183
    v_add_f32 v196, v196, v197
    v_add_f32 v148, v148, v196
    v_lshlrev_b32 v198, 16, v187
    v_and_b32 v199, 0xffff0000, v187
    buffer_load_dwordx4 v243, s[52:55], s1 offen offset:3072 lds
    v_add_f32 v198, v198, v199
    v_add_f32 v149, v149, v198
    s_mov_b32 s72, s32
    s_mov_b32 s73, s33
    s_mov_b32 s74, 0x500
    s_mov_b32 s75, 0x00020000
    s_lshl_b32 s81, s7, 2
    s_add_u32 s81, s81, s14
    s_lshl_b32 s81, s81, 4
    v_and_b32 v7, 15, v1
    v_add_u32 v7, s81, v7
    v_lshrrev_b32 v246, 4, v1
    v_lshlrev_b32 v246, 2, v246
    s_mul_i32 s81, s6, 80
    v_add_u32 v246, s81, v246
    v_mul_u32_u24 v247, 640, v7
    v_add_u32 v247, v247, v246
    v_lshlrev_b32 v247, 1, v247
    v_lshlrev_b32 v246, 1, v246
    v_lshlrev_b32 v7, 4, v7
    s_waitcnt vmcnt(15)
    s_barrier
    s_waitcnt vmcnt(14)
    s_mov_b32 s80, 0
parallel_sum__ssm_conv_s5__glu_gated_bilinear__prompt_kernel_hs_np:
    v_readfirstlane_b32 s15, v97
    s_nop 3
    s_cmp_lg_u32 s15, 0
    s_cbranch_scc1 parallel_sum__ssm_conv_s5__glu_gated_bilinear__prompt_kernel_hs_np_ok
    s_add_u32 s80, s80, 1
    s_cmp_lt_u32 s80, 0x20000
    s_cbranch_scc0 parallel_sum__ssm_conv_s5__glu_gated_bilinear__prompt_kernel_hs_np_ok
    buffer_load_dword v97, v101, s[76:79], 0 offen sc1
    s_waitcnt vmcnt(0)
    s_branch parallel_sum__ssm_conv_s5__glu_gated_bilinear__prompt_kernel_hs_np
parallel_sum__ssm_conv_s5__glu_gated_bilinear__prompt_kernel_hs_np_ok:
    v_mov_b32 v2, 0x27fc0
    ds_write_b32 v2, v97
    s_waitcnt vmcnt(12)
    v_mov_b32 v99, v97
    v_lshlrev_b32 v3, 4, v100
    s_mov_b32 exec_lo, 1
    s_mov_b32 exec_hi, 1
    buffer_store_dwordx4 v[96:99], v3, s[64:67], 0 offen sc1
    s_mov_b64 exec, -1
    ds_read_b128 v[172:175], v152 offset:0
    ds_read_b128 v[176:179], v152 offset:1024
    ds_read_b128 v[180:183], v152 offset:2048
    ds_read_b128 v[184:187], v152 offset:3072
    s_add_u32 s1, s12, 896
    s_add_u32 m0, s13, 53376
    s_nop 0
    buffer_load_dwordx4 v232, s[48:51], s1 offen offset:0 lds
    buffer_load_dwordx4 v233, s[48:51], s1 offen offset:1024 lds
    buffer_load_dwordx4 v234, s[48:51], s1 offen offset:2048 lds
    s_waitcnt lgkmcnt(0)
    v_lshlrev_b32 v196, 16, v172
    v_and_b32 v197, 0xffff0000, v172
    v_add_f32 v196, v196, v197
    v_add_f32 v146, v146, v196
    v_lshlrev_b32 v198, 16, v176
    v_and_b32 v199, 0xffff0000, v176
    buffer_load_dwordx4 v235, s[48:51], s1 offen offset:3072 lds
    v_add_f32 v198, v198, v199
    v_add_f32 v147, v147, v198
    v_lshlrev_b32 v196, 16, v180
    v_and_b32 v197, 0xffff0000, v180
    v_add_f32 v196, v196, v197
    v_add_f32 v148, v148, v196
    v_lshlrev_b32 v198, 16, v184
    s_add_u32 m0, s13, 57472
    s_nop 0
    buffer_load_dwordx4 v236, s[48:51], s1 offen offset:0 lds
    v_and_b32 v199, 0xffff0000, v184
    v_add_f32 v198, v198, v199
    v_add_f32 v149, v149, v198
    v_lshlrev_b32 v196, 16, v173
    v_and_b32 v197, 0xffff0000, v173
    v_add_f32 v196, v196, v197
    v_add_f32 v146, v146, v196
    buffer_load_dwordx4 v237, s[48:51], s1 offen offset:1024 lds
    v_lshlrev_b32 v198, 16, v177
    v_and_b32 v199, 0xffff0000, v177
    v_add_f32 v198, v198, v199
    v_add_f32 v147, v147, v198
    v_lshlrev_b32 v196, 16, v181
    v_and_b32 v197, 0xffff0000, v181
    v_add_f32 v196, v196, v197
    buffer_load_dwordx4 v238, s[48:51], s1 offen offset:2048 lds
    v_add_f32 v148, v148, v196
    v_lshlrev_b32 v198, 16, v185
    v_and_b32 v199, 0xffff0000, v185
    v_add_f32 v198, v198, v199
    v_add_f32 v149, v149, v198
    v_lshlrev_b32 v196, 16, v174
    v_and_b32 v197, 0xffff0000, v174
    buffer_load_dwordx4 v239, s[48:51], s1 offen offset:3072 lds
    v_add_f32 v196, v196, v197
    v_add_f32 v146, v146, v196
    v_lshlrev_b32 v198, 16, v178
    v_and_b32 v199, 0xffff0000, v178
    v_add_f32 v198, v198, v199
    v_add_f32 v147, v147, v198
    v_lshlrev_b32 v196, 16, v182
    s_add_u32 s1, s101, 896
    s_add_u32 m0, s100, 53376
    s_nop 0
    buffer_load_dwordx4 v240, s[52:55], s1 offen offset:0 lds
    v_and_b32 v197, 0xffff0000, v182
    v_add_f32 v196, v196, v197
    v_add_f32 v148, v148, v196
    v_lshlrev_b32 v198, 16, v186
    v_and_b32 v199, 0xffff0000, v186
    v_add_f32 v198, v198, v199
    v_add_f32 v149, v149, v198
    buffer_load_dwordx4 v241, s[52:55], s1 offen offset:1024 lds
    v_lshlrev_b32 v196, 16, v175
    v_and_b32 v197, 0xffff0000, v175
    v_add_f32 v196, v196, v197
    v_add_f32 v146, v146, v196
    v_lshlrev_b32 v198, 16, v179
    v_and_b32 v199, 0xffff0000, v179
    v_add_f32 v198, v198, v199
    buffer_load_dwordx4 v242, s[52:55], s1 offen offset:2048 lds
    v_add_f32 v147, v147, v198
    v_lshlrev_b32 v196, 16, v183
    v_and_b32 v197, 0xffff0000, v183
    v_add_f32 v196, v196, v197
    v_add_f32 v148, v148, v196
    v_lshlrev_b32 v198, 16, v187
    v_and_b32 v199, 0xffff0000, v187
    buffer_load_dwordx4 v243, s[52:55], s1 offen offset:3072 lds
    v_add_f32 v198, v198, v199
    v_add_f32 v149, v149, v198
    s_lshr_b32 s80, s2, 5
    s_bfe_u32 s81, s2, 0x20003
    s_mul_i32 s80, s80, 3
    s_lshr_b32 s4, s80, 1
    s_sub_u32 s80, s4, 13
    s_cmp_ge_u32 s4, 13
    s_cselect_b32 s4, s80, s4
    s_lshl_b32 s4, s4, 12
    s_lshl_b32 s3, s6, 2
    s_add_u32 s3, s3, s14
    s_mul_i32 s3, s3, 51200
    s_mov_b32 s80, 0
    s_sub_u32 s81, s80, 5
    s_cmp_ge_u32 s80, 5
    s_cselect_b32 s80, s81, s80
    s_sub_u32 s81, s80, 5
    s_cmp_ge_u32 s80, 5
    s_cselect_b32 s80, s81, s80
    s_lshl_b32 s16, s80, 12
    s_mul_i32 s21, s80, 10240
    s_add_u32 s21, s21, s3
    s_add_u32 s80, s80, 1
    s_cmp_eq_u32 s80, 5
    s_cselect_b32 s80, 0, s80
    s_lshl_b32 s17, s80, 12
    s_mul_i32 s22, s80, 10240
    s_add_u32 s22, s22, s3
    s_add_u32 s80, s80, 1
    s_cmp_eq_u32 s80, 5
    s_cselect_b32 s80, 0, s80
    s_lshl_b32 s18, s80, 12
    s_mul_i32 s23, s80, 10240
    s_add_u32 s23, s23, s3
    s_add_u32 s80, s80, 1
    s_cmp_eq_u32 s80, 5
    s_cselect_b32 s80, 0, s80
    s_lshl_b32 s19, s80, 12
    s_mul_i32 s24, s80, 10240
    s_add_u32 s24, s24, s3
    s_add_u32 s80, s80, 1
    s_cmp_eq_u32 s80, 5
    s_cselect_b32 s80, 0, s80
    s_lshl_b32 s20, s80, 12
    s_mul_i32 s25, s80, 10240
    s_add_u32 s25, s25, s3
    s_waitcnt lgkmcnt(0)
    s_waitcnt vmcnt(13)
    s_barrier
    ds_read_b128 v[172:175], v150 offset:0
    ds_read_b128 v[176:179], v150 offset:1024
    ds_read_b128 v[180:183], v150 offset:2048
    ds_read_b128 v[184:187], v150 offset:3072
    s_add_u32 s1, s12, 1024
    s_add_u32 m0, s13, 106752
    s_nop 0
    buffer_load_dwordx4 v232, s[48:51], s1 offen offset:0 lds
    buffer_load_dwordx4 v233, s[48:51], s1 offen offset:1024 lds
    buffer_load_dwordx4 v234, s[48:51], s1 offen offset:2048 lds
    s_waitcnt lgkmcnt(0)
    v_lshlrev_b32 v196, 16, v172
    v_and_b32 v197, 0xffff0000, v172
    v_add_f32 v196, v196, v197
    v_add_f32 v146, v146, v196
    v_lshlrev_b32 v198, 16, v176
    v_and_b32 v199, 0xffff0000, v176
    buffer_load_dwordx4 v235, s[48:51], s1 offen offset:3072 lds
    v_add_f32 v198, v198, v199
    v_add_f32 v147, v147, v198
    v_lshlrev_b32 v196, 16, v180
    v_and_b32 v197, 0xffff0000, v180
    v_add_f32 v196, v196, v197
    v_add_f32 v148, v148, v196
    v_lshlrev_b32 v198, 16, v184
    s_add_u32 m0, s13, 110848
    s_nop 0
    buffer_load_dwordx4 v236, s[48:51], s1 offen offset:0 lds
    v_and_b32 v199, 0xffff0000, v184
    v_add_f32 v198, v198, v199
    v_add_f32 v149, v149, v198
    v_lshlrev_b32 v196, 16, v173
    v_and_b32 v197, 0xffff0000, v173
    v_add_f32 v196, v196, v197
    v_add_f32 v146, v146, v196
    buffer_load_dwordx4 v237, s[48:51], s1 offen offset:1024 lds
    v_lshlrev_b32 v198, 16, v177
    v_and_b32 v199, 0xffff0000, v177
    v_add_f32 v198, v198, v199
    v_add_f32 v147, v147, v198
    v_lshlrev_b32 v196, 16, v181
    v_and_b32 v197, 0xffff0000, v181
    v_add_f32 v196, v196, v197
    buffer_load_dwordx4 v238, s[48:51], s1 offen offset:2048 lds
    v_add_f32 v148, v148, v196
    v_lshlrev_b32 v198, 16, v185
    v_and_b32 v199, 0xffff0000, v185
    v_add_f32 v198, v198, v199
    v_add_f32 v149, v149, v198
    v_lshlrev_b32 v196, 16, v174
    v_and_b32 v197, 0xffff0000, v174
    buffer_load_dwordx4 v239, s[48:51], s1 offen offset:3072 lds
    v_add_f32 v196, v196, v197
    v_add_f32 v146, v146, v196
    v_lshlrev_b32 v198, 16, v178
    v_and_b32 v199, 0xffff0000, v178
    v_add_f32 v198, v198, v199
    v_add_f32 v147, v147, v198
    v_lshlrev_b32 v196, 16, v182
    s_add_u32 s1, s101, 1024
    s_add_u32 m0, s100, 106752
    s_nop 0
    buffer_load_dwordx4 v240, s[52:55], s1 offen offset:0 lds
    v_and_b32 v197, 0xffff0000, v182
    v_add_f32 v196, v196, v197
    v_add_f32 v148, v148, v196
    v_lshlrev_b32 v198, 16, v186
    v_and_b32 v199, 0xffff0000, v186
    v_add_f32 v198, v198, v199
    v_add_f32 v149, v149, v198
    buffer_load_dwordx4 v241, s[52:55], s1 offen offset:1024 lds
    v_lshlrev_b32 v196, 16, v175
    v_and_b32 v197, 0xffff0000, v175
    v_add_f32 v196, v196, v197
    v_add_f32 v146, v146, v196
    v_lshlrev_b32 v198, 16, v179
    v_and_b32 v199, 0xffff0000, v179
    v_add_f32 v198, v198, v199
    buffer_load_dwordx4 v242, s[52:55], s1 offen offset:2048 lds
    v_add_f32 v147, v147, v198
    v_lshlrev_b32 v196, 16, v183
    v_and_b32 v197, 0xffff0000, v183
    v_add_f32 v196, v196, v197
    v_add_f32 v148, v148, v196
    v_lshlrev_b32 v198, 16, v187
    v_and_b32 v199, 0xffff0000, v187
    buffer_load_dwordx4 v243, s[52:55], s1 offen offset:3072 lds
    v_add_f32 v198, v198, v199
    v_add_f32 v149, v149, v198
    s_waitcnt vmcnt(12)
    s_barrier
    s_lshl_b32 s80, s6, 8
    s_lshl_b32 s81, s14, 6
    s_add_u32 s80, s80, s81
    v_add_u32 v4, s80, v1
    v_lshlrev_b32 v4, 4, v4
    s_mul_i32 s9, s7, 20480
    s_add_u32 s9, s9, 0x10000
    s_lshl_b32 s81, s14, 5
    v_and_b32 v5, 31, v1
    v_add_u32 v5, s81, v5
    v_lshlrev_b32 v6, 3, v5
    buffer_load_dwordx4 v[168:171], v4, s[64:67], 0 offen sc1
    buffer_load_dwordx4 v[228:231], v7, s[64:67], 0 offen sc1
    ds_read_b128 v[172:175], v151 offset:0
    ds_read_b128 v[176:179], v151 offset:1024
    ds_read_b128 v[180:183], v151 offset:2048
    ds_read_b128 v[184:187], v151 offset:3072
    s_add_u32 s1, s12, 1152
    s_add_u32 m0, s13, 0
    s_nop 0
    buffer_load_dwordx4 v232, s[48:51], s1 offen offset:0 lds
    buffer_load_dwordx4 v233, s[48:51], s1 offen offset:1024 lds
    buffer_load_dwordx4 v234, s[48:51], s1 offen offset:2048 lds
    s_waitcnt lgkmcnt(0)
    v_lshlrev_b32 v196, 16, v172
    v_and_b32 v197, 0xffff0000, v172
    v_add_f32 v196, v196, v197
    v_add_f32 v146, v146, v196
    v_lshlrev_b32 v198, 16, v176
    v_and_b32 v199, 0xffff0000, v176
    buffer_load_dwordx4 v235, s[48:51], s1 offen offset:3072 lds
    v_add_f32 v198, v198, v199
    v_add_f32 v147, v147, v198
    v_lshlrev_b32 v196, 16, v180
    v_and_b32 v197, 0xffff0000, v180
    v_add_f32 v196, v196, v197
    v_add_f32 v148, v148, v196
    v_lshlrev_b32 v198, 16, v184
    s_add_u32 m0, s13, 4096
    s_nop 0
    buffer_load_dwordx4 v236, s[48:51], s1 offen offset:0 lds
    v_and_b32 v199, 0xffff0000, v184
    v_add_f32 v198, v198, v199
    v_add_f32 v149, v149, v198
    v_lshlrev_b32 v196, 16, v173
    v_and_b32 v197, 0xffff0000, v173
    v_add_f32 v196, v196, v197
    v_add_f32 v146, v146, v196
    buffer_load_dwordx4 v237, s[48:51], s1 offen offset:1024 lds
    v_lshlrev_b32 v198, 16, v177
    v_and_b32 v199, 0xffff0000, v177
    v_add_f32 v198, v198, v199
    v_add_f32 v147, v147, v198
    v_lshlrev_b32 v196, 16, v181
    v_and_b32 v197, 0xffff0000, v181
    v_add_f32 v196, v196, v197
    buffer_load_dwordx4 v238, s[48:51], s1 offen offset:2048 lds
    v_add_f32 v148, v148, v196
    v_lshlrev_b32 v198, 16, v185
    v_and_b32 v199, 0xffff0000, v185
    v_add_f32 v198, v198, v199
    v_add_f32 v149, v149, v198
    v_lshlrev_b32 v196, 16, v174
    v_and_b32 v197, 0xffff0000, v174
    buffer_load_dwordx4 v239, s[48:51], s1 offen offset:3072 lds
    v_add_f32 v196, v196, v197
    v_add_f32 v146, v146, v196
    v_lshlrev_b32 v198, 16, v178
    v_and_b32 v199, 0xffff0000, v178
    v_add_f32 v198, v198, v199
    v_add_f32 v147, v147, v198
    v_lshlrev_b32 v196, 16, v182
    s_add_u32 s1, s101, 1152
    s_add_u32 m0, s100, 0
    s_nop 0
    buffer_load_dwordx4 v240, s[52:55], s1 offen offset:0 lds
    v_and_b32 v197, 0xffff0000, v182
    v_add_f32 v196, v196, v197
    v_add_f32 v148, v148, v196
    v_lshlrev_b32 v198, 16, v186
    v_and_b32 v199, 0xffff0000, v186
    v_add_f32 v198, v198, v199
    v_add_f32 v149, v149, v198
    buffer_load_dwordx4 v241, s[52:55], s1 offen offset:1024 lds
    v_lshlrev_b32 v196, 16, v175
    v_and_b32 v197, 0xffff0000, v175
    v_add_f32 v196, v196, v197
    v_add_f32 v146, v146, v196
    v_lshlrev_b32 v198, 16, v179
    v_and_b32 v199, 0xffff0000, v179
    v_add_f32 v198, v198, v199
    buffer_load_dwordx4 v242, s[52:55], s1 offen offset:2048 lds
    v_add_f32 v147, v147, v198
    v_lshlrev_b32 v196, 16, v183
    v_and_b32 v197, 0xffff0000, v183
    v_add_f32 v196, v196, v197
    v_add_f32 v148, v148, v196
    v_lshlrev_b32 v198, 16, v187
    v_and_b32 v199, 0xffff0000, v187
    buffer_load_dwordx4 v243, s[52:55], s1 offen offset:3072 lds
    v_add_f32 v198, v198, v199
    v_add_f32 v149, v149, v198
    s_add_u32 s80, s11, 0x0
    v_add_u32 v242, s80, v0
    s_add_u32 s80, s11, 0xa000
    v_add_u32 v243, s80, v0
    s_add_u32 s80, s11, 0x14000
    v_add_u32 v244, s80, v0
    s_add_u32 s80, s11, 0x1e000
    v_add_u32 v245, s80, v0
    s_waitcnt vmcnt(14)
    s_barrier
    s_mov_b32 s80, 0
    s_waitcnt vmcnt(12)
parallel_sum__ssm_conv_s5__glu_gated_bilinear__prompt_kernel_hs_gp:
    v_xor_b32 v2, s15, v169
    v_xor_b32 v3, s15, v171
    v_or_b32 v2, v2, v3
    v_xor_b32 v3, s15, v229
    v_or_b32 v2, v2, v3
    v_xor_b32 v3, s15, v231
    v_or_b32 v2, v2, v3
    v_cmp_ne_u32 vcc, 0, v2
    s_cmp_eq_u64 vcc, 0
    s_cbranch_scc1 parallel_sum__ssm_conv_s5__glu_gated_bilinear__prompt_kernel_hs_gp_ok
    s_add_u32 s80, s80, 1
    s_cmp_lt_u32 s80, 0x20000
    s_cbranch_scc0 parallel_sum__ssm_conv_s5__glu_gated_bilinear__prompt_kernel_hs_gp_ok
    s_sleep 2
    buffer_load_dwordx4 v[168:171], v4, s[64:67], 0 offen sc1
    buffer_load_dwordx4 v[228:231], v7, s[64:67], 0 offen sc1
    s_waitcnt vmcnt(0)
    s_branch parallel_sum__ssm_conv_s5__glu_gated_bilinear__prompt_kernel_hs_gp
parallel_sum__ssm_conv_s5__glu_gated_bilinear__prompt_kernel_hs_gp_ok:
    ds_read_b128 v[172:175], v152 offset:0
    ds_read_b128 v[176:179], v152 offset:1024
    ds_read_b128 v[180:183], v152 offset:2048
    ds_read_b128 v[184:187], v152 offset:3072
    s_add_u32 s82, s4, 0
    s_sub_u32 s83, s82, 53248
    s_cmp_ge_u32 s82, 53248
    s_cselect_b32 s82, s83, s82
    s_mul_i32 s82, s82, 5
    s_add_u32 s82, s82, s10
    s_add_u32 m0, s11, 61440
    s_nop 0
    buffer_load_dwordx4 v248, s[60:63], s82 offen offset:0 sc1 lds
    buffer_load_dwordx4 v249, s[60:63], s82 offen offset:1024 sc1 lds
    buffer_load_dwordx4 v250, s[60:63], s82 offen offset:2048 sc1 lds
    buffer_load_dwordx4 v251, s[60:63], s82 offen offset:3072 sc1 lds
    s_add_u32 m0, s11, 65536
    s_nop 0
    buffer_load_dwordx4 v252, s[60:63], s82 offen offset:0 sc1 lds
    s_add_u32 s82, s4, 4096
    s_sub_u32 s83, s82, 53248
    s_cmp_ge_u32 s82, 53248
    s_cselect_b32 s82, s83, s82
    s_mul_i32 s82, s82, 5
    s_add_u32 s82, s82, s10
    s_add_u32 m0, s11, 81920
    s_nop 0
    buffer_load_dwordx4 v248, s[60:63], s82 offen offset:0 sc1 lds
    buffer_load_dwordx4 v249, s[60:63], s82 offen offset:1024 sc1 lds
    buffer_load_dwordx4 v250, s[60:63], s82 offen offset:2048 sc1 lds
    buffer_load_dwordx4 v251, s[60:63], s82 offen offset:3072 sc1 lds
    s_add_u32 m0, s11, 86016
    s_nop 0
    buffer_load_dwordx4 v252, s[60:63], s82 offen offset:0 sc1 lds
    s_waitcnt lgkmcnt(0)
    v_lshlrev_b32 v196, 16, v172
    v_and_b32 v197, 0xffff0000, v172
    v_add_f32 v196, v196, v197
    v_add_f32 v146, v146, v196
    v_lshlrev_b32 v198, 16, v176
    v_and_b32 v199, 0xffff0000, v176
    v_add_f32 v198, v198, v199
    v_add_f32 v147, v147, v198
    v_lshlrev_b32 v196, 16, v180
    v_and_b32 v197, 0xffff0000, v180
    v_add_f32 v196, v196, v197
    v_add_f32 v148, v148, v196
    v_lshlrev_b32 v198, 16, v184
    v_and_b32 v199, 0xffff0000, v184
    v_add_f32 v198, v198, v199
    v_add_f32 v149, v149, v198
    v_lshlrev_b32 v196, 16, v173
    v_and_b32 v197, 0xffff0000, v173
    v_add_f32 v196, v196, v197
    v_add_f32 v146, v146, v196
    v_lshlrev_b32 v198, 16, v177
    v_and_b32 v199, 0xffff0000, v177
    v_add_f32 v198, v198, v199
    v_add_f32 v147, v147, v198
    v_lshlrev_b32 v196, 16, v181
    v_and_b32 v197, 0xffff0000, v181
    v_add_f32 v196, v196, v197
    v_add_f32 v148, v148, v196
    v_lshlrev_b32 v198, 16, v185
    v_and_b32 v199, 0xffff0000, v185
    v_add_f32 v198, v198, v199
    v_add_f32 v149, v149, v198
    v_lshlrev_b32 v196, 16, v174
    v_and_b32 v197, 0xffff0000, v174
    v_add_f32 v196, v196, v197
    v_add_f32 v146, v146, v196
    v_lshlrev_b32 v198, 16, v178
    v_and_b32 v199, 0xffff0000, v178
    v_add_f32 v198, v198, v199
    v_add_f32 v147, v147, v198
    v_lshlrev_b32 v196, 16, v182
    v_and_b32 v197, 0xffff0000, v182
    v_add_f32 v196, v196, v197
    v_add_f32 v148, v148, v196
    v_lshlrev_b32 v198, 16, v186
    v_and_b32 v199, 0xffff0000, v186
    v_add_f32 v198, v198, v199
    v_add_f32 v149, v149, v198
    v_lshlrev_b32 v196, 16, v175
    v_and_b32 v197, 0xffff0000, v175
    v_add_f32 v196, v196, v197
    v_add_f32 v146, v146, v196
    v_lshlrev_b32 v198, 16, v179
    v_and_b32 v199, 0xffff0000, v179
    v_add_f32 v198, v198, v199
    v_add_f32 v147, v147, v198
    v_lshlrev_b32 v196, 16, v183
    v_and_b32 v197, 0xffff0000, v183
    v_add_f32 v196, v196, v197
    v_add_f32 v148, v148, v196
    v_lshlrev_b32 v198, 16, v187
    v_and_b32 v199, 0xffff0000, v187
    v_add_f32 v198, v198, v199
    v_add_f32 v149, v149, v198
    s_lshl_b32 s81, s14, 6
    v_and_b32 v5, 32, v1
    v_bfe_u32 v4, v1, 3, 1
    v_lshl_or_b32 v5, v4, 4, v5
    v_and_b32 v4, 7, v1
    v_lshl_or_b32 v5, v4, 1, v5
    v_bfe_u32 v4, v1, 4, 1
    v_or_b32 v5, v5, v4
    v_add_u32 v5, s81, v5
    v_lshlrev_b32 v5, 2, v5
    v_add_u32 v5, 0xd080, v5
    ds_write_b32 v5, v168
    ds_write_b32 v5, v170 offset:1024
    s_waitcnt lgkmcnt(0)
    s_waitcnt vmcnt(10)
    s_barrier
    ds_read_b128 v[172:175], v150 offset:0
    ds_read_b128 v[176:179], v150 offset:1024
    ds_read_b128 v[180:183], v150 offset:2048
    ds_read_b128 v[184:187], v150 offset:3072
    s_add_u32 s82, s4, 8192
    s_sub_u32 s83, s82, 53248
    s_cmp_ge_u32 s82, 53248
    s_cselect_b32 s82, s83, s82
    s_mul_i32 s82, s82, 5
    s_add_u32 s82, s82, s10
    s_add_u32 m0, s11, 102400
    s_nop 0
    buffer_load_dwordx4 v248, s[60:63], s82 offen offset:0 sc1 lds
    buffer_load_dwordx4 v249, s[60:63], s82 offen offset:1024 sc1 lds
    buffer_load_dwordx4 v250, s[60:63], s82 offen offset:2048 sc1 lds
    buffer_load_dwordx4 v251, s[60:63], s82 offen offset:3072 sc1 lds
    s_add_u32 m0, s11, 106496
    s_nop 0
    buffer_load_dwordx4 v252, s[60:63], s82 offen offset:0 sc1 lds
    s_add_u32 s82, s4, 12288
    s_sub_u32 s83, s82, 53248
    s_cmp_ge_u32 s82, 53248
    s_cselect_b32 s82, s83, s82
    s_mul_i32 s82, s82, 5
    s_add_u32 s82, s82, s10
    s_add_u32 m0, s11, 122880
    s_nop 0
    buffer_load_dwordx4 v248, s[60:63], s82 offen offset:0 sc1 lds
    buffer_load_dwordx4 v249, s[60:63], s82 offen offset:1024 sc1 lds
    buffer_load_dwordx4 v250, s[60:63], s82 offen offset:2048 sc1 lds
    buffer_load_dwordx4 v251, s[60:63], s82 offen offset:3072 sc1 lds
    s_add_u32 m0, s11, 126976
    s_nop 0
    buffer_load_dwordx4 v252, s[60:63], s82 offen offset:0 sc1 lds
    s_waitcnt lgkmcnt(0)
    v_lshlrev_b32 v196, 16, v172
    v_and_b32 v197, 0xffff0000, v172
    v_add_f32 v196, v196, v197
    v_add_f32 v146, v146, v196
    v_lshlrev_b32 v198, 16, v176
    v_and_b32 v199, 0xffff0000, v176
    v_add_f32 v198, v198, v199
    v_add_f32 v147, v147, v198
    v_lshlrev_b32 v196, 16, v180
    v_and_b32 v197, 0xffff0000, v180
    v_add_f32 v196, v196, v197
    v_add_f32 v148, v148, v196
    v_lshlrev_b32 v198, 16, v184
    v_and_b32 v199, 0xffff0000, v184
    v_add_f32 v198, v198, v199
    v_add_f32 v149, v149, v198
    v_lshlrev_b32 v196, 16, v173
    v_and_b32 v197, 0xffff0000, v173
    v_add_f32 v196, v196, v197
    v_add_f32 v146, v146, v196
    v_lshlrev_b32 v198, 16, v177
    v_and_b32 v199, 0xffff0000, v177
    v_add_f32 v198, v198, v199
    v_add_f32 v147, v147, v198
    v_lshlrev_b32 v196, 16, v181
    v_and_b32 v197, 0xffff0000, v181
    v_add_f32 v196, v196, v197
    v_add_f32 v148, v148, v196
    v_lshlrev_b32 v198, 16, v185
    v_and_b32 v199, 0xffff0000, v185
    v_add_f32 v198, v198, v199
    v_add_f32 v149, v149, v198
    v_lshlrev_b32 v196, 16, v174
    v_and_b32 v197, 0xffff0000, v174
    v_add_f32 v196, v196, v197
    v_add_f32 v146, v146, v196
    v_lshlrev_b32 v198, 16, v178
    v_and_b32 v199, 0xffff0000, v178
    v_add_f32 v198, v198, v199
    v_add_f32 v147, v147, v198
    v_lshlrev_b32 v196, 16, v182
    v_and_b32 v197, 0xffff0000, v182
    v_add_f32 v196, v196, v197
    v_add_f32 v148, v148, v196
    v_lshlrev_b32 v198, 16, v186
    v_and_b32 v199, 0xffff0000, v186
    v_add_f32 v198, v198, v199
    v_add_f32 v149, v149, v198
    v_lshlrev_b32 v196, 16, v175
    v_and_b32 v197, 0xffff0000, v175
    v_add_f32 v196, v196, v197
    v_add_f32 v146, v146, v196
    v_lshlrev_b32 v198, 16, v179
    v_and_b32 v199, 0xffff0000, v179
    v_add_f32 v198, v198, v199
    v_add_f32 v147, v147, v198
    v_lshlrev_b32 v196, 16, v183
    v_and_b32 v197, 0xffff0000, v183
    v_add_f32 v196, v196, v197
    v_add_f32 v148, v148, v196
    v_lshlrev_b32 v198, 16, v187
    v_and_b32 v199, 0xffff0000, v187
    v_add_f32 v198, v198, v199
    v_add_f32 v149, v149, v198
    s_nop 2
    v_add_f32 v146, v146, v146 quad_perm:[1,0,3,2] row_mask:0xf bank_mask:0xf
    v_add_f32 v147, v147, v147 quad_perm:[1,0,3,2] row_mask:0xf bank_mask:0xf
    v_add_f32 v148, v148, v148 quad_perm:[1,0,3,2] row_mask:0xf bank_mask:0xf
    v_add_f32 v149, v149, v149 quad_perm:[1,0,3,2] row_mask:0xf bank_mask:0xf
    s_nop 1
    v_add_f32 v146, v146, v146 quad_perm:[2,3,0,1] row_mask:0xf bank_mask:0xf
    v_add_f32 v147, v147, v147 quad_perm:[2,3,0,1] row_mask:0xf bank_mask:0xf
    v_add_f32 v148, v148, v148 quad_perm:[2,3,0,1] row_mask:0xf bank_mask:0xf
    v_add_f32 v149, v149, v149 quad_perm:[2,3,0,1] row_mask:0xf bank_mask:0xf
    s_nop 1
    v_add_f32 v146, v146, v146 row_half_mirror row_mask:0xf bank_mask:0xf
    v_add_f32 v147, v147, v147 row_half_mirror row_mask:0xf bank_mask:0xf
    v_add_f32 v148, v148, v148 row_half_mirror row_mask:0xf bank_mask:0xf
    v_add_f32 v149, v149, v149 row_half_mirror row_mask:0xf bank_mask:0xf
    s_nop 1
    s_lshl_b32 s80, s14, 7
    s_add_u32 s80, s80, 0xd880
    v_lshrrev_b32 v196, 1, v1
    v_add_u32 v196, s80, v196
    s_mov_b32 exec_lo, 0x01010101
    s_mov_b32 exec_hi, 0x01010101
    ds_write_b32 v196, v146 offset:0
    ds_write_b32 v196, v147 offset:32
    ds_write_b32 v196, v148 offset:64
    ds_write_b32 v196, v149 offset:96
    s_mov_b64 exec, -1
    s_waitcnt lgkmcnt(0)
    s_add_u32 s82, s4, 16384
    s_sub_u32 s83, s82, 53248
    s_cmp_ge_u32 s82, 53248
    s_cselect_b32 s82, s83, s82
    s_mul_i32 s82, s82, 5
    s_add_u32 s82, s82, s10
    s_add_u32 m0, s11, 143360
    s_nop 0
    buffer_load_dwordx4 v248, s[60:63], s82 offen offset:0 sc1 lds
    buffer_load_dwordx4 v249, s[60:63], s82 offen offset:1024 sc1 lds
    buffer_load_dwordx4 v250, s[60:63], s82 offen offset:2048 sc1 lds
    buffer_load_dwordx4 v251, s[60:63], s82 offen offset:3072 sc1 lds
    s_add_u32 m0, s11, 147456
    s_nop 0
    buffer_load_dwordx4 v252, s[60:63], s82 offen offset:0 sc1 lds
    v_and_b32 v2, 31, v1
    v_lshlrev_b32 v2, 2, v2
    s_lshl_b32 s9, s7, 8
    s_add_u32 s9, s9, 0xe0000
    s_lshl_b32 s0, s7, 2
    s_mul_i32 s0, s0, 96256
    s_lshr_b32 s80, s14, 1
    s_mul_i32 s80, s80, 20480
    s_add_u32 s0, s0, s80
    s_and_b32 s80, s14, 1
    s_lshl_b32 s81, s80, 11
    s_add_u32 s0, s0, s81
    v_lshrrev_b32 v3, 4, v1
    v_bfe_u32 v4, v1, 1, 2
    v_add_u32 v3, v3, v4
    v_lshlrev_b32 v3, 4, v3
    v_and_b32 v4, 15, v1
    v_mul_u32_u24 v4, 320, v4
    v_add_u32 v3, v3, v4
    s_add_u32 s80, s11, 0x14000
    v_add_u32 v3, s80, v3
    s_add_u32 s81, s14, 0
    s_and_b32 s81, s81, 3
    s_mul_i32 s80, s81, 96256
    s_add_u32 s8, s0, s80
    s_mul_i32 s80, s81, 20480
    v_add_u32 v4, s80, v3
    s_add_u32 s81, s14, 1
    s_and_b32 s81, s81, 3
    s_mul_i32 s80, s81, 96256
    s_add_u32 s12, s0, s80
    s_mul_i32 s80, s81, 20480
    v_add_u32 v5, s80, v3
    s_add_u32 s81, s14, 2
    s_and_b32 s81, s81, 3
    s_mul_i32 s80, s81, 96256
    s_add_u32 s13, s0, s80
    s_mul_i32 s80, s81, 20480
    v_add_u32 v6, s80, v3
    s_add_u32 s81, s14, 3
    s_and_b32 s81, s81, 3
    s_mul_i32 s80, s81, 96256
    s_add_u32 s100, s0, s80
    s_mul_i32 s80, s81, 20480
    v_add_u32 v7, s80, v3
    s_waitcnt lgkmcnt(0)
    s_barrier
    buffer_load_dwordx2 v[208:209], v247, s[48:51], 0 offen offset:0
    buffer_load_dwordx2 v[218:219], v246, s[72:75], 0 offen offset:0
    buffer_load_dwordx2 v[210:211], v247, s[48:51], 0 offen offset:32
    buffer_load_dwordx2 v[220:221], v246, s[72:75], 0 offen offset:32
    buffer_load_dwordx2 v[212:213], v247, s[48:51], 0 offen offset:64
    buffer_load_dwordx2 v[222:223], v246, s[72:75], 0 offen offset:64
    buffer_load_dwordx2 v[214:215], v247, s[48:51], 0 offen offset:96
    buffer_load_dwordx2 v[224:225], v246, s[72:75], 0 offen offset:96
    buffer_load_dwordx2 v[216:217], v247, s[48:51], 0 offen offset:128
    buffer_load_dwordx2 v[226:227], v246, s[72:75], 0 offen offset:128
    s_add_u32 s82, s4, 32768
    s_sub_u32 s83, s82, 53248
    s_cmp_ge_u32 s82, 53248
    s_cselect_b32 s82, s83, s82
    s_mul_i32 s82, s82, 5
    s_add_u32 s82, s82, s10
    buffer_load_dwordx4 v[88:91], v248, s[60:63], s82 offen offset:0 sc1
    buffer_load_dwordx4 v[92:95], v249, s[60:63], s82 offen offset:1024 sc1
    buffer_load_dwordx4 v[96:99], v250, s[60:63], s82 offen offset:2048 sc1
    buffer_load_dwordx4 v[100:103], v251, s[60:63], s82 offen offset:3072 sc1
    buffer_load_dwordx4 v[104:107], v252, s[60:63], s82 offen offset:0 sc1
    s_barrier
    s_add_u32 s82, s4, 36864
    s_sub_u32 s83, s82, 53248
    s_cmp_ge_u32 s82, 53248
    s_cselect_b32 s82, s83, s82
    s_mul_i32 s82, s82, 5
    s_add_u32 s82, s82, s10
    buffer_load_dwordx4 v[108:111], v248, s[60:63], s82 offen offset:0 sc1
    buffer_load_dwordx4 v[112:115], v249, s[60:63], s82 offen offset:1024 sc1
    buffer_load_dwordx4 v[116:119], v250, s[60:63], s82 offen offset:2048 sc1
    buffer_load_dwordx4 v[120:123], v251, s[60:63], s82 offen offset:3072 sc1
    buffer_load_dwordx4 v[124:127], v252, s[60:63], s82 offen offset:0 sc1
    s_add_u32 s82, s4, 40960
    s_sub_u32 s83, s82, 53248
    s_cmp_ge_u32 s82, 53248
    s_cselect_b32 s82, s83, s82
    s_mul_i32 s82, s82, 5
    s_add_u32 s82, s82, s10
    buffer_load_dwordx4 v[188:191], v248, s[60:63], s82 offen offset:0 sc1
    buffer_load_dwordx4 v[192:195], v249, s[60:63], s82 offen offset:1024 sc1
    buffer_load_dwordx4 v[196:199], v250, s[60:63], s82 offen offset:2048 sc1
    buffer_load_dwordx4 v[200:203], v251, s[60:63], s82 offen offset:3072 sc1
    buffer_load_dwordx4 v[204:207], v252, s[60:63], s82 offen offset:0 sc1
    s_add_u32 s82, s4, 45056
    s_sub_u32 s83, s82, 53248
    s_cmp_ge_u32 s82, 53248
    s_cselect_b32 s82, s83, s82
    s_mul_i32 s82, s82, 5
    s_add_u32 s82, s82, s10
    buffer_load_dwordx4 v[168:171], v248, s[60:63], s82 offen offset:0 sc1
    buffer_load_dwordx4 v[172:175], v249, s[60:63], s82 offen offset:1024 sc1
    buffer_load_dwordx4 v[176:179], v250, s[60:63], s82 offen offset:2048 sc1
    buffer_load_dwordx4 v[180:183], v251, s[60:63], s82 offen offset:3072 sc1
    buffer_load_dwordx4 v[184:187], v252, s[60:63], s82 offen offset:0 sc1
    s_barrier
    s_add_u32 s82, s4, 49152
    s_sub_u32 s83, s82, 53248
    s_cmp_ge_u32 s82, 53248
    s_cselect_b32 s82, s83, s82
    s_mul_i32 s82, s82, 5
    s_add_u32 s82, s82, s10
    buffer_load_dwordx4 v[148:151], v248, s[60:63], s82 offen offset:0 sc1
    buffer_load_dwordx4 v[152:155], v249, s[60:63], s82 offen offset:1024 sc1
    buffer_load_dwordx4 v[156:159], v250, s[60:63], s82 offen offset:2048 sc1
    buffer_load_dwordx4 v[160:163], v251, s[60:63], s82 offen offset:3072 sc1
    buffer_load_dwordx4 v[164:167], v252, s[60:63], s82 offen offset:0 sc1
    s_add_u32 s80, s21, 0
    buffer_load_dwordx4 v[8:11], v0, s[60:63], s80 offen offset:0 sc1
    buffer_load_dwordx4 v[12:15], v0, s[60:63], s80 offen offset:1024 sc1
    buffer_load_dwordx4 v[16:19], v0, s[60:63], s80 offen offset:2048 sc1
    buffer_load_dwordx4 v[20:23], v0, s[60:63], s80 offen offset:3072 sc1
    s_add_u32 s80, s21, 4096
    buffer_load_dwordx4 v[24:27], v0, s[60:63], s80 offen offset:0 sc1
    s_add_u32 s80, s21, 4096
    buffer_load_dwordx4 v[28:31], v0, s[60:63], s80 offen offset:1024 sc1
    buffer_load_dwordx4 v[32:35], v0, s[60:63], s80 offen offset:2048 sc1
    buffer_load_dwordx4 v[36:39], v0, s[60:63], s80 offen offset:3072 sc1
    s_add_u32 s80, s21, 8192
    buffer_load_dwordx4 v[40:43], v0, s[60:63], s80 offen offset:0 sc1
    buffer_load_dwordx4 v[44:47], v0, s[60:63], s80 offen offset:1024 sc1
    s_add_u32 s80, s22, 0
    buffer_load_dwordx4 v[48:51], v0, s[60:63], s80 offen offset:0 sc1
    buffer_load_dwordx4 v[52:55], v0, s[60:63], s80 offen offset:1024 sc1
    buffer_load_dwordx4 v[56:59], v0, s[60:63], s80 offen offset:2048 sc1
    buffer_load_dwordx4 v[60:63], v0, s[60:63], s80 offen offset:3072 sc1
    s_add_u32 s80, s22, 4096
    buffer_load_dwordx4 v[64:67], v0, s[60:63], s80 offen offset:0 sc1
    s_add_u32 s80, s22, 4096
    buffer_load_dwordx4 v[68:71], v0, s[60:63], s80 offen offset:1024 sc1
    buffer_load_dwordx4 v[72:75], v0, s[60:63], s80 offen offset:2048 sc1
    buffer_load_dwordx4 v[76:79], v0, s[60:63], s80 offen offset:3072 sc1
    s_add_u32 s80, s22, 8192
    buffer_load_dwordx4 v[80:83], v0, s[60:63], s80 offen offset:0 sc1
    buffer_load_dwordx4 v[84:87], v0, s[60:63], s80 offen offset:1024 sc1
    s_waitcnt vmcnt(45)
    v_lshlrev_b32 v128, 16, v208
    v_and_b32 v129, 0xffff0000, v208
    v_lshlrev_b32 v130, 16, v209
    v_and_b32 v131, 0xffff0000, v209
    v_lshlrev_b32 v232, 16, v218
    v_and_b32 v233, 0xffff0000, v218
    v_lshlrev_b32 v234, 16, v219
    v_and_b32 v235, 0xffff0000, v219
    v_sub_f32 v236, v128, v228
    v_sub_f32 v237, v129, v228
    v_sub_f32 v238, v130, v228
    v_sub_f32 v239, v131, v228
    v_cvt_pk_bf16_f32 v240, v236, v237
    v_cvt_pk_bf16_f32 v241, v238, v239
    v_lshlrev_b32 v236, 16, v240
    v_and_b32 v237, 0xffff0000, v240
    v_lshlrev_b32 v238, 16, v241
    v_and_b32 v239, 0xffff0000, v241
    v_mul_f32 v236, v236, v230
    v_mul_f32 v237, v237, v230
    v_mul_f32 v238, v238, v230
    v_mul_f32 v239, v239, v230
    v_cvt_pk_bf16_f32 v240, v236, v237
    v_cvt_pk_bf16_f32 v241, v238, v239
    v_lshlrev_b32 v236, 16, v240
    v_and_b32 v237, 0xffff0000, v240
    v_lshlrev_b32 v238, 16, v241
    v_and_b32 v239, 0xffff0000, v241
    v_mul_f32 v236, v236, v232
    v_mul_f32 v237, v237, v233
    v_mul_f32 v238, v238, v234
    v_mul_f32 v239, v239, v235
    v_cvt_pk_bf16_f32 v240, v236, v237
    v_cvt_pk_bf16_f32 v241, v238, v239
    v_lshlrev_b32 v236, 16, v240
    v_and_b32 v237, 0xffff0000, v240
    v_lshlrev_b32 v238, 16, v241
    v_and_b32 v239, 0xffff0000, v241
    v_add_f32 v128, v236, v128
    v_add_f32 v129, v237, v129
    v_add_f32 v130, v238, v130
    v_add_f32 v131, v239, v131
    v_lshlrev_b32 v132, 16, v210
    v_and_b32 v133, 0xffff0000, v210
    v_lshlrev_b32 v134, 16, v211
    v_and_b32 v135, 0xffff0000, v211
    v_lshlrev_b32 v232, 16, v220
    v_and_b32 v233, 0xffff0000, v220
    v_lshlrev_b32 v234, 16, v221
    v_and_b32 v235, 0xffff0000, v221
    v_sub_f32 v236, v132, v228
    v_sub_f32 v237, v133, v228
    v_sub_f32 v238, v134, v228
    v_sub_f32 v239, v135, v228
    v_cvt_pk_bf16_f32 v240, v236, v237
    v_cvt_pk_bf16_f32 v241, v238, v239
    v_lshlrev_b32 v236, 16, v240
    v_and_b32 v237, 0xffff0000, v240
    v_lshlrev_b32 v238, 16, v241
    v_and_b32 v239, 0xffff0000, v241
    v_mul_f32 v236, v236, v230
    v_mul_f32 v237, v237, v230
    v_mul_f32 v238, v238, v230
    v_mul_f32 v239, v239, v230
    v_cvt_pk_bf16_f32 v240, v236, v237
    v_cvt_pk_bf16_f32 v241, v238, v239
    v_lshlrev_b32 v236, 16, v240
    v_and_b32 v237, 0xffff0000, v240
    v_lshlrev_b32 v238, 16, v241
    v_and_b32 v239, 0xffff0000, v241
    v_mul_f32 v236, v236, v232
    v_mul_f32 v237, v237, v233
    v_mul_f32 v238, v238, v234
    v_mul_f32 v239, v239, v235
    v_cvt_pk_bf16_f32 v240, v236, v237
    v_cvt_pk_bf16_f32 v241, v238, v239
    v_lshlrev_b32 v236, 16, v240
    v_and_b32 v237, 0xffff0000, v240
    v_lshlrev_b32 v238, 16, v241
    v_and_b32 v239, 0xffff0000, v241
    v_add_f32 v132, v236, v132
    v_add_f32 v133, v237, v133
    v_add_f32 v134, v238, v134
    v_add_f32 v135, v239, v135
    v_lshlrev_b32 v136, 16, v212
    v_and_b32 v137, 0xffff0000, v212
    v_lshlrev_b32 v138, 16, v213
    v_and_b32 v139, 0xffff0000, v213
    v_lshlrev_b32 v232, 16, v222
    v_and_b32 v233, 0xffff0000, v222
    v_lshlrev_b32 v234, 16, v223
    v_and_b32 v235, 0xffff0000, v223
    v_sub_f32 v236, v136, v228
    v_sub_f32 v237, v137, v228
    v_sub_f32 v238, v138, v228
    v_sub_f32 v239, v139, v228
    v_cvt_pk_bf16_f32 v240, v236, v237
    v_cvt_pk_bf16_f32 v241, v238, v239
    v_lshlrev_b32 v236, 16, v240
    v_and_b32 v237, 0xffff0000, v240
    v_lshlrev_b32 v238, 16, v241
    v_and_b32 v239, 0xffff0000, v241
    v_mul_f32 v236, v236, v230
    v_mul_f32 v237, v237, v230
    v_mul_f32 v238, v238, v230
    v_mul_f32 v239, v239, v230
    v_cvt_pk_bf16_f32 v240, v236, v237
    v_cvt_pk_bf16_f32 v241, v238, v239
    v_lshlrev_b32 v236, 16, v240
    v_and_b32 v237, 0xffff0000, v240
    v_lshlrev_b32 v238, 16, v241
    v_and_b32 v239, 0xffff0000, v241
    v_mul_f32 v236, v236, v232
    v_mul_f32 v237, v237, v233
    v_mul_f32 v238, v238, v234
    v_mul_f32 v239, v239, v235
    v_cvt_pk_bf16_f32 v240, v236, v237
    v_cvt_pk_bf16_f32 v241, v238, v239
    v_lshlrev_b32 v236, 16, v240
    v_and_b32 v237, 0xffff0000, v240
    v_lshlrev_b32 v238, 16, v241
    v_and_b32 v239, 0xffff0000, v241
    v_add_f32 v136, v236, v136
    v_add_f32 v137, v237, v137
    v_add_f32 v138, v238, v138
    v_add_f32 v139, v239, v139
    v_lshlrev_b32 v140, 16, v214
    v_and_b32 v141, 0xffff0000, v214
    v_lshlrev_b32 v142, 16, v215
    v_and_b32 v143, 0xffff0000, v215
    v_lshlrev_b32 v232, 16, v224
    v_and_b32 v233, 0xffff0000, v224
    v_lshlrev_b32 v234, 16, v225
    v_and_b32 v235, 0xffff0000, v225
    v_sub_f32 v236, v140, v228
    v_sub_f32 v237, v141, v228
    v_sub_f32 v238, v142, v228
    v_sub_f32 v239, v143, v228
    v_cvt_pk_bf16_f32 v240, v236, v237
    v_cvt_pk_bf16_f32 v241, v238, v239
    v_lshlrev_b32 v236, 16, v240
    v_and_b32 v237, 0xffff0000, v240
    v_lshlrev_b32 v238, 16, v241
    v_and_b32 v239, 0xffff0000, v241
    v_mul_f32 v236, v236, v230
    v_mul_f32 v237, v237, v230
    v_mul_f32 v238, v238, v230
    v_mul_f32 v239, v239, v230
    v_cvt_pk_bf16_f32 v240, v236, v237
    v_cvt_pk_bf16_f32 v241, v238, v239
    v_lshlrev_b32 v236, 16, v240
    v_and_b32 v237, 0xffff0000, v240
    v_lshlrev_b32 v238, 16, v241
    v_and_b32 v239, 0xffff0000, v241
    v_mul_f32 v236, v236, v232
    v_mul_f32 v237, v237, v233
    v_mul_f32 v238, v238, v234
    v_mul_f32 v239, v239, v235
    v_cvt_pk_bf16_f32 v240, v236, v237
    v_cvt_pk_bf16_f32 v241, v238, v239
    v_lshlrev_b32 v236, 16, v240
    v_and_b32 v237, 0xffff0000, v240
    v_lshlrev_b32 v238, 16, v241
    v_and_b32 v239, 0xffff0000, v241
    v_add_f32 v140, v236, v140
    v_add_f32 v141, v237, v141
    v_add_f32 v142, v238, v142
    v_add_f32 v143, v239, v143
    v_lshlrev_b32 v144, 16, v216
    v_and_b32 v145, 0xffff0000, v216
    v_lshlrev_b32 v146, 16, v217
    v_and_b32 v147, 0xffff0000, v217
    v_lshlrev_b32 v232, 16, v226
    v_and_b32 v233, 0xffff0000, v226
    v_lshlrev_b32 v234, 16, v227
    v_and_b32 v235, 0xffff0000, v227
    v_sub_f32 v236, v144, v228
    v_sub_f32 v237, v145, v228
    v_sub_f32 v238, v146, v228
    v_sub_f32 v239, v147, v228
    v_cvt_pk_bf16_f32 v240, v236, v237
    v_cvt_pk_bf16_f32 v241, v238, v239
    v_lshlrev_b32 v236, 16, v240
    v_and_b32 v237, 0xffff0000, v240
    v_lshlrev_b32 v238, 16, v241
    v_and_b32 v239, 0xffff0000, v241
    v_mul_f32 v236, v236, v230
    v_mul_f32 v237, v237, v230
    v_mul_f32 v238, v238, v230
    v_mul_f32 v239, v239, v230
    v_cvt_pk_bf16_f32 v240, v236, v237
    v_cvt_pk_bf16_f32 v241, v238, v239
    v_lshlrev_b32 v236, 16, v240
    v_and_b32 v237, 0xffff0000, v240
    v_lshlrev_b32 v238, 16, v241
    v_and_b32 v239, 0xffff0000, v241
    v_mul_f32 v236, v236, v232
    v_mul_f32 v237, v237, v233
    v_mul_f32 v238, v238, v234
    v_mul_f32 v239, v239, v235
    v_cvt_pk_bf16_f32 v240, v236, v237
    v_cvt_pk_bf16_f32 v241, v238, v239
    v_lshlrev_b32 v236, 16, v240
    v_and_b32 v237, 0xffff0000, v240
    v_lshlrev_b32 v238, 16, v241
    v_and_b32 v239, 0xffff0000, v241
    v_add_f32 v144, v236, v144
    v_add_f32 v145, v237, v145
    v_add_f32 v146, v238, v146
    v_add_f32 v147, v239, v147
    s_barrier
    s_cmp_lg_u32 s14, 0
    s_cbranch_scc1 parallel_sum__ssm_conv_s5__glu_gated_bilinear__prompt_kernel_hs_e0
    s_add_u32 s0, s9, 128
    s_sleep 0
    s_mov_b32 s80, 0
parallel_sum__ssm_conv_s5__glu_gated_bilinear__prompt_kernel_hs_pollg:
    buffer_load_dword v3, v2, s[64:67], s0 offen sc1
    s_waitcnt vmcnt(0)
    v_cmp_ne_u32 vcc, s15, v3
    s_and_b32 s82, vcc_lo, 0x3fffff
    s_cbranch_scc0 parallel_sum__ssm_conv_s5__glu_gated_bilinear__prompt_kernel_hs_pollg_ok
    s_add_u32 s80, s80, 1
    s_cmp_lt_u32 s80, 0x20000
    s_cbranch_scc0 parallel_sum__ssm_conv_s5__glu_gated_bilinear__prompt_kernel_hs_pollg_ok
    s_sleep 2
    s_branch parallel_sum__ssm_conv_s5__glu_gated_bilinear__prompt_kernel_hs_pollg
parallel_sum__ssm_conv_s5__glu_gated_bilinear__prompt_kernel_hs_pollg_ok:
parallel_sum__ssm_conv_s5__glu_gated_bilinear__prompt_kernel_hs_e0:
    s_add_u32 s82, s4, 20480
    s_sub_u32 s83, s82, 53248
    s_cmp_ge_u32 s82, 53248
    s_cselect_b32 s82, s83, s82
    s_mul_i32 s82, s82, 5
    s_add_u32 s82, s82, s10
    s_add_u32 m0, s11, 0
    s_nop 0
    buffer_load_dwordx4 v248, s[60:63], s82 offen offset:0 sc1 lds
    buffer_load_dwordx4 v249, s[60:63], s82 offen offset:1024 sc1 lds
    buffer_load_dwordx4 v250, s[60:63], s82 offen offset:2048 sc1 lds
    buffer_load_dwordx4 v251, s[60:63], s82 offen offset:3072 sc1 lds
    s_add_u32 m0, s11, 4096
    s_nop 0
    buffer_load_dwordx4 v252, s[60:63], s82 offen offset:0 sc1 lds
    s_add_u32 s82, s4, 24576
    s_sub_u32 s83, s82, 53248
    s_cmp_ge_u32 s82, 53248
    s_cselect_b32 s82, s83, s82
    s_mul_i32 s82, s82, 5
    s_add_u32 s82, s82, s10
    s_add_u32 m0, s11, 20480
    s_nop 0
    buffer_load_dwordx4 v248, s[60:63], s82 offen offset:0 sc1 lds
    buffer_load_dwordx4 v249, s[60:63], s82 offen offset:1024 sc1 lds
    buffer_load_dwordx4 v250, s[60:63], s82 offen offset:2048 sc1 lds
    buffer_load_dwordx4 v251, s[60:63], s82 offen offset:3072 sc1 lds
    s_add_u32 m0, s11, 24576
    s_nop 0
    buffer_load_dwordx4 v252, s[60:63], s82 offen offset:0 sc1 lds
    s_add_u32 s82, s4, 28672
    s_sub_u32 s83, s82, 53248
    s_cmp_ge_u32 s82, 53248
    s_cselect_b32 s82, s83, s82
    s_mul_i32 s82, s82, 5
    s_add_u32 s82, s82, s10
    s_add_u32 m0, s11, 40960
    s_nop 0
    buffer_load_dwordx4 v248, s[60:63], s82 offen offset:0 sc1 lds
    buffer_load_dwordx4 v249, s[60:63], s82 offen offset:1024 sc1 lds
    buffer_load_dwordx4 v250, s[60:63], s82 offen offset:2048 sc1 lds
    buffer_load_dwordx4 v251, s[60:63], s82 offen offset:3072 sc1 lds
    s_add_u32 m0, s11, 45056
    s_nop 0
    buffer_load_dwordx4 v252, s[60:63], s82 offen offset:0 sc1 lds
    s_barrier
    s_waitcnt vmcnt(55)
    ds_write_b128 v243, v[88:91] offset:20480
    ds_write_b128 v243, v[92:95] offset:21504
    ds_write_b128 v243, v[96:99] offset:22528
    ds_write_b128 v243, v[100:103] offset:23552
    ds_write_b128 v243, v[104:107] offset:24576
    s_waitcnt vmcnt(50)
    ds_write_b128 v244, v[108:111] offset:0
    ds_write_b128 v244, v[112:115] offset:1024
    ds_write_b128 v244, v[116:119] offset:2048
    ds_write_b128 v244, v[120:123] offset:3072
    ds_write_b128 v244, v[124:127] offset:4096
    s_waitcnt vmcnt(45)
    ds_write_b128 v244, v[188:191] offset:20480
    ds_write_b128 v244, v[192:195] offset:21504
    ds_write_b128 v244, v[196:199] offset:22528
    ds_write_b128 v244, v[200:203] offset:23552
    ds_write_b128 v244, v[204:207] offset:24576
    s_waitcnt vmcnt(40)
    ds_write_b128 v245, v[168:171] offset:0
    ds_write_b128 v245, v[172:175] offset:1024
    ds_write_b128 v245, v[176:179] offset:2048
    ds_write_b128 v245, v[180:183] offset:3072
    ds_write_b128 v245, v[184:187] offset:4096
    s_waitcnt vmcnt(35)
    ds_write_b128 v245, v[148:151] offset:20480
    ds_write_b128 v245, v[152:155] offset:21504
    ds_write_b128 v245, v[156:159] offset:22528
    ds_write_b128 v245, v[160:163] offset:23552
    ds_write_b128 v245, v[164:167] offset:24576
    s_waitcnt lgkmcnt(0)
    s_waitcnt vmcnt(0)
parallel_sum__ssm_conv_s5__glu_gated_bilinear__prompt_kernel_hs_e3:
    s_waitcnt lgkmcnt(0)
    s_barrier
    s_add_u32 s80, s23, 0
    buffer_load_dwordx4 v[88:91], v0, s[60:63], s80 offen offset:0 sc1
    buffer_load_dwordx4 v[92:95], v0, s[60:63], s80 offen offset:1024 sc1
    buffer_load_dwordx4 v[96:99], v0, s[60:63], s80 offen offset:2048 sc1
    buffer_load_dwordx4 v[100:103], v0, s[60:63], s80 offen offset:3072 sc1
    s_add_u32 s80, s23, 4096
    buffer_load_dwordx4 v[104:107], v0, s[60:63], s80 offen offset:0 sc1
    s_add_u32 s80, s23, 4096
    buffer_load_dwordx4 v[108:111], v0, s[60:63], s80 offen offset:1024 sc1
    buffer_load_dwordx4 v[112:115], v0, s[60:63], s80 offen offset:2048 sc1
    buffer_load_dwordx4 v[116:119], v0, s[60:63], s80 offen offset:3072 sc1
    s_add_u32 s80, s23, 8192
    buffer_load_dwordx4 v[120:123], v0, s[60:63], s80 offen offset:0 sc1
    buffer_load_dwordx4 v[124:127], v0, s[60:63], s80 offen offset:1024 sc1
    s_branch parallel_sum__ssm_conv_s5__glu_gated_bilinear__prompt_kernel_p2h2
parallel_sum__ssm_conv_s5__glu_gated_bilinear__prompt_kernel_p2h:
parallel_sum__ssm_conv_s5__glu_gated_bilinear__prompt_kernel_p2h2:
    s_mov_b32 s80, 0
parallel_sum__ssm_conv_s5__glu_gated_bilinear__prompt_kernel_polls:
    buffer_load_dword v3, v2, s[64:67], s9 offen sc1
    s_waitcnt vmcnt(0)
    v_cmp_ne_u32 vcc, s15, v3
    s_and_b32 s82, vcc_lo, 0x3ff
    s_cbranch_scc0 parallel_sum__ssm_conv_s5__glu_gated_bilinear__prompt_kernel_polls_ok
    s_add_u32 s80, s80, 1
    s_cmp_lt_u32 s80, 0x20000
    s_cbranch_scc0 parallel_sum__ssm_conv_s5__glu_gated_bilinear__prompt_kernel_polls_ok
    s_sleep 2
    s_branch parallel_sum__ssm_conv_s5__glu_gated_bilinear__prompt_kernel_polls
parallel_sum__ssm_conv_s5__glu_gated_bilinear__prompt_kernel_polls_ok:
parallel_sum__ssm_conv_s5__glu_gated_bilinear__prompt_kernel_go:
    v_mul_f32 v2, v230, v230
    s_add_u32 s81, s11, 0xf000
    v_lshl_add_u32 v3, v1, 2, s81
    v_lshrrev_b32 v208, 4, v1
    v_bfe_u32 v1, v1, 1, 2
    v_add_u32 v208, v208, v1
    v_cmp_lt_u32 vcc, 3, v208
    v_mov_b32 v208, 0xffffffc0
    v_mov_b32 v1, 0x100
    v_cndmask_b32 v1, v1, v208, vcc
    s_add_u32 s80, s8, s16
    buffer_load_dwordx4 v[208:211], v0, s[56:59], s80 offen offset:0 sc1
    s_add_u32 s80, s8, s16
    buffer_load_dwordx4 v[212:215], v0, s[56:59], s80 offen offset:1024 sc1
    s_add_u32 s80, s12, s16
    buffer_load_dwordx4 v[216:219], v0, s[56:59], s80 offen offset:0 sc1
    s_add_u32 s80, s8, s17
    buffer_load_dwordx4 v[220:223], v0, s[56:59], s80 offen offset:0 sc1
    s_add_u32 s80, s12, s16
    buffer_load_dwordx4 v[224:227], v0, s[56:59], s80 offen offset:1024 sc1
    s_add_u32 s80, s13, s16
    buffer_load_dwordx4 v[228:231], v0, s[56:59], s80 offen offset:0 sc1
    s_add_u32 s80, s8, s17
    buffer_load_dwordx4 v[232:235], v0, s[56:59], s80 offen offset:1024 sc1
    s_add_u32 s80, s12, s17
    buffer_load_dwordx4 v[236:239], v0, s[56:59], s80 offen offset:0 sc1
    s_add_u32 s80, s13, s16
    buffer_load_dwordx4 v[240:243], v0, s[56:59], s80 offen offset:1024 sc1
    s_add_u32 s80, s100, s16
    buffer_load_dwordx4 v[244:247], v0, s[56:59], s80 offen offset:0 sc1
    s_add_u32 s80, s8, s18
    buffer_load_dwordx4 v[248:251], v0, s[56:59], s80 offen offset:0 sc1
    s_add_u32 s80, s12, s17
    buffer_load_dwordx4 v[252:255], v0, s[56:59], s80 offen offset:1024 sc1
    s_waitcnt vmcnt(11)
    v_mfma_f32_16x16x32_bf16 v[128:131], v[8:11], v[208:211], v[128:131]
    v_mfma_f32_16x16x32_bf16 v[132:135], v[12:15], v[208:211], v[132:135]
    v_mfma_f32_16x16x32_bf16 v[136:139], v[16:19], v[208:211], v[136:139]
    v_mfma_f32_16x16x32_bf16 v[140:143], v[20:23], v[208:211], v[140:143]
    v_mfma_f32_16x16x32_bf16 v[144:147], v[24:27], v[208:211], v[144:147]
    s_add_u32 s80, s13, s17
    buffer_load_dwordx4 v[208:211], v0, s[56:59], s80 offen offset:0 sc1
    s_waitcnt vmcnt(11)
    v_mfma_f32_16x16x32_bf16 v[128:131], v[28:31], v[212:215], v[128:131]
    v_mfma_f32_16x16x32_bf16 v[132:135], v[32:35], v[212:215], v[132:135]
    v_mfma_f32_16x16x32_bf16 v[136:139], v[36:39], v[212:215], v[136:139]
    v_mfma_f32_16x16x32_bf16 v[140:143], v[40:43], v[212:215], v[140:143]
    v_mfma_f32_16x16x32_bf16 v[144:147], v[44:47], v[212:215], v[144:147]
    s_add_u32 s80, s100, s16
    buffer_load_dwordx4 v[212:215], v0, s[56:59], s80 offen offset:1024 sc1
    s_waitcnt vmcnt(11)
    v_mfma_f32_16x16x32_bf16 v[148:151], v[8:11], v[216:219], 0
    v_mfma_f32_16x16x32_bf16 v[152:155], v[12:15], v[216:219], 0
    v_mfma_f32_16x16x32_bf16 v[156:159], v[16:19], v[216:219], 0
    v_mfma_f32_16x16x32_bf16 v[160:163], v[20:23], v[216:219], 0
    v_mfma_f32_16x16x32_bf16 v[164:167], v[24:27], v[216:219], 0
    s_add_u32 s80, s8, s18
    buffer_load_dwordx4 v[216:219], v0, s[56:59], s80 offen offset:1024 sc1
    s_waitcnt vmcnt(11)
    v_mfma_f32_16x16x32_bf16 v[128:131], v[48:51], v[220:223], v[128:131]
    v_mfma_f32_16x16x32_bf16 v[132:135], v[52:55], v[220:223], v[132:135]
    v_mfma_f32_16x16x32_bf16 v[136:139], v[56:59], v[220:223], v[136:139]
    v_mfma_f32_16x16x32_bf16 v[140:143], v[60:63], v[220:223], v[140:143]
    v_mfma_f32_16x16x32_bf16 v[144:147], v[64:67], v[220:223], v[144:147]
    s_add_u32 s80, s12, s18
    buffer_load_dwordx4 v[220:223], v0, s[56:59], s80 offen offset:0 sc1
    s_waitcnt vmcnt(11)
    v_mfma_f32_16x16x32_bf16 v[148:151], v[28:31], v[224:227], v[148:151]
    v_mfma_f32_16x16x32_bf16 v[152:155], v[32:35], v[224:227], v[152:155]
    v_mfma_f32_16x16x32_bf16 v[156:159], v[36:39], v[224:227], v[156:159]
    v_mfma_f32_16x16x32_bf16 v[160:163], v[40:43], v[224:227], v[160:163]
    v_mfma_f32_16x16x32_bf16 v[164:167], v[44:47], v[224:227], v[164:167]
    s_add_u32 s80, s13, s17
    buffer_load_dwordx4 v[224:227], v0, s[56:59], s80 offen offset:1024 sc1
    s_waitcnt vmcnt(11)
    v_mfma_f32_16x16x32_bf16 v[168:171], v[8:11], v[228:231], 0
    v_mfma_f32_16x16x32_bf16 v[172:175], v[12:15], v[228:231], 0
    v_mfma_f32_16x16x32_bf16 v[176:179], v[16:19], v[228:231], 0
    v_mfma_f32_16x16x32_bf16 v[180:183], v[20:23], v[228:231], 0
    v_mfma_f32_16x16x32_bf16 v[184:187], v[24:27], v[228:231], 0
    s_add_u32 s80, s100, s17
    buffer_load_dwordx4 v[228:231], v0, s[56:59], s80 offen offset:0 sc1
    s_waitcnt vmcnt(11)
    v_mfma_f32_16x16x32_bf16 v[128:131], v[68:71], v[232:235], v[128:131]
    v_mfma_f32_16x16x32_bf16 v[132:135], v[72:75], v[232:235], v[132:135]
    v_mfma_f32_16x16x32_bf16 v[136:139], v[76:79], v[232:235], v[136:139]
    v_mfma_f32_16x16x32_bf16 v[140:143], v[80:83], v[232:235], v[140:143]
    v_mfma_f32_16x16x32_bf16 v[144:147], v[84:87], v[232:235], v[144:147]
    s_add_u32 s80, s8, s19
    buffer_load_dwordx4 v[232:235], v0, s[56:59], s80 offen offset:0 sc1
    s_waitcnt vmcnt(11)
    v_mfma_f32_16x16x32_bf16 v[148:151], v[48:51], v[236:239], v[148:151]
    v_mfma_f32_16x16x32_bf16 v[152:155], v[52:55], v[236:239], v[152:155]
    v_mfma_f32_16x16x32_bf16 v[156:159], v[56:59], v[236:239], v[156:159]
    v_mfma_f32_16x16x32_bf16 v[160:163], v[60:63], v[236:239], v[160:163]
    v_mfma_f32_16x16x32_bf16 v[164:167], v[64:67], v[236:239], v[164:167]
    s_add_u32 s80, s12, s18
    buffer_load_dwordx4 v[236:239], v0, s[56:59], s80 offen offset:1024 sc1
    s_waitcnt vmcnt(11)
    v_mfma_f32_16x16x32_bf16 v[168:171], v[28:31], v[240:243], v[168:171]
    v_mfma_f32_16x16x32_bf16 v[172:175], v[32:35], v[240:243], v[172:175]
    v_mfma_f32_16x16x32_bf16 v[176:179], v[36:39], v[240:243], v[176:179]
    v_mfma_f32_16x16x32_bf16 v[180:183], v[40:43], v[240:243], v[180:183]
    v_mfma_f32_16x16x32_bf16 v[184:187], v[44:47], v[240:243], v[184:187]
    s_add_u32 s80, s13, s18
    buffer_load_dwordx4 v[240:243], v0, s[56:59], s80 offen offset:0 sc1
    s_waitcnt vmcnt(11)
    v_mfma_f32_16x16x32_bf16 v[188:191], v[8:11], v[244:247], 0
    s_add_u32 s80, s24, 0
    buffer_load_dwordx4 v[8:11], v0, s[60:63], s80 offen sc1
    v_mfma_f32_16x16x32_bf16 v[192:195], v[12:15], v[244:247], 0
    s_add_u32 s80, s24, 1024
    buffer_load_dwordx4 v[12:15], v0, s[60:63], s80 offen sc1
    v_mfma_f32_16x16x32_bf16 v[196:199], v[16:19], v[244:247], 0
    s_add_u32 s80, s24, 2048
    buffer_load_dwordx4 v[16:19], v0, s[60:63], s80 offen sc1
    v_mfma_f32_16x16x32_bf16 v[200:203], v[20:23], v[244:247], 0
    s_add_u32 s80, s24, 3072
    buffer_load_dwordx4 v[20:23], v0, s[60:63], s80 offen sc1
    v_mfma_f32_16x16x32_bf16 v[204:207], v[24:27], v[244:247], 0
    s_add_u32 s80, s24, 4096
    buffer_load_dwordx4 v[24:27], v0, s[60:63], s80 offen sc1
    s_add_u32 s80, s100, s17
    buffer_load_dwordx4 v[244:247], v0, s[56:59], s80 offen offset:1024 sc1
    s_waitcnt vmcnt(16)
    v_mfma_f32_16x16x32_bf16 v[128:131], v[88:91], v[248:251], v[128:131]
    v_mfma_f32_16x16x32_bf16 v[132:135], v[92:95], v[248:251], v[132:135]
    v_mfma_f32_16x16x32_bf16 v[136:139], v[96:99], v[248:251], v[136:139]
    v_mfma_f32_16x16x32_bf16 v[140:143], v[100:103], v[248:251], v[140:143]
    v_mfma_f32_16x16x32_bf16 v[144:147], v[104:107], v[248:251], v[144:147]
    s_add_u32 s80, s8, s19
    buffer_load_dwordx4 v[248:251], v0, s[56:59], s80 offen offset:1024 sc1
    s_waitcnt vmcnt(16)
    v_mfma_f32_16x16x32_bf16 v[148:151], v[68:71], v[252:255], v[148:151]
    v_mfma_f32_16x16x32_bf16 v[152:155], v[72:75], v[252:255], v[152:155]
    v_mfma_f32_16x16x32_bf16 v[156:159], v[76:79], v[252:255], v[156:159]
    v_mfma_f32_16x16x32_bf16 v[160:163], v[80:83], v[252:255], v[160:163]
    v_mfma_f32_16x16x32_bf16 v[164:167], v[84:87], v[252:255], v[164:167]
    s_add_u32 s80, s12, s19
    buffer_load_dwordx4 v[252:255], v0, s[56:59], s80 offen offset:0 sc1
    s_waitcnt vmcnt(16)
    v_mfma_f32_16x16x32_bf16 v[168:171], v[48:51], v[208:211], v[168:171]
    v_mfma_f32_16x16x32_bf16 v[172:175], v[52:55], v[208:211], v[172:175]
    v_mfma_f32_16x16x32_bf16 v[176:179], v[56:59], v[208:211], v[176:179]
    v_mfma_f32_16x16x32_bf16 v[180:183], v[60:63], v[208:211], v[180:183]
    v_mfma_f32_16x16x32_bf16 v[184:187], v[64:67], v[208:211], v[184:187]
    s_add_u32 s80, s13, s18
    buffer_load_dwordx4 v[208:211], v0, s[56:59], s80 offen offset:1024 sc1
    s_waitcnt vmcnt(16)
    v_mfma_f32_16x16x32_bf16 v[188:191], v[28:31], v[212:215], v[188:191]
    s_add_u32 s80, s24, 5120
    buffer_load_dwordx4 v[28:31], v0, s[60:63], s80 offen sc1
    v_mfma_f32_16x16x32_bf16 v[192:195], v[32:35], v[212:215], v[192:195]
    s_add_u32 s80, s24, 6144
    buffer_load_dwordx4 v[32:35], v0, s[60:63], s80 offen sc1
    v_mfma_f32_16x16x32_bf16 v[196:199], v[36:39], v[212:215], v[196:199]
    s_add_u32 s80, s24, 7168
    buffer_load_dwordx4 v[36:39], v0, s[60:63], s80 offen sc1
    v_mfma_f32_16x16x32_bf16 v[200:203], v[40:43], v[212:215], v[200:203]
    s_add_u32 s80, s24, 8192
    buffer_load_dwordx4 v[40:43], v0, s[60:63], s80 offen sc1
    v_mfma_f32_16x16x32_bf16 v[204:207], v[44:47], v[212:215], v[204:207]
    s_add_u32 s80, s24, 9216
    buffer_load_dwordx4 v[44:47], v0, s[60:63], s80 offen sc1
    s_add_u32 s80, s100, s18
    buffer_load_dwordx4 v[212:215], v0, s[56:59], s80 offen offset:0 sc1
    s_waitcnt vmcnt(21)
    v_mfma_f32_16x16x32_bf16 v[128:131], v[108:111], v[216:219], v[128:131]
    v_mfma_f32_16x16x32_bf16 v[132:135], v[112:115], v[216:219], v[132:135]
    v_mfma_f32_16x16x32_bf16 v[136:139], v[116:119], v[216:219], v[136:139]
    v_mfma_f32_16x16x32_bf16 v[140:143], v[120:123], v[216:219], v[140:143]
    v_mfma_f32_16x16x32_bf16 v[144:147], v[124:127], v[216:219], v[144:147]
    s_add_u32 s80, s8, s20
    buffer_load_dwordx4 v[216:219], v0, s[56:59], s80 offen offset:0 sc1
    s_waitcnt vmcnt(21)
    v_mfma_f32_16x16x32_bf16 v[148:151], v[88:91], v[220:223], v[148:151]
    v_mfma_f32_16x16x32_bf16 v[152:155], v[92:95], v[220:223], v[152:155]
    v_mfma_f32_16x16x32_bf16 v[156:159], v[96:99], v[220:223], v[156:159]
    v_mfma_f32_16x16x32_bf16 v[160:163], v[100:103], v[220:223], v[160:163]
    v_mfma_f32_16x16x32_bf16 v[164:167], v[104:107], v[220:223], v[164:167]
    s_add_u32 s80, s12, s19
    buffer_load_dwordx4 v[220:223], v0, s[56:59], s80 offen offset:1024 sc1
    s_waitcnt vmcnt(21)
    v_mfma_f32_16x16x32_bf16 v[168:171], v[68:71], v[224:227], v[168:171]
    v_mfma_f32_16x16x32_bf16 v[172:175], v[72:75], v[224:227], v[172:175]
    v_mfma_f32_16x16x32_bf16 v[176:179], v[76:79], v[224:227], v[176:179]
    v_mfma_f32_16x16x32_bf16 v[180:183], v[80:83], v[224:227], v[180:183]
    v_mfma_f32_16x16x32_bf16 v[184:187], v[84:87], v[224:227], v[184:187]
    s_add_u32 s80, s13, s19
    buffer_load_dwordx4 v[224:227], v0, s[56:59], s80 offen offset:0 sc1
    s_waitcnt vmcnt(21)
    v_mfma_f32_16x16x32_bf16 v[188:191], v[48:51], v[228:231], v[188:191]
    s_add_u32 s80, s25, 0
    buffer_load_dwordx4 v[48:51], v0, s[60:63], s80 offen sc1
    v_mfma_f32_16x16x32_bf16 v[192:195], v[52:55], v[228:231], v[192:195]
    s_add_u32 s80, s25, 1024
    buffer_load_dwordx4 v[52:55], v0, s[60:63], s80 offen sc1
    v_mfma_f32_16x16x32_bf16 v[196:199], v[56:59], v[228:231], v[196:199]
    s_add_u32 s80, s25, 2048
    buffer_load_dwordx4 v[56:59], v0, s[60:63], s80 offen sc1
    v_mfma_f32_16x16x32_bf16 v[200:203], v[60:63], v[228:231], v[200:203]
    s_add_u32 s80, s25, 3072
    buffer_load_dwordx4 v[60:63], v0, s[60:63], s80 offen sc1
    v_mfma_f32_16x16x32_bf16 v[204:207], v[64:67], v[228:231], v[204:207]
    s_add_u32 s80, s25, 4096
    buffer_load_dwordx4 v[64:67], v0, s[60:63], s80 offen sc1
    s_add_u32 s80, s100, s18
    buffer_load_dwordx4 v[228:231], v0, s[56:59], s80 offen offset:1024 sc1
    s_waitcnt vmcnt(26)
    s_waitcnt vmcnt(23)
    v_mfma_f32_16x16x32_bf16 v[128:131], v[8:11], v[232:235], v[128:131]
    s_waitcnt vmcnt(22)
    v_mfma_f32_16x16x32_bf16 v[132:135], v[12:15], v[232:235], v[132:135]
    s_waitcnt vmcnt(21)
    v_mfma_f32_16x16x32_bf16 v[136:139], v[16:19], v[232:235], v[136:139]
    s_waitcnt vmcnt(20)
    v_mfma_f32_16x16x32_bf16 v[140:143], v[20:23], v[232:235], v[140:143]
    s_waitcnt vmcnt(19)
    v_mfma_f32_16x16x32_bf16 v[144:147], v[24:27], v[232:235], v[144:147]
    s_add_u32 s80, s8, s20
    buffer_load_dwordx4 v[232:235], v0, s[56:59], s80 offen offset:1024 sc1
    v_mfma_f32_16x16x32_bf16 v[148:151], v[108:111], v[236:239], v[148:151]
    v_mfma_f32_16x16x32_bf16 v[152:155], v[112:115], v[236:239], v[152:155]
    v_mfma_f32_16x16x32_bf16 v[156:159], v[116:119], v[236:239], v[156:159]
    v_mfma_f32_16x16x32_bf16 v[160:163], v[120:123], v[236:239], v[160:163]
    v_mfma_f32_16x16x32_bf16 v[164:167], v[124:127], v[236:239], v[164:167]
    s_add_u32 s80, s12, s20
    buffer_load_dwordx4 v[236:239], v0, s[56:59], s80 offen offset:0 sc1
    v_mfma_f32_16x16x32_bf16 v[168:171], v[88:91], v[240:243], v[168:171]
    v_mfma_f32_16x16x32_bf16 v[172:175], v[92:95], v[240:243], v[172:175]
    v_mfma_f32_16x16x32_bf16 v[176:179], v[96:99], v[240:243], v[176:179]
    v_mfma_f32_16x16x32_bf16 v[180:183], v[100:103], v[240:243], v[180:183]
    v_mfma_f32_16x16x32_bf16 v[184:187], v[104:107], v[240:243], v[184:187]
    s_add_u32 s80, s13, s19
    buffer_load_dwordx4 v[240:243], v0, s[56:59], s80 offen offset:1024 sc1
    s_waitcnt vmcnt(21)
    v_mfma_f32_16x16x32_bf16 v[188:191], v[68:71], v[244:247], v[188:191]
    s_add_u32 s80, s25, 5120
    buffer_load_dwordx4 v[68:71], v0, s[60:63], s80 offen sc1
    v_mfma_f32_16x16x32_bf16 v[192:195], v[72:75], v[244:247], v[192:195]
    s_add_u32 s80, s25, 6144
    buffer_load_dwordx4 v[72:75], v0, s[60:63], s80 offen sc1
    v_mfma_f32_16x16x32_bf16 v[196:199], v[76:79], v[244:247], v[196:199]
    s_add_u32 s80, s25, 7168
    buffer_load_dwordx4 v[76:79], v0, s[60:63], s80 offen sc1
    v_mfma_f32_16x16x32_bf16 v[200:203], v[80:83], v[244:247], v[200:203]
    s_add_u32 s80, s25, 8192
    buffer_load_dwordx4 v[80:83], v0, s[60:63], s80 offen sc1
    v_mfma_f32_16x16x32_bf16 v[204:207], v[84:87], v[244:247], v[204:207]
    s_add_u32 s80, s25, 9216
    buffer_load_dwordx4 v[84:87], v0, s[60:63], s80 offen sc1
    s_add_u32 s80, s100, s19
    buffer_load_dwordx4 v[244:247], v0, s[56:59], s80 offen offset:0 sc1
    s_waitcnt vmcnt(26)
    s_waitcnt vmcnt(23)
    v_mfma_f32_16x16x32_bf16 v[128:131], v[28:31], v[248:251], v[128:131]
    s_waitcnt vmcnt(22)
    v_mfma_f32_16x16x32_bf16 v[132:135], v[32:35], v[248:251], v[132:135]
    s_waitcnt vmcnt(21)
    v_mfma_f32_16x16x32_bf16 v[136:139], v[36:39], v[248:251], v[136:139]
    s_waitcnt vmcnt(20)
    v_mfma_f32_16x16x32_bf16 v[140:143], v[40:43], v[248:251], v[140:143]
    s_waitcnt vmcnt(19)
    v_mfma_f32_16x16x32_bf16 v[144:147], v[44:47], v[248:251], v[144:147]
    s_add_u32 s80, s12, s20
    buffer_load_dwordx4 v[248:251], v0, s[56:59], s80 offen offset:1024 sc1
    v_mfma_f32_16x16x32_bf16 v[148:151], v[8:11], v[252:255], v[148:151]
    v_mfma_f32_16x16x32_bf16 v[152:155], v[12:15], v[252:255], v[152:155]
    v_mfma_f32_16x16x32_bf16 v[156:159], v[16:19], v[252:255], v[156:159]
    v_mfma_f32_16x16x32_bf16 v[160:163], v[20:23], v[252:255], v[160:163]
    v_mfma_f32_16x16x32_bf16 v[164:167], v[24:27], v[252:255], v[164:167]
    s_add_u32 s80, s13, s20
    buffer_load_dwordx4 v[252:255], v0, s[56:59], s80 offen offset:0 sc1
    v_mfma_f32_16x16x32_bf16 v[168:171], v[108:111], v[208:211], v[168:171]
    v_mfma_f32_16x16x32_bf16 v[172:175], v[112:115], v[208:211], v[172:175]
    v_mfma_f32_16x16x32_bf16 v[176:179], v[116:119], v[208:211], v[176:179]
    v_mfma_f32_16x16x32_bf16 v[180:183], v[120:123], v[208:211], v[180:183]
    v_mfma_f32_16x16x32_bf16 v[184:187], v[124:127], v[208:211], v[184:187]
    s_add_u32 s80, s100, s19
    buffer_load_dwordx4 v[208:211], v0, s[56:59], s80 offen offset:1024 sc1
    s_waitcnt vmcnt(21)
    v_mfma_f32_16x16x32_bf16 v[188:191], v[88:91], v[212:215], v[188:191]
    v_mfma_f32_16x16x32_bf16 v[192:195], v[92:95], v[212:215], v[192:195]
    v_mfma_f32_16x16x32_bf16 v[196:199], v[96:99], v[212:215], v[196:199]
    v_mfma_f32_16x16x32_bf16 v[200:203], v[100:103], v[212:215], v[200:203]
    v_mfma_f32_16x16x32_bf16 v[204:207], v[104:107], v[212:215], v[204:207]
    s_add_u32 s80, s13, s20
    buffer_load_dwordx4 v[212:215], v0, s[56:59], s80 offen offset:1024 sc1
    s_waitcnt vmcnt(21)
    s_waitcnt vmcnt(18)
    v_mfma_f32_16x16x32_bf16 v[128:131], v[48:51], v[216:219], v[128:131]
    s_waitcnt vmcnt(17)
    v_mfma_f32_16x16x32_bf16 v[132:135], v[52:55], v[216:219], v[132:135]
    s_waitcnt vmcnt(16)
    v_mfma_f32_16x16x32_bf16 v[136:139], v[56:59], v[216:219], v[136:139]
    s_waitcnt vmcnt(15)
    v_mfma_f32_16x16x32_bf16 v[140:143], v[60:63], v[216:219], v[140:143]
    s_waitcnt vmcnt(14)
    v_mfma_f32_16x16x32_bf16 v[144:147], v[64:67], v[216:219], v[144:147]
    s_add_u32 s80, s100, s20
    buffer_load_dwordx4 v[216:219], v0, s[56:59], s80 offen offset:0 sc1
    v_mfma_f32_16x16x32_bf16 v[148:151], v[28:31], v[220:223], v[148:151]
    v_mfma_f32_16x16x32_bf16 v[152:155], v[32:35], v[220:223], v[152:155]
    v_mfma_f32_16x16x32_bf16 v[156:159], v[36:39], v[220:223], v[156:159]
    v_mfma_f32_16x16x32_bf16 v[160:163], v[40:43], v[220:223], v[160:163]
    v_mfma_f32_16x16x32_bf16 v[164:167], v[44:47], v[220:223], v[164:167]
    s_add_u32 s80, s100, s20
    buffer_load_dwordx4 v[220:223], v0, s[56:59], s80 offen offset:1024 sc1
    s_barrier
    ds_write_b32 v3, v2
    v_mfma_f32_16x16x32_bf16 v[168:171], v[8:11], v[224:227], v[168:171]
    v_mfma_f32_16x16x32_bf16 v[172:175], v[12:15], v[224:227], v[172:175]
    v_mfma_f32_16x16x32_bf16 v[176:179], v[16:19], v[224:227], v[176:179]
    v_mfma_f32_16x16x32_bf16 v[180:183], v[20:23], v[224:227], v[180:183]
    v_mfma_f32_16x16x32_bf16 v[184:187], v[24:27], v[224:227], v[184:187]
    s_waitcnt vmcnt(15)
    v_mfma_f32_16x16x32_bf16 v[188:191], v[108:111], v[228:231], v[188:191]
    v_mfma_f32_16x16x32_bf16 v[192:195], v[112:115], v[228:231], v[192:195]
    v_mfma_f32_16x16x32_bf16 v[196:199], v[116:119], v[228:231], v[196:199]
    v_mfma_f32_16x16x32_bf16 v[200:203], v[120:123], v[228:231], v[200:203]
    v_mfma_f32_16x16x32_bf16 v[204:207], v[124:127], v[228:231], v[204:207]
    s_waitcnt vmcnt(14)
    s_waitcnt vmcnt(11)
    v_mfma_f32_16x16x32_bf16 v[128:131], v[68:71], v[232:235], v[128:131]
    s_waitcnt vmcnt(10)
    v_mfma_f32_16x16x32_bf16 v[132:135], v[72:75], v[232:235], v[132:135]
    s_waitcnt vmcnt(9)
    v_mfma_f32_16x16x32_bf16 v[136:139], v[76:79], v[232:235], v[136:139]
    s_waitcnt vmcnt(8)
    v_mfma_f32_16x16x32_bf16 v[140:143], v[80:83], v[232:235], v[140:143]
    s_waitcnt vmcnt(7)
    v_mfma_f32_16x16x32_bf16 v[144:147], v[84:87], v[232:235], v[144:147]
    v_mfma_f32_16x16x32_bf16 v[148:151], v[48:51], v[236:239], v[148:151]
    v_mfma_f32_16x16x32_bf16 v[152:155], v[52:55], v[236:239], v[152:155]
    v_mfma_f32_16x16x32_bf16 v[156:159], v[56:59], v[236:239], v[156:159]
    v_mfma_f32_16x16x32_bf16 v[160:163], v[60:63], v[236:239], v[160:163]
    ds_write_b128 v4, v[128:131] offset:0
    v_mfma_f32_16x16x32_bf16 v[164:167], v[64:67], v[236:239], v[164:167]
    ds_write_b128 v4, v[132:135] offset:64
    v_mfma_f32_16x16x32_bf16 v[168:171], v[28:31], v[240:243], v[168:171]
    ds_write_b128 v4, v[136:139] offset:128
    v_mfma_f32_16x16x32_bf16 v[172:175], v[32:35], v[240:243], v[172:175]
    ds_write_b128 v4, v[140:143] offset:192
    v_mfma_f32_16x16x32_bf16 v[176:179], v[36:39], v[240:243], v[176:179]
    v_add_u32 v2, v1, v4
    ds_write_b128 v2, v[144:147]
    v_mfma_f32_16x16x32_bf16 v[180:183], v[40:43], v[240:243], v[180:183]
    v_mfma_f32_16x16x32_bf16 v[184:187], v[44:47], v[240:243], v[184:187]
    s_waitcnt vmcnt(6)
    v_mfma_f32_16x16x32_bf16 v[188:191], v[8:11], v[244:247], v[188:191]
    v_mfma_f32_16x16x32_bf16 v[192:195], v[12:15], v[244:247], v[192:195]
    v_mfma_f32_16x16x32_bf16 v[196:199], v[16:19], v[244:247], v[196:199]
    v_mfma_f32_16x16x32_bf16 v[200:203], v[20:23], v[244:247], v[200:203]
    v_mfma_f32_16x16x32_bf16 v[204:207], v[24:27], v[244:247], v[204:207]
    s_waitcnt vmcnt(5)
    v_mfma_f32_16x16x32_bf16 v[148:151], v[68:71], v[248:251], v[148:151]
    v_mfma_f32_16x16x32_bf16 v[152:155], v[72:75], v[248:251], v[152:155]
    v_mfma_f32_16x16x32_bf16 v[156:159], v[76:79], v[248:251], v[156:159]
    v_mfma_f32_16x16x32_bf16 v[160:163], v[80:83], v[248:251], v[160:163]
    v_mfma_f32_16x16x32_bf16 v[164:167], v[84:87], v[248:251], v[164:167]
    s_waitcnt vmcnt(4)
    v_mfma_f32_16x16x32_bf16 v[168:171], v[48:51], v[252:255], v[168:171]
    v_mfma_f32_16x16x32_bf16 v[172:175], v[52:55], v[252:255], v[172:175]
    v_mfma_f32_16x16x32_bf16 v[176:179], v[56:59], v[252:255], v[176:179]
    v_mfma_f32_16x16x32_bf16 v[180:183], v[60:63], v[252:255], v[180:183]
    ds_write_b128 v5, v[148:151] offset:0
    v_mfma_f32_16x16x32_bf16 v[184:187], v[64:67], v[252:255], v[184:187]
    ds_write_b128 v5, v[152:155] offset:64
    s_waitcnt vmcnt(3)
    v_mfma_f32_16x16x32_bf16 v[188:191], v[28:31], v[208:211], v[188:191]
    ds_write_b128 v5, v[156:159] offset:128
    v_mfma_f32_16x16x32_bf16 v[192:195], v[32:35], v[208:211], v[192:195]
    ds_write_b128 v5, v[160:163] offset:192
    v_mfma_f32_16x16x32_bf16 v[196:199], v[36:39], v[208:211], v[196:199]
    v_add_u32 v2, v1, v5
    ds_write_b128 v2, v[164:167]
    v_mfma_f32_16x16x32_bf16 v[200:203], v[40:43], v[208:211], v[200:203]
    v_mfma_f32_16x16x32_bf16 v[204:207], v[44:47], v[208:211], v[204:207]
    s_waitcnt vmcnt(2)
    v_mfma_f32_16x16x32_bf16 v[168:171], v[68:71], v[212:215], v[168:171]
    v_mfma_f32_16x16x32_bf16 v[172:175], v[72:75], v[212:215], v[172:175]
    v_mfma_f32_16x16x32_bf16 v[176:179], v[76:79], v[212:215], v[176:179]
    v_mfma_f32_16x16x32_bf16 v[180:183], v[80:83], v[212:215], v[180:183]
    v_mfma_f32_16x16x32_bf16 v[184:187], v[84:87], v[212:215], v[184:187]
    s_waitcnt vmcnt(1)
    v_mfma_f32_16x16x32_bf16 v[188:191], v[48:51], v[216:219], v[188:191]
    v_mfma_f32_16x16x32_bf16 v[192:195], v[52:55], v[216:219], v[192:195]
    v_mfma_f32_16x16x32_bf16 v[196:199], v[56:59], v[216:219], v[196:199]
    v_mfma_f32_16x16x32_bf16 v[200:203], v[60:63], v[216:219], v[200:203]
    ds_write_b128 v6, v[168:171] offset:0
    v_mfma_f32_16x16x32_bf16 v[204:207], v[64:67], v[216:219], v[204:207]
    ds_write_b128 v6, v[172:175] offset:64
    s_waitcnt vmcnt(0)
    v_mfma_f32_16x16x32_bf16 v[188:191], v[68:71], v[220:223], v[188:191]
    ds_write_b128 v6, v[176:179] offset:128
    v_mfma_f32_16x16x32_bf16 v[192:195], v[72:75], v[220:223], v[192:195]
    ds_write_b128 v6, v[180:183] offset:192
    v_mfma_f32_16x16x32_bf16 v[196:199], v[76:79], v[220:223], v[196:199]
    v_add_u32 v2, v1, v6
    ds_write_b128 v2, v[184:187]
    v_mfma_f32_16x16x32_bf16 v[200:203], v[80:83], v[220:223], v[200:203]
    v_mfma_f32_16x16x32_bf16 v[204:207], v[84:87], v[220:223], v[204:207]
    s_nop 3
    s_nop 7
    s_nop 3
    ds_write_b128 v7, v[188:191] offset:0
    ds_write_b128 v7, v[192:195] offset:64
    ds_write_b128 v7, v[196:199] offset:128
    ds_write_b128 v7, v[200:203] offset:192
    v_add_u32 v2, v1, v7
    ds_write_b128 v2, v[204:207]
    s_waitcnt lgkmcnt(0)
    s_barrier
parallel_sum__ssm_conv_s5__glu_gated_bilinear__prompt_kernel_done:
    s_endpgm
.section .rodata,"a"
.p2align 6
.amdhsa_kernel parallel_sum__ssm_conv_s5__glu_gated_bilinear__prompt_kernel
  .amdhsa_next_free_vgpr 256
  .amdhsa_next_free_sgpr 102
  .amdhsa_accum_offset 256
  .amdhsa_group_segment_fixed_size 0
  .amdhsa_kernarg_size 128
  .amdhsa_user_sgpr_count 2
  .amdhsa_user_sgpr_kernarg_segment_ptr 1
  .amdhsa_system_sgpr_workgroup_id_x 1
  .amdhsa_float_denorm_mode_32 3
  .amdhsa_float_denorm_mode_16_64 3
.end_amdhsa_kernel
```
